```python
import torch

def _softmax(x, axis=-1):
    return torch.softmax(x, dim=axis)
def _gelu(x):
    return torch.nn.functional.gelu(x, approximate="tanh")
def _silu(x):
    return torch.nn.functional.silu(x)
def _sigmoid(x):
    return torch.sigmoid(x)
def _layernorm(x, axis=-1, eps=1e-5):
    m = x.mean(dim=axis, keepdim=True)
    v = x.var(dim=axis, keepdim=True, unbiased=False)
    return (x - m) / torch.sqrt(v + eps)
def _scatter_add(tgt, idx, src, axis=0):
    return tgt.clone().index_add_(axis, idx, src)
def _segment_sum(src, seg, n):
    out = torch.zeros((n,) + src.shape[1:], dtype=src.dtype)
    return out.index_add_(0, seg, src)
def _pad(x, pw):
    flat = tuple(v for pair in reversed(pw) for v in pair)
    return torch.nn.functional.pad(x, flat)

kernel_name = 'parallel_sum__linear_attn_block__glu_gated_bilinear__prompt'

def setup_inputs():

    _w = (lambda a: (lambda t: t.to(torch.bfloat16) if t.is_floating_point() else t)(torch.as_tensor(a)))
    def _A_setup():
        B, S, D = 1, 2048, 512
        return {
            "x": _w((lambda *s: torch.randn(*s, dtype=torch.bfloat16) * 0.05)(B, S, D)),
            "wqkv": _w((lambda *s: torch.randn(*s, dtype=torch.bfloat16) * 0.05)(D, 3 * D)),
            "wo": _w((lambda *s: torch.randn(*s, dtype=torch.bfloat16) * 0.05)(D, D)),
        }
    _A_in = _A_setup()

    def _B_setup():
        B, S, D, F = 1, 2048, 512, 1792
        return {
            "x": _w((lambda *s: torch.randn(*s, dtype=torch.bfloat16) * 0.05)(B, S, D)),
            "w_gate": _w((lambda *s: torch.randn(*s, dtype=torch.bfloat16) * 0.2)(D, F) * (D ** -0.5)),
            "w_up": _w((lambda *s: torch.randn(*s, dtype=torch.bfloat16) * 0.2)(D, F) * (D ** -0.5)),
            "w_down": _w((lambda *s: torch.randn(*s, dtype=torch.bfloat16) * 0.2)(F, D) * (F ** -0.5)),
        }
    _B_in = _B_setup()

    return {
        "A_x": _A_in["x"],
        "A_wqkv": _A_in["wqkv"],
        "A_wo": _A_in["wo"],
        "B_x": _B_in["x"],
        "B_w_gate": _B_in["w_gate"],
        "B_w_up": _B_in["w_up"],
        "B_w_down": _B_in["w_down"],
    }

def reference(A_x, A_wqkv, A_wo, B_x, B_w_gate, B_w_up, B_w_down):
    def _A_ref(x, wqkv, wo):
        B, S, D = x.shape
        H = 32; Dh = D // H
        qkv = (lambda x, *d: x.permute(*d))((x @ wqkv).reshape(B, S, 3, H, Dh), 2, 0, 3, 1, 4)
        q, k, v = qkv[0], qkv[1], qkv[2]
        phi = lambda t: torch.where(t > 0, t + 1, torch.exp(t)) + 1e-6
        pq, pk = phi(q), phi(k)
        kv = torch.einsum("bhsd,bhse->bhde", pk, v)
        z = torch.einsum("bhsd->bhd", pk)
        num = torch.einsum("bhqd,bhde->bhqe", pq, kv)
        den = torch.einsum("bhqd,bhd->bhq", pq, z)[..., None] + 1e-6
        o = num / den
        return (lambda x, *d: x.permute(*d))(o, 0, 2, 1, 3).reshape(B, S, D) @ wo

    def _B_ref(x, w_gate, w_up, w_down):
        g = torch.einsum("bsd,df->bsf", x, w_gate)
        u = torch.einsum("bsd,df->bsf", x, w_up)
        h = g * u
        return torch.einsum("bsf,fd->bsd", h, w_down)

    x = A_x
    xn = _layernorm(x, axis=-1)
    return x + _A_ref(xn, A_wqkv, A_wo) + _B_ref(xn, B_w_gate, B_w_up, B_w_down)
```

```asm
; @launch grid=(256,1,1) block=(256,1,1) lds=163840
.amdgcn_target "amdgcn-amd-amdhsa--gfx950"
.text
.globl parallel_sum__linear_attn_block__glu_gated_bilinear__prompt_kernel
.p2align 8
.type parallel_sum__linear_attn_block__glu_gated_bilinear__prompt_kernel,@function
parallel_sum__linear_attn_block__glu_gated_bilinear__prompt_kernel:
  s_cmp_ge_u32 s2, 256
  s_cbranch_scc1 L_end
  s_load_dwordx16 s[76:91], s[0:1], 0
  s_load_dwordx4 s[92:95], s[0:1], 64
  v_and_b32 v30, 63, v0
  v_lshrrev_b32 v32, 6, v0
  v_lshlrev_b32 v1, 4, v30
  v_readfirstlane_b32 s45, v32
  v_lshlrev_b32 v0, 2, v30
  v_lshrrev_b32 v33, 3, v30
  v_and_b32 v34, 7, v30
  v_lshrrev_b32 v35, 4, v30
  v_xor_b32 v36, v34, v35
  v_lshlrev_b32 v36, 4, v36
  v_lshl_add_u32 v37, v33, 10, v36
  v_xor_b32 v38, 64, v37
  v_add_u32 v2, 4096, v37
  v_add_u32 v3, 11264, v38
  v_add_u32 v4, 18432, v37
  v_add_u32 v5, 25600, v38
  s_and_b32 s5, s2, 7
  s_lshr_b32 s6, s2, 3
  s_and_b32 s59, s5, 1
  s_lshl_b32 s59, s59, 3
  s_and_b32 s7, s6, 7
  s_add_u32 s59, s59, s7
  s_lshl_b32 s46, s45, 12
  s_lshl_b32 s47, s59, 17
  s_lshl_b32 s7, s45, 15
  s_add_u32 s47, s47, s7
  s_lshr_b32 s64, s5, 1
  s_lshl_b32 s64, s64, 2
  s_lshr_b32 s7, s6, 3
  s_add_u32 s64, s64, s7
  s_and_b32 s61, s64, 3
  s_lshr_b32 s64, s64, 2
  s_and_b32 s63, s6, 7
  s_lshr_b32 s7, s6, 3
  s_lshl_b32 s62, s5, 2
  s_add_u32 s62, s62, s7
  s_add_u32 s66, s61, s59
  s_and_b32 s66, s66, 3
  s_lshl_b32 s65, s66, 1
  s_getpc_b64 s[96:97]
L_pc:
  s_lshl_b32 s5, s6, 2
  s_add_u32 s5, s5, s45
  s_lshl_b32 s5, s5, 10
  s_min_u32 s5, s5, L_codeend-L_pc
  v_add_u32 v39, s5, v1
  global_load_dwordx4 v[64:67], v39, s[96:97]
  s_waitcnt lgkmcnt(0)
  s_sub_u32 s8, s76, 4096
  s_subb_u32 s9, s77, 0
  s_and_b32 s9, s9, 0xffff
  s_mov_b32 s10, 0x201000
  s_mov_b32 s11, 0x20000
  s_add_u32 s3, s65, 0
  s_and_b32 s3, s3, 7
  s_mul_i32 s3, s3, 128
  s_add_u32 s3, s3, s47
  s_add_u32 m0, s46, 32768
  s_nop 0
  buffer_load_dwordx4 v2, s[8:11], s3 offen lds
  buffer_load_dwordx4 v3, s[8:11], s3 offen offset:1024 lds
  buffer_load_dwordx4 v4, s[8:11], s3 offen offset:2048 lds
  buffer_load_dwordx4 v5, s[8:11], s3 offen offset:3072 lds
  s_add_u32 s3, s65, 1
  s_and_b32 s3, s3, 7
  s_mul_i32 s3, s3, 128
  s_add_u32 s3, s3, s47
  s_add_u32 m0, s46, 49152
  s_nop 0
  buffer_load_dwordx4 v2, s[8:11], s3 offen lds
  buffer_load_dwordx4 v3, s[8:11], s3 offen offset:1024 lds
  buffer_load_dwordx4 v4, s[8:11], s3 offen offset:2048 lds
  buffer_load_dwordx4 v5, s[8:11], s3 offen offset:3072 lds
  s_add_u32 s3, s65, 2
  s_and_b32 s3, s3, 7
  s_mul_i32 s3, s3, 128
  s_add_u32 s3, s3, s47
  s_add_u32 m0, s46, 65536
  s_nop 0
  buffer_load_dwordx4 v2, s[8:11], s3 offen lds
  buffer_load_dwordx4 v3, s[8:11], s3 offen offset:1024 lds
  buffer_load_dwordx4 v4, s[8:11], s3 offen offset:2048 lds
  buffer_load_dwordx4 v5, s[8:11], s3 offen offset:3072 lds
  s_sub_u32 s12, s78, 4096
  s_subb_u32 s13, s79, 0
  s_and_b32 s13, s13, 0xffff
  s_mov_b32 s14, 0x181000
  s_mov_b32 s15, 0x20000
  s_sub_u32 s20, s84, 4096
  s_subb_u32 s21, s85, 0
  s_and_b32 s21, s21, 0xffff
  s_mov_b32 s22, 0x1c1000
  s_mov_b32 s23, 0x20000
  s_sub_u32 s24, s86, 4096
  s_subb_u32 s25, s87, 0
  s_and_b32 s25, s25, 0xffff
  s_mov_b32 s26, 0x1c1000
  s_mov_b32 s27, 0x20000
  s_sub_u32 s16, s80, 4096
  s_subb_u32 s17, s81, 0
  s_and_b32 s17, s17, 0xffff
  s_mov_b32 s18, 0x81000
  s_mov_b32 s19, 0x20000
  s_sub_u32 s28, s88, 4096
  s_subb_u32 s29, s89, 0
  s_and_b32 s29, s29, 0xffff
  s_mov_b32 s30, 0x1c1000
  s_mov_b32 s31, 0x20000
  s_mov_b32 s32, s90
  s_and_b32 s33, s91, 0xffff
  s_mov_b32 s34, 0x200000
  s_mov_b32 s35, 0x20000
  s_mov_b32 s40, s92
  s_and_b32 s41, s93, 0xffff
  s_mov_b32 s42, 0x100
  s_mov_b32 s43, 0x20000
  s_mov_b32 s36, s94
  s_and_b32 s37, s95, 0xffff
  s_mov_b32 s38, 0xe00000
  s_mov_b32 s39, 0x20000
  s_lshr_b32 s60, s61, 1
  s_lshl_b32 s7, s64, 1
  s_add_u32 s60, s60, s7
  s_mov_b32 s67, 0x3f803f80
  v_and_b32 v36, 1, v35
  v_lshlrev_b32 v37, 1, v36
  v_xor_b32 v37, v34, v37
  v_lshlrev_b32 v37, 4, v37
  v_mul_u32_u24 v38, 3584, v33
  v_add_u32 v10, v38, v37
  v_lshlrev_b32 v37, 2, v36
  v_xor_b32 v37, v34, v37
  v_lshlrev_b32 v37, 4, v37
  v_mul_u32_u24 v38, 3072, v33
  v_add_u32 v11, v38, v37
  v_lshl_add_u32 v38, v33, 10, v37
  v_add_u32 v6, 4096, v38
  v_add_u32 v7, 11264, v38
  v_add_u32 v8, 18432, v38
  v_add_u32 v9, 25600, v38
  v_lshrrev_b32 v37, 2, v30
  v_mul_u32_u24 v38, 3584, v37
  v_and_b32 v39, 3, v30
  v_lshl_add_u32 v12, v39, 4, v38
  v_bfe_u32 v40, v30, 2, 2
  v_lshrrev_b32 v41, 5, v30
  v_and_b32 v42, 1, v33
  v_lshl_add_u32 v43, v41, 3, v40
  v_lshl_add_u32 v44, v41, 2, v40
  v_lshlrev_b32 v45, 3, v39
  v_lshl_add_u32 v46, v36, 1, v42
  v_lshl_add_u32 v46, v46, 5, v45
  v_lshl_add_u32 v46, v43, 7, v46
  v_lshl_add_u32 v13, v36, 11, v46
  v_lshl_add_u32 v46, v36, 5, v45
  v_lshlrev_b32 v47, 6, v42
  v_xor_b32 v46, v46, v47
  v_lshl_add_u32 v14, v43, 7, v46
  v_lshl_add_u32 v16, v44, 7, v46
  v_add_u32 v16, s46, v16
  v_lshl_add_u32 v46, v36, 5, v45
  v_lshl_add_u32 v46, v43, 6, v46
  v_lshl_add_u32 v15, v36, 10, v46
  v_and_b32 v46, 31, v30
  v_bfe_u32 v47, v30, 1, 3
  v_xor_b32 v47, v47, v41
  v_lshlrev_b32 v47, 4, v47
  v_lshl_add_u32 v63, v46, 7, v47
  v_add_u32 v63, s46, v63
  s_mul_i32 s51, s45, 458752
  s_lshl_b32 s5, s63, 7
  s_add_u32 s51, s51, s5
  s_lshl_b32 s52, s45, 17
  s_add_u32 s52, s52, s5
  s_mul_i32 s5, s62, 294912
  s_mul_i32 s57, s45, 57344
  s_add_u32 s57, s57, s5
  s_lshl_b32 s58, s45, 14
  s_add_u32 s58, s58, s5
  s_add_u32 s58, s58, 229376
  s_mul_i32 s74, s62, 73728
  s_add_u32 s74, s74, 11534336
  s_mul_i32 s6, s45, 14336
  s_add_u32 s74, s74, s6
  s_lshl_b32 s5, s59, 2
  s_add_u32 s5, s5, s45
  s_lshr_b32 s6, s5, 1
  s_and_b32 s7, s5, 1
  s_mul_i32 s53, s6, 294912
  s_lshl_b32 s44, s7, 10
  s_add_u32 s53, s53, s44
  s_mul_i32 s73, s6, 73728
  s_lshl_b32 s44, s7, 8
  s_add_u32 s73, s73, s44
  s_add_u32 s73, s73, 11534336
  s_lshl_b32 s68, s60, 13
  s_add_u32 s68, s68, 10485760
  s_lshl_b32 s6, s60, 7
  s_lshl_b32 s7, s59, 2
  s_add_u32 s69, s6, s7
  s_add_u32 s69, s69, 10551296
  s_memrealtime s[96:97]
  s_lshl_b32 s5, s5, 7
  s_lshl_b32 s6, s64, 4
  s_lshl_b32 s7, s61, 2
  s_add_u32 s5, s5, s6
  s_add_u32 s5, s5, s7
  s_add_u32 s5, s5, 10552320
  s_waitcnt lgkmcnt(0)
  s_and_b32 s6, s45, 1
  s_cmp_eq_u32 s6, 0
  s_mov_b32 s6, 0x9e3779b1
  s_cselect_b32 s6, 0x85ebca6b, s6
  s_or_b32 s72, s96, 1
  s_mul_i32 s72, s72, s6
  s_mov_b32 s75, s5
  s_mov_b32 s84, 0x0000ffff
  s_mov_b32 s85, 0x0000ffff
  s_cmp_eq_u32 s45, 0
  s_cselect_b32 s6, 0, 0x7ffffff0
  v_mov_b32 v25, s6
  s_cmp_eq_u32 s61, 1
  s_cbranch_scc1 L_KV
  s_cmp_eq_u32 s61, 2
  s_cbranch_scc1 L_KV
  s_mul_i32 s7, s64, 448
  s_cmp_eq_u32 s61, 3
  s_cselect_b32 s6, 320, 0
  s_add_u32 s7, s7, s6
  s_mul_i32 s48, s45, 57344
  s_lshl_b32 s6, s7, 1
  s_add_u32 s48, s48, s6
  s_add_u32 s49, s48, 128
  s_mul_i32 s50, s45, 98304
  s_lshl_b32 s6, s60, 7
  s_add_u32 s50, s50, s6
  s_lshl_b32 s6, s7, 7
  s_add_u32 s54, s53, s6
  s_add_u32 s55, s54, 8192
  s_lshl_b32 s6, s60, 13
  s_add_u32 s56, s53, s6
  s_add_u32 s56, s56, 229376
  s_lshl_b32 s5, s2, 2
  s_add_u32 s5, s5, s45
  v_lshlrev_b32 v60, 7, v30
  s_mul_i32 s6, s5, 1792
  s_add_u32 s6, s6, 4096
  s_mov_b64 exec, 0x3fff
  buffer_load_dword v55, v60, s[28:31], s6 offen
  s_mul_i32 s6, s5, 512
  s_add_u32 s6, s6, 4096
  s_mov_b64 exec, 0xf
  buffer_load_dword v54, v60, s[16:19], s6 offen
  s_mov_b64 exec, -1
  v_mov_b32 v26, 0
  v_mov_b32 v40, 0
  v_mov_b32 v27, 0
  v_mov_b32 v41, 0
  v_mov_b32 v28, 0
  v_mov_b32 v42, 0
  v_mov_b32 v29, 0
  v_mov_b32 v43, 0
  s_waitcnt vmcnt(10)
  v_add_u32 v17, 32768, v63
  v_xor_b32 v18, 32, v17
  v_xor_b32 v19, 64, v17
  v_xor_b32 v20, 96, v17
  ds_read_b128 v[128:131], v17
  ds_read_b128 v[132:135], v18
  ds_read_b128 v[136:139], v19
  ds_read_b128 v[140:143], v20
  s_add_u32 s3, s65, 3
  s_and_b32 s3, s3, 7
  s_mul_i32 s3, s3, 128
  s_add_u32 s3, s3, s47
  s_add_u32 m0, s46, 81920
  s_nop 0
  buffer_load_dwordx4 v2, s[8:11], s3 offen lds
  buffer_load_dwordx4 v3, s[8:11], s3 offen offset:1024 lds
  buffer_load_dwordx4 v4, s[8:11], s3 offen offset:2048 lds
  buffer_load_dwordx4 v5, s[8:11], s3 offen offset:3072 lds
  s_waitcnt vmcnt(10)
  v_add_u32 v17, 49152, v63
  v_xor_b32 v18, 32, v17
  v_xor_b32 v19, 64, v17
  v_xor_b32 v20, 96, v17
  ds_read_b128 v[144:147], v17
  ds_read_b128 v[148:151], v18
  ds_read_b128 v[152:155], v19
  ds_read_b128 v[156:159], v20
  s_add_u32 s3, s65, 4
  s_and_b32 s3, s3, 7
  s_mul_i32 s3, s3, 128
  s_add_u32 s3, s3, s47
  s_add_u32 m0, s46, 98304
  s_nop 0
  buffer_load_dwordx4 v2, s[8:11], s3 offen lds
  buffer_load_dwordx4 v3, s[8:11], s3 offen offset:1024 lds
  buffer_load_dwordx4 v4, s[8:11], s3 offen offset:2048 lds
  buffer_load_dwordx4 v5, s[8:11], s3 offen offset:3072 lds
  s_waitcnt lgkmcnt(4)
  v_dot2c_f32_bf16 v26, s67, v128
  v_dot2c_f32_bf16 v40, v128, v128
  v_dot2c_f32_bf16 v27, s67, v129
  v_dot2c_f32_bf16 v41, v129, v129
  v_dot2c_f32_bf16 v28, s67, v130
  v_dot2c_f32_bf16 v42, v130, v130
  v_dot2c_f32_bf16 v29, s67, v131
  v_dot2c_f32_bf16 v43, v131, v131
  v_dot2c_f32_bf16 v26, s67, v132
  v_dot2c_f32_bf16 v40, v132, v132
  v_dot2c_f32_bf16 v27, s67, v133
  v_dot2c_f32_bf16 v41, v133, v133
  v_dot2c_f32_bf16 v28, s67, v134
  v_dot2c_f32_bf16 v42, v134, v134
  v_dot2c_f32_bf16 v29, s67, v135
  v_dot2c_f32_bf16 v43, v135, v135
  v_dot2c_f32_bf16 v26, s67, v136
  v_dot2c_f32_bf16 v40, v136, v136
  v_dot2c_f32_bf16 v27, s67, v137
  v_dot2c_f32_bf16 v41, v137, v137
  v_dot2c_f32_bf16 v28, s67, v138
  v_dot2c_f32_bf16 v42, v138, v138
  v_dot2c_f32_bf16 v29, s67, v139
  v_dot2c_f32_bf16 v43, v139, v139
  v_dot2c_f32_bf16 v26, s67, v140
  v_dot2c_f32_bf16 v40, v140, v140
  v_dot2c_f32_bf16 v27, s67, v141
  v_dot2c_f32_bf16 v41, v141, v141
  v_dot2c_f32_bf16 v28, s67, v142
  v_dot2c_f32_bf16 v42, v142, v142
  v_dot2c_f32_bf16 v29, s67, v143
  v_dot2c_f32_bf16 v43, v143, v143
  s_waitcnt vmcnt(10)
  v_add_u32 v17, 65536, v63
  v_xor_b32 v18, 32, v17
  v_xor_b32 v19, 64, v17
  v_xor_b32 v20, 96, v17
  ds_read_b128 v[160:163], v17
  ds_read_b128 v[164:167], v18
  ds_read_b128 v[168:171], v19
  ds_read_b128 v[172:175], v20
  s_add_u32 s3, s65, 5
  s_and_b32 s3, s3, 7
  s_mul_i32 s3, s3, 128
  s_add_u32 s3, s3, s47
  s_add_u32 m0, s46, 114688
  s_nop 0
  buffer_load_dwordx4 v2, s[8:11], s3 offen lds
  buffer_load_dwordx4 v3, s[8:11], s3 offen offset:1024 lds
  buffer_load_dwordx4 v4, s[8:11], s3 offen offset:2048 lds
  buffer_load_dwordx4 v5, s[8:11], s3 offen offset:3072 lds
  s_waitcnt lgkmcnt(4)
  v_dot2c_f32_bf16 v26, s67, v144
  v_dot2c_f32_bf16 v40, v144, v144
  v_dot2c_f32_bf16 v27, s67, v145
  v_dot2c_f32_bf16 v41, v145, v145
  v_dot2c_f32_bf16 v28, s67, v146
  v_dot2c_f32_bf16 v42, v146, v146
  v_dot2c_f32_bf16 v29, s67, v147
  v_dot2c_f32_bf16 v43, v147, v147
  v_dot2c_f32_bf16 v26, s67, v148
  v_dot2c_f32_bf16 v40, v148, v148
  v_dot2c_f32_bf16 v27, s67, v149
  v_dot2c_f32_bf16 v41, v149, v149
  v_dot2c_f32_bf16 v28, s67, v150
  v_dot2c_f32_bf16 v42, v150, v150
  v_dot2c_f32_bf16 v29, s67, v151
  v_dot2c_f32_bf16 v43, v151, v151
  v_dot2c_f32_bf16 v26, s67, v152
  v_dot2c_f32_bf16 v40, v152, v152
  v_dot2c_f32_bf16 v27, s67, v153
  v_dot2c_f32_bf16 v41, v153, v153
  v_dot2c_f32_bf16 v28, s67, v154
  v_dot2c_f32_bf16 v42, v154, v154
  v_dot2c_f32_bf16 v29, s67, v155
  v_dot2c_f32_bf16 v43, v155, v155
  v_dot2c_f32_bf16 v26, s67, v156
  v_dot2c_f32_bf16 v40, v156, v156
  v_dot2c_f32_bf16 v27, s67, v157
  v_dot2c_f32_bf16 v41, v157, v157
  v_dot2c_f32_bf16 v28, s67, v158
  v_dot2c_f32_bf16 v42, v158, v158
  v_dot2c_f32_bf16 v29, s67, v159
  v_dot2c_f32_bf16 v43, v159, v159
  s_waitcnt vmcnt(8)
  v_add_u32 v17, 81920, v63
  v_xor_b32 v18, 32, v17
  v_xor_b32 v19, 64, v17
  v_xor_b32 v20, 96, v17
  ds_read_b128 v[176:179], v17
  ds_read_b128 v[180:183], v18
  ds_read_b128 v[184:187], v19
  ds_read_b128 v[188:191], v20
  s_add_u32 s3, s65, 6
  s_and_b32 s3, s3, 7
  s_mul_i32 s3, s3, 128
  s_add_u32 s3, s3, s47
  s_add_u32 m0, s46, 131072
  s_nop 0
  buffer_load_dwordx4 v2, s[8:11], s3 offen lds
  buffer_load_dwordx4 v3, s[8:11], s3 offen offset:1024 lds
  buffer_load_dwordx4 v4, s[8:11], s3 offen offset:2048 lds
  buffer_load_dwordx4 v5, s[8:11], s3 offen offset:3072 lds
  s_waitcnt lgkmcnt(4)
  v_dot2c_f32_bf16 v26, s67, v160
  v_dot2c_f32_bf16 v40, v160, v160
  v_dot2c_f32_bf16 v27, s67, v161
  v_dot2c_f32_bf16 v41, v161, v161
  v_dot2c_f32_bf16 v28, s67, v162
  v_dot2c_f32_bf16 v42, v162, v162
  v_dot2c_f32_bf16 v29, s67, v163
  v_dot2c_f32_bf16 v43, v163, v163
  v_dot2c_f32_bf16 v26, s67, v164
  v_dot2c_f32_bf16 v40, v164, v164
  v_dot2c_f32_bf16 v27, s67, v165
  v_dot2c_f32_bf16 v41, v165, v165
  v_dot2c_f32_bf16 v28, s67, v166
  v_dot2c_f32_bf16 v42, v166, v166
  v_dot2c_f32_bf16 v29, s67, v167
  v_dot2c_f32_bf16 v43, v167, v167
  v_dot2c_f32_bf16 v26, s67, v168
  v_dot2c_f32_bf16 v40, v168, v168
  v_dot2c_f32_bf16 v27, s67, v169
  v_dot2c_f32_bf16 v41, v169, v169
  v_dot2c_f32_bf16 v28, s67, v170
  v_dot2c_f32_bf16 v42, v170, v170
  v_dot2c_f32_bf16 v29, s67, v171
  v_dot2c_f32_bf16 v43, v171, v171
  v_dot2c_f32_bf16 v26, s67, v172
  v_dot2c_f32_bf16 v40, v172, v172
  v_dot2c_f32_bf16 v27, s67, v173
  v_dot2c_f32_bf16 v41, v173, v173
  v_dot2c_f32_bf16 v28, s67, v174
  v_dot2c_f32_bf16 v42, v174, v174
  v_dot2c_f32_bf16 v29, s67, v175
  v_dot2c_f32_bf16 v43, v175, v175
  s_waitcnt vmcnt(8)
  v_add_u32 v17, 98304, v63
  v_xor_b32 v18, 32, v17
  v_xor_b32 v19, 64, v17
  v_xor_b32 v20, 96, v17
  ds_read_b128 v[192:195], v17
  ds_read_b128 v[196:199], v18
  ds_read_b128 v[200:203], v19
  ds_read_b128 v[204:207], v20
  s_add_u32 s3, s65, 7
  s_and_b32 s3, s3, 7
  s_mul_i32 s3, s3, 128
  s_add_u32 s3, s3, s47
  s_add_u32 m0, s46, 147456
  s_nop 0
  buffer_load_dwordx4 v2, s[8:11], s3 offen lds
  buffer_load_dwordx4 v3, s[8:11], s3 offen offset:1024 lds
  buffer_load_dwordx4 v4, s[8:11], s3 offen offset:2048 lds
  buffer_load_dwordx4 v5, s[8:11], s3 offen offset:3072 lds
  s_waitcnt lgkmcnt(4)
  v_dot2c_f32_bf16 v26, s67, v176
  v_dot2c_f32_bf16 v40, v176, v176
  v_dot2c_f32_bf16 v27, s67, v177
  v_dot2c_f32_bf16 v41, v177, v177
  v_dot2c_f32_bf16 v28, s67, v178
  v_dot2c_f32_bf16 v42, v178, v178
  v_dot2c_f32_bf16 v29, s67, v179
  v_dot2c_f32_bf16 v43, v179, v179
  v_dot2c_f32_bf16 v26, s67, v180
  v_dot2c_f32_bf16 v40, v180, v180
  v_dot2c_f32_bf16 v27, s67, v181
  v_dot2c_f32_bf16 v41, v181, v181
  v_dot2c_f32_bf16 v28, s67, v182
  v_dot2c_f32_bf16 v42, v182, v182
  v_dot2c_f32_bf16 v29, s67, v183
  v_dot2c_f32_bf16 v43, v183, v183
  v_dot2c_f32_bf16 v26, s67, v184
  v_dot2c_f32_bf16 v40, v184, v184
  v_dot2c_f32_bf16 v27, s67, v185
  v_dot2c_f32_bf16 v41, v185, v185
  v_dot2c_f32_bf16 v28, s67, v186
  v_dot2c_f32_bf16 v42, v186, v186
  v_dot2c_f32_bf16 v29, s67, v187
  v_dot2c_f32_bf16 v43, v187, v187
  v_dot2c_f32_bf16 v26, s67, v188
  v_dot2c_f32_bf16 v40, v188, v188
  v_dot2c_f32_bf16 v27, s67, v189
  v_dot2c_f32_bf16 v41, v189, v189
  v_dot2c_f32_bf16 v28, s67, v190
  v_dot2c_f32_bf16 v42, v190, v190
  v_dot2c_f32_bf16 v29, s67, v191
  v_dot2c_f32_bf16 v43, v191, v191
  s_waitcnt vmcnt(8)
  v_add_u32 v17, 114688, v63
  v_xor_b32 v18, 32, v17
  v_xor_b32 v19, 64, v17
  v_xor_b32 v20, 96, v17
  ds_read_b128 v[208:211], v17
  ds_read_b128 v[212:215], v18
  ds_read_b128 v[216:219], v19
  ds_read_b128 v[220:223], v20
  v_add_u32 v2, 4096, v10
  v_add_u32 v3, 31744, v10
  v_xor_b32 v5, 64, v10
  v_add_u32 v4, 2048, v5
  v_add_u32 v5, 29696, v5
  s_add_u32 s3, s65, 0
  s_and_b32 s3, s3, 7
  s_mul_i32 s3, s3, 229376
  s_add_u32 s3, s3, s48
  s_add_u32 m0, s46, 0
  s_nop 0
  buffer_load_dwordx4 v2, s[20:23], s3 offen lds
  buffer_load_dwordx4 v3, s[20:23], s3 offen offset:1024 lds
  buffer_load_dwordx4 v4, s[24:27], s3 offen offset:2048 lds
  buffer_load_dwordx4 v5, s[24:27], s3 offen offset:3072 lds
  s_waitcnt lgkmcnt(4)
  v_dot2c_f32_bf16 v26, s67, v192
  v_dot2c_f32_bf16 v40, v192, v192
  v_dot2c_f32_bf16 v27, s67, v193
  v_dot2c_f32_bf16 v41, v193, v193
  v_dot2c_f32_bf16 v28, s67, v194
  v_dot2c_f32_bf16 v42, v194, v194
  v_dot2c_f32_bf16 v29, s67, v195
  v_dot2c_f32_bf16 v43, v195, v195
  v_dot2c_f32_bf16 v26, s67, v196
  v_dot2c_f32_bf16 v40, v196, v196
  v_dot2c_f32_bf16 v27, s67, v197
  v_dot2c_f32_bf16 v41, v197, v197
  v_dot2c_f32_bf16 v28, s67, v198
  v_dot2c_f32_bf16 v42, v198, v198
  v_dot2c_f32_bf16 v29, s67, v199
  v_dot2c_f32_bf16 v43, v199, v199
  v_dot2c_f32_bf16 v26, s67, v200
  v_dot2c_f32_bf16 v40, v200, v200
  v_dot2c_f32_bf16 v27, s67, v201
  v_dot2c_f32_bf16 v41, v201, v201
  v_dot2c_f32_bf16 v28, s67, v202
  v_dot2c_f32_bf16 v42, v202, v202
  v_dot2c_f32_bf16 v29, s67, v203
  v_dot2c_f32_bf16 v43, v203, v203
  v_dot2c_f32_bf16 v26, s67, v204
  v_dot2c_f32_bf16 v40, v204, v204
  v_dot2c_f32_bf16 v27, s67, v205
  v_dot2c_f32_bf16 v41, v205, v205
  v_dot2c_f32_bf16 v28, s67, v206
  v_dot2c_f32_bf16 v42, v206, v206
  v_dot2c_f32_bf16 v29, s67, v207
  v_dot2c_f32_bf16 v43, v207, v207
  s_waitcnt vmcnt(8)
  v_add_u32 v17, 131072, v63
  v_xor_b32 v18, 32, v17
  v_xor_b32 v19, 64, v17
  v_xor_b32 v20, 96, v17
  ds_read_b128 v[224:227], v17
  ds_read_b128 v[228:231], v18
  ds_read_b128 v[232:235], v19
  ds_read_b128 v[236:239], v20
  s_add_u32 s3, s65, 1
  s_and_b32 s3, s3, 7
  s_mul_i32 s3, s3, 229376
  s_add_u32 s3, s3, s48
  s_add_u32 m0, s46, 16384
  s_nop 0
  buffer_load_dwordx4 v2, s[20:23], s3 offen lds
  buffer_load_dwordx4 v3, s[20:23], s3 offen offset:1024 lds
  buffer_load_dwordx4 v4, s[24:27], s3 offen offset:2048 lds
  buffer_load_dwordx4 v5, s[24:27], s3 offen offset:3072 lds
  s_waitcnt lgkmcnt(4)
  v_dot2c_f32_bf16 v26, s67, v208
  v_dot2c_f32_bf16 v40, v208, v208
  v_dot2c_f32_bf16 v27, s67, v209
  v_dot2c_f32_bf16 v41, v209, v209
  v_dot2c_f32_bf16 v28, s67, v210
  v_dot2c_f32_bf16 v42, v210, v210
  v_dot2c_f32_bf16 v29, s67, v211
  v_dot2c_f32_bf16 v43, v211, v211
  v_dot2c_f32_bf16 v26, s67, v212
  v_dot2c_f32_bf16 v40, v212, v212
  v_dot2c_f32_bf16 v27, s67, v213
  v_dot2c_f32_bf16 v41, v213, v213
  v_dot2c_f32_bf16 v28, s67, v214
  v_dot2c_f32_bf16 v42, v214, v214
  v_dot2c_f32_bf16 v29, s67, v215
  v_dot2c_f32_bf16 v43, v215, v215
  v_dot2c_f32_bf16 v26, s67, v216
  v_dot2c_f32_bf16 v40, v216, v216
  v_dot2c_f32_bf16 v27, s67, v217
  v_dot2c_f32_bf16 v41, v217, v217
  v_dot2c_f32_bf16 v28, s67, v218
  v_dot2c_f32_bf16 v42, v218, v218
  v_dot2c_f32_bf16 v29, s67, v219
  v_dot2c_f32_bf16 v43, v219, v219
  v_dot2c_f32_bf16 v26, s67, v220
  v_dot2c_f32_bf16 v40, v220, v220
  v_dot2c_f32_bf16 v27, s67, v221
  v_dot2c_f32_bf16 v41, v221, v221
  v_dot2c_f32_bf16 v28, s67, v222
  v_dot2c_f32_bf16 v42, v222, v222
  v_dot2c_f32_bf16 v29, s67, v223
  v_dot2c_f32_bf16 v43, v223, v223
  s_waitcnt vmcnt(8)
  v_add_u32 v17, 147456, v63
  v_xor_b32 v18, 32, v17
  v_xor_b32 v19, 64, v17
  v_xor_b32 v20, 96, v17
  ds_read_b128 v[240:243], v17
  ds_read_b128 v[244:247], v18
  ds_read_b128 v[248:251], v19
  ds_read_b128 v[252:255], v20
  s_mov_b64 exec, 1
  v_mov_b32 v62, 0
  v_mov_b32 v61, s72
  buffer_store_dword v61, v62, s[36:39], s75 offen sc1
  s_mov_b64 exec, -1
  s_waitcnt lgkmcnt(4)
  v_dot2c_f32_bf16 v26, s67, v224
  v_dot2c_f32_bf16 v40, v224, v224
  v_dot2c_f32_bf16 v27, s67, v225
  v_dot2c_f32_bf16 v41, v225, v225
  v_dot2c_f32_bf16 v28, s67, v226
  v_dot2c_f32_bf16 v42, v226, v226
  v_dot2c_f32_bf16 v29, s67, v227
  v_dot2c_f32_bf16 v43, v227, v227
  v_dot2c_f32_bf16 v26, s67, v228
  v_dot2c_f32_bf16 v40, v228, v228
  v_dot2c_f32_bf16 v27, s67, v229
  v_dot2c_f32_bf16 v41, v229, v229
  v_dot2c_f32_bf16 v28, s67, v230
  v_dot2c_f32_bf16 v42, v230, v230
  v_dot2c_f32_bf16 v29, s67, v231
  v_dot2c_f32_bf16 v43, v231, v231
  v_dot2c_f32_bf16 v26, s67, v232
  v_dot2c_f32_bf16 v40, v232, v232
  v_dot2c_f32_bf16 v27, s67, v233
  v_dot2c_f32_bf16 v41, v233, v233
  v_dot2c_f32_bf16 v28, s67, v234
  v_dot2c_f32_bf16 v42, v234, v234
  v_dot2c_f32_bf16 v29, s67, v235
  v_dot2c_f32_bf16 v43, v235, v235
  v_dot2c_f32_bf16 v26, s67, v236
  v_dot2c_f32_bf16 v40, v236, v236
  v_dot2c_f32_bf16 v27, s67, v237
  v_dot2c_f32_bf16 v41, v237, v237
  v_dot2c_f32_bf16 v28, s67, v238
  v_dot2c_f32_bf16 v42, v238, v238
  v_dot2c_f32_bf16 v29, s67, v239
  v_dot2c_f32_bf16 v43, v239, v239
  s_waitcnt lgkmcnt(0)
  v_dot2c_f32_bf16 v26, s67, v240
  v_dot2c_f32_bf16 v40, v240, v240
  v_dot2c_f32_bf16 v27, s67, v241
  v_dot2c_f32_bf16 v41, v241, v241
  v_dot2c_f32_bf16 v28, s67, v242
  v_dot2c_f32_bf16 v42, v242, v242
  v_dot2c_f32_bf16 v29, s67, v243
  v_dot2c_f32_bf16 v43, v243, v243
  v_dot2c_f32_bf16 v26, s67, v244
  v_dot2c_f32_bf16 v40, v244, v244
  v_dot2c_f32_bf16 v27, s67, v245
  v_dot2c_f32_bf16 v41, v245, v245
  v_dot2c_f32_bf16 v28, s67, v246
  v_dot2c_f32_bf16 v42, v246, v246
  v_dot2c_f32_bf16 v29, s67, v247
  v_dot2c_f32_bf16 v43, v247, v247
  v_dot2c_f32_bf16 v26, s67, v248
  v_dot2c_f32_bf16 v40, v248, v248
  v_dot2c_f32_bf16 v27, s67, v249
  v_dot2c_f32_bf16 v41, v249, v249
  v_dot2c_f32_bf16 v28, s67, v250
  v_dot2c_f32_bf16 v42, v250, v250
  v_dot2c_f32_bf16 v29, s67, v251
  v_dot2c_f32_bf16 v43, v251, v251
  v_dot2c_f32_bf16 v26, s67, v252
  v_dot2c_f32_bf16 v40, v252, v252
  v_dot2c_f32_bf16 v27, s67, v253
  v_dot2c_f32_bf16 v41, v253, v253
  v_dot2c_f32_bf16 v28, s67, v254
  v_dot2c_f32_bf16 v42, v254, v254
  v_dot2c_f32_bf16 v29, s67, v255
  v_dot2c_f32_bf16 v43, v255, v255
  v_add_f32 v26, v26, v27
  s_nop 0
  v_add_f32 v28, v28, v29
  v_add_f32 v40, v40, v41
  v_add_f32 v42, v42, v43
  v_add_f32 v26, v26, v28
  v_add_f32 v40, v40, v42
  v_mov_b32 v27, v26
  v_mov_b32 v41, v40
  s_nop 0
  v_permlane32_swap_b32 v26, v27
  v_permlane32_swap_b32 v40, v41
  v_add_f32 v26, v26, v27
  v_add_f32 v40, v40, v41
  v_mul_f32 v23, 0xbb000000, v26
  v_mul_f32 v40, 0x3b000000, v40
  v_fma_f32 v40, -v23, v23, v40
  v_max_f32 v40, 0, v40
  v_add_f32 v40, 0x3727c5ac, v40
  v_rsq_f32 v24, v40
  s_nop 0
  v_mul_f32 v48, v23, v24
  s_mov_b32 s44, 0xffff0000
  v_lshlrev_b32 v32, 16, v128
  v_and_b32 v33, s44, v128
  v_lshlrev_b32 v34, 16, v129
  v_and_b32 v35, s44, v129
  v_lshlrev_b32 v36, 16, v130
  v_and_b32 v37, s44, v130
  v_pk_fma_f32 v[32:33], v[32:33], v[24:25], v[48:49] op_sel_hi:[1,0,0]
  v_lshlrev_b32 v38, 16, v131
  v_and_b32 v39, s44, v131
  v_pk_fma_f32 v[34:35], v[34:35], v[24:25], v[48:49] op_sel_hi:[1,0,0]
  s_add_u32 s3, s65, 2
  s_and_b32 s3, s3, 7
  s_mul_i32 s3, s3, 229376
  s_add_u32 s3, s3, s48
  s_add_u32 m0, s46, 32768
  s_nop 0
  buffer_load_dwordx4 v2, s[20:23], s3 offen lds
  buffer_load_dwordx4 v3, s[20:23], s3 offen offset:1024 lds
  buffer_load_dwordx4 v4, s[24:27], s3 offen offset:2048 lds
  buffer_load_dwordx4 v5, s[24:27], s3 offen offset:3072 lds
  v_lshlrev_b32 v40, 16, v132
  v_and_b32 v41, s44, v132
  v_pk_fma_f32 v[36:37], v[36:37], v[24:25], v[48:49] op_sel_hi:[1,0,0]
  v_cvt_pk_bf16_f32 v128, v32, v33
  v_lshlrev_b32 v42, 16, v133
  v_and_b32 v43, s44, v133
  v_pk_fma_f32 v[38:39], v[38:39], v[24:25], v[48:49] op_sel_hi:[1,0,0]
  v_cvt_pk_bf16_f32 v129, v34, v35
  v_lshlrev_b32 v44, 16, v134
  v_and_b32 v45, s44, v134
  v_pk_fma_f32 v[40:41], v[40:41], v[24:25], v[48:49] op_sel_hi:[1,0,0]
  v_cvt_pk_bf16_f32 v130, v36, v37
  v_lshlrev_b32 v46, 16, v135
  v_and_b32 v47, s44, v135
  v_pk_fma_f32 v[42:43], v[42:43], v[24:25], v[48:49] op_sel_hi:[1,0,0]
  v_cvt_pk_bf16_f32 v131, v38, v39
  v_lshlrev_b32 v32, 16, v136
  v_and_b32 v33, s44, v136
  v_pk_fma_f32 v[44:45], v[44:45], v[24:25], v[48:49] op_sel_hi:[1,0,0]
  v_cvt_pk_bf16_f32 v132, v40, v41
  v_lshlrev_b32 v34, 16, v137
  v_and_b32 v35, s44, v137
  v_pk_fma_f32 v[46:47], v[46:47], v[24:25], v[48:49] op_sel_hi:[1,0,0]
  v_cvt_pk_bf16_f32 v133, v42, v43
  v_lshlrev_b32 v36, 16, v138
  v_and_b32 v37, s44, v138
  v_pk_fma_f32 v[32:33], v[32:33], v[24:25], v[48:49] op_sel_hi:[1,0,0]
  v_cvt_pk_bf16_f32 v134, v44, v45
  v_lshlrev_b32 v38, 16, v139
  v_and_b32 v39, s44, v139
  v_pk_fma_f32 v[34:35], v[34:35], v[24:25], v[48:49] op_sel_hi:[1,0,0]
  v_cvt_pk_bf16_f32 v135, v46, v47
  v_lshlrev_b32 v40, 16, v140
  v_and_b32 v41, s44, v140
  v_pk_fma_f32 v[36:37], v[36:37], v[24:25], v[48:49] op_sel_hi:[1,0,0]
  v_cvt_pk_bf16_f32 v136, v32, v33
  v_lshlrev_b32 v42, 16, v141
  v_and_b32 v43, s44, v141
  v_pk_fma_f32 v[38:39], v[38:39], v[24:25], v[48:49] op_sel_hi:[1,0,0]
  v_cvt_pk_bf16_f32 v137, v34, v35
  v_lshlrev_b32 v44, 16, v142
  v_and_b32 v45, s44, v142
  v_pk_fma_f32 v[40:41], v[40:41], v[24:25], v[48:49] op_sel_hi:[1,0,0]
  v_cvt_pk_bf16_f32 v138, v36, v37
  v_lshlrev_b32 v46, 16, v143
  v_and_b32 v47, s44, v143
  v_pk_fma_f32 v[42:43], v[42:43], v[24:25], v[48:49] op_sel_hi:[1,0,0]
  v_cvt_pk_bf16_f32 v139, v38, v39
  v_lshlrev_b32 v32, 16, v144
  v_and_b32 v33, s44, v144
  v_pk_fma_f32 v[44:45], v[44:45], v[24:25], v[48:49] op_sel_hi:[1,0,0]
  v_cvt_pk_bf16_f32 v140, v40, v41
  v_lshlrev_b32 v34, 16, v145
  v_and_b32 v35, s44, v145
  v_pk_fma_f32 v[46:47], v[46:47], v[24:25], v[48:49] op_sel_hi:[1,0,0]
  v_cvt_pk_bf16_f32 v141, v42, v43
  v_lshlrev_b32 v36, 16, v146
  v_and_b32 v37, s44, v146
  v_pk_fma_f32 v[32:33], v[32:33], v[24:25], v[48:49] op_sel_hi:[1,0,0]
  v_cvt_pk_bf16_f32 v142, v44, v45
  v_lshlrev_b32 v38, 16, v147
  v_and_b32 v39, s44, v147
  v_pk_fma_f32 v[34:35], v[34:35], v[24:25], v[48:49] op_sel_hi:[1,0,0]
  v_cvt_pk_bf16_f32 v143, v46, v47
  v_lshlrev_b32 v40, 16, v148
  v_and_b32 v41, s44, v148
  v_pk_fma_f32 v[36:37], v[36:37], v[24:25], v[48:49] op_sel_hi:[1,0,0]
  v_cvt_pk_bf16_f32 v144, v32, v33
  v_lshlrev_b32 v42, 16, v149
  v_and_b32 v43, s44, v149
  v_pk_fma_f32 v[38:39], v[38:39], v[24:25], v[48:49] op_sel_hi:[1,0,0]
  v_cvt_pk_bf16_f32 v145, v34, v35
  s_add_u32 s3, s65, 3
  s_and_b32 s3, s3, 7
  s_mul_i32 s3, s3, 229376
  s_add_u32 s3, s3, s48
  s_add_u32 m0, s46, 49152
  s_nop 0
  buffer_load_dwordx4 v2, s[20:23], s3 offen lds
  buffer_load_dwordx4 v3, s[20:23], s3 offen offset:1024 lds
  buffer_load_dwordx4 v4, s[24:27], s3 offen offset:2048 lds
  buffer_load_dwordx4 v5, s[24:27], s3 offen offset:3072 lds
  v_lshlrev_b32 v44, 16, v150
  v_and_b32 v45, s44, v150
  v_pk_fma_f32 v[40:41], v[40:41], v[24:25], v[48:49] op_sel_hi:[1,0,0]
  v_cvt_pk_bf16_f32 v146, v36, v37
  v_lshlrev_b32 v46, 16, v151
  v_and_b32 v47, s44, v151
  v_pk_fma_f32 v[42:43], v[42:43], v[24:25], v[48:49] op_sel_hi:[1,0,0]
  v_cvt_pk_bf16_f32 v147, v38, v39
  v_lshlrev_b32 v32, 16, v152
  v_and_b32 v33, s44, v152
  v_pk_fma_f32 v[44:45], v[44:45], v[24:25], v[48:49] op_sel_hi:[1,0,0]
  v_cvt_pk_bf16_f32 v148, v40, v41
  v_lshlrev_b32 v34, 16, v153
  v_and_b32 v35, s44, v153
  v_pk_fma_f32 v[46:47], v[46:47], v[24:25], v[48:49] op_sel_hi:[1,0,0]
  v_cvt_pk_bf16_f32 v149, v42, v43
  v_lshlrev_b32 v36, 16, v154
  v_and_b32 v37, s44, v154
  v_pk_fma_f32 v[32:33], v[32:33], v[24:25], v[48:49] op_sel_hi:[1,0,0]
  v_cvt_pk_bf16_f32 v150, v44, v45
  v_lshlrev_b32 v38, 16, v155
  v_and_b32 v39, s44, v155
  v_pk_fma_f32 v[34:35], v[34:35], v[24:25], v[48:49] op_sel_hi:[1,0,0]
  v_cvt_pk_bf16_f32 v151, v46, v47
  v_lshlrev_b32 v40, 16, v156
  v_and_b32 v41, s44, v156
  v_pk_fma_f32 v[36:37], v[36:37], v[24:25], v[48:49] op_sel_hi:[1,0,0]
  v_cvt_pk_bf16_f32 v152, v32, v33
  v_lshlrev_b32 v42, 16, v157
  v_and_b32 v43, s44, v157
  v_pk_fma_f32 v[38:39], v[38:39], v[24:25], v[48:49] op_sel_hi:[1,0,0]
  v_cvt_pk_bf16_f32 v153, v34, v35
  v_lshlrev_b32 v44, 16, v158
  v_and_b32 v45, s44, v158
  v_pk_fma_f32 v[40:41], v[40:41], v[24:25], v[48:49] op_sel_hi:[1,0,0]
  v_cvt_pk_bf16_f32 v154, v36, v37
  v_lshlrev_b32 v46, 16, v159
  v_and_b32 v47, s44, v159
  v_pk_fma_f32 v[42:43], v[42:43], v[24:25], v[48:49] op_sel_hi:[1,0,0]
  v_cvt_pk_bf16_f32 v155, v38, v39
  v_lshlrev_b32 v32, 16, v160
  v_and_b32 v33, s44, v160
  v_pk_fma_f32 v[44:45], v[44:45], v[24:25], v[48:49] op_sel_hi:[1,0,0]
  v_cvt_pk_bf16_f32 v156, v40, v41
  v_lshlrev_b32 v34, 16, v161
  v_and_b32 v35, s44, v161
  v_pk_fma_f32 v[46:47], v[46:47], v[24:25], v[48:49] op_sel_hi:[1,0,0]
  v_cvt_pk_bf16_f32 v157, v42, v43
  v_lshlrev_b32 v36, 16, v162
  v_and_b32 v37, s44, v162
  v_pk_fma_f32 v[32:33], v[32:33], v[24:25], v[48:49] op_sel_hi:[1,0,0]
  v_cvt_pk_bf16_f32 v158, v44, v45
  v_lshlrev_b32 v38, 16, v163
  v_and_b32 v39, s44, v163
  v_pk_fma_f32 v[34:35], v[34:35], v[24:25], v[48:49] op_sel_hi:[1,0,0]
  v_cvt_pk_bf16_f32 v159, v46, v47
  v_lshlrev_b32 v40, 16, v164
  v_and_b32 v41, s44, v164
  v_pk_fma_f32 v[36:37], v[36:37], v[24:25], v[48:49] op_sel_hi:[1,0,0]
  v_cvt_pk_bf16_f32 v160, v32, v33
  v_lshlrev_b32 v42, 16, v165
  v_and_b32 v43, s44, v165
  v_pk_fma_f32 v[38:39], v[38:39], v[24:25], v[48:49] op_sel_hi:[1,0,0]
  v_cvt_pk_bf16_f32 v161, v34, v35
  v_lshlrev_b32 v44, 16, v166
  v_and_b32 v45, s44, v166
  v_pk_fma_f32 v[40:41], v[40:41], v[24:25], v[48:49] op_sel_hi:[1,0,0]
  v_cvt_pk_bf16_f32 v162, v36, v37
  v_lshlrev_b32 v46, 16, v167
  v_and_b32 v47, s44, v167
  v_pk_fma_f32 v[42:43], v[42:43], v[24:25], v[48:49] op_sel_hi:[1,0,0]
  v_cvt_pk_bf16_f32 v163, v38, v39
  s_add_u32 s3, s65, 4
  s_and_b32 s3, s3, 7
  s_mul_i32 s3, s3, 229376
  s_add_u32 s3, s3, s48
  s_add_u32 m0, s46, 65536
  s_nop 0
  buffer_load_dwordx4 v2, s[20:23], s3 offen lds
  buffer_load_dwordx4 v3, s[20:23], s3 offen offset:1024 lds
  buffer_load_dwordx4 v4, s[24:27], s3 offen offset:2048 lds
  buffer_load_dwordx4 v5, s[24:27], s3 offen offset:3072 lds
  v_lshlrev_b32 v32, 16, v168
  v_and_b32 v33, s44, v168
  v_pk_fma_f32 v[44:45], v[44:45], v[24:25], v[48:49] op_sel_hi:[1,0,0]
  v_cvt_pk_bf16_f32 v164, v40, v41
  v_lshlrev_b32 v34, 16, v169
  v_and_b32 v35, s44, v169
  v_pk_fma_f32 v[46:47], v[46:47], v[24:25], v[48:49] op_sel_hi:[1,0,0]
  v_cvt_pk_bf16_f32 v165, v42, v43
  v_lshlrev_b32 v36, 16, v170
  v_and_b32 v37, s44, v170
  v_pk_fma_f32 v[32:33], v[32:33], v[24:25], v[48:49] op_sel_hi:[1,0,0]
  v_cvt_pk_bf16_f32 v166, v44, v45
  v_lshlrev_b32 v38, 16, v171
  v_and_b32 v39, s44, v171
  v_pk_fma_f32 v[34:35], v[34:35], v[24:25], v[48:49] op_sel_hi:[1,0,0]
  v_cvt_pk_bf16_f32 v167, v46, v47
  v_lshlrev_b32 v40, 16, v172
  v_and_b32 v41, s44, v172
  v_pk_fma_f32 v[36:37], v[36:37], v[24:25], v[48:49] op_sel_hi:[1,0,0]
  v_cvt_pk_bf16_f32 v168, v32, v33
  v_lshlrev_b32 v42, 16, v173
  v_and_b32 v43, s44, v173
  v_pk_fma_f32 v[38:39], v[38:39], v[24:25], v[48:49] op_sel_hi:[1,0,0]
  v_cvt_pk_bf16_f32 v169, v34, v35
  v_lshlrev_b32 v44, 16, v174
  v_and_b32 v45, s44, v174
  v_pk_fma_f32 v[40:41], v[40:41], v[24:25], v[48:49] op_sel_hi:[1,0,0]
  v_cvt_pk_bf16_f32 v170, v36, v37
  v_lshlrev_b32 v46, 16, v175
  v_and_b32 v47, s44, v175
  v_pk_fma_f32 v[42:43], v[42:43], v[24:25], v[48:49] op_sel_hi:[1,0,0]
  v_cvt_pk_bf16_f32 v171, v38, v39
  v_lshlrev_b32 v32, 16, v176
  v_and_b32 v33, s44, v176
  v_pk_fma_f32 v[44:45], v[44:45], v[24:25], v[48:49] op_sel_hi:[1,0,0]
  v_cvt_pk_bf16_f32 v172, v40, v41
  v_lshlrev_b32 v34, 16, v177
  v_and_b32 v35, s44, v177
  v_pk_fma_f32 v[46:47], v[46:47], v[24:25], v[48:49] op_sel_hi:[1,0,0]
  v_cvt_pk_bf16_f32 v173, v42, v43
  v_lshlrev_b32 v36, 16, v178
  v_and_b32 v37, s44, v178
  v_pk_fma_f32 v[32:33], v[32:33], v[24:25], v[48:49] op_sel_hi:[1,0,0]
  v_cvt_pk_bf16_f32 v174, v44, v45
  v_lshlrev_b32 v38, 16, v179
  v_and_b32 v39, s44, v179
  v_pk_fma_f32 v[34:35], v[34:35], v[24:25], v[48:49] op_sel_hi:[1,0,0]
  v_cvt_pk_bf16_f32 v175, v46, v47
  v_lshlrev_b32 v40, 16, v180
  v_and_b32 v41, s44, v180
  v_pk_fma_f32 v[36:37], v[36:37], v[24:25], v[48:49] op_sel_hi:[1,0,0]
  v_cvt_pk_bf16_f32 v176, v32, v33
  v_lshlrev_b32 v42, 16, v181
  v_and_b32 v43, s44, v181
  v_pk_fma_f32 v[38:39], v[38:39], v[24:25], v[48:49] op_sel_hi:[1,0,0]
  v_cvt_pk_bf16_f32 v177, v34, v35
  v_lshlrev_b32 v44, 16, v182
  v_and_b32 v45, s44, v182
  v_pk_fma_f32 v[40:41], v[40:41], v[24:25], v[48:49] op_sel_hi:[1,0,0]
  v_cvt_pk_bf16_f32 v178, v36, v37
  v_lshlrev_b32 v46, 16, v183
  v_and_b32 v47, s44, v183
  v_pk_fma_f32 v[42:43], v[42:43], v[24:25], v[48:49] op_sel_hi:[1,0,0]
  v_cvt_pk_bf16_f32 v179, v38, v39
  v_lshlrev_b32 v32, 16, v184
  v_and_b32 v33, s44, v184
  v_pk_fma_f32 v[44:45], v[44:45], v[24:25], v[48:49] op_sel_hi:[1,0,0]
  v_cvt_pk_bf16_f32 v180, v40, v41
  v_lshlrev_b32 v34, 16, v185
  v_and_b32 v35, s44, v185
  v_pk_fma_f32 v[46:47], v[46:47], v[24:25], v[48:49] op_sel_hi:[1,0,0]
  v_cvt_pk_bf16_f32 v181, v42, v43
  s_add_u32 s3, s65, 5
  s_and_b32 s3, s3, 7
  s_mul_i32 s3, s3, 229376
  s_add_u32 s3, s3, s48
  s_add_u32 m0, s46, 81920
  s_nop 0
  buffer_load_dwordx4 v2, s[20:23], s3 offen lds
  buffer_load_dwordx4 v3, s[20:23], s3 offen offset:1024 lds
  buffer_load_dwordx4 v4, s[24:27], s3 offen offset:2048 lds
  buffer_load_dwordx4 v5, s[24:27], s3 offen offset:3072 lds
  v_lshlrev_b32 v36, 16, v186
  v_and_b32 v37, s44, v186
  v_pk_fma_f32 v[32:33], v[32:33], v[24:25], v[48:49] op_sel_hi:[1,0,0]
  v_cvt_pk_bf16_f32 v182, v44, v45
  v_lshlrev_b32 v38, 16, v187
  v_and_b32 v39, s44, v187
  v_pk_fma_f32 v[34:35], v[34:35], v[24:25], v[48:49] op_sel_hi:[1,0,0]
  v_cvt_pk_bf16_f32 v183, v46, v47
  v_lshlrev_b32 v40, 16, v188
  v_and_b32 v41, s44, v188
  v_pk_fma_f32 v[36:37], v[36:37], v[24:25], v[48:49] op_sel_hi:[1,0,0]
  v_cvt_pk_bf16_f32 v184, v32, v33
  v_lshlrev_b32 v42, 16, v189
  v_and_b32 v43, s44, v189
  v_pk_fma_f32 v[38:39], v[38:39], v[24:25], v[48:49] op_sel_hi:[1,0,0]
  v_cvt_pk_bf16_f32 v185, v34, v35
  v_lshlrev_b32 v44, 16, v190
  v_and_b32 v45, s44, v190
  v_pk_fma_f32 v[40:41], v[40:41], v[24:25], v[48:49] op_sel_hi:[1,0,0]
  v_cvt_pk_bf16_f32 v186, v36, v37
  v_lshlrev_b32 v46, 16, v191
  v_and_b32 v47, s44, v191
  v_pk_fma_f32 v[42:43], v[42:43], v[24:25], v[48:49] op_sel_hi:[1,0,0]
  v_cvt_pk_bf16_f32 v187, v38, v39
  v_lshlrev_b32 v32, 16, v192
  v_and_b32 v33, s44, v192
  v_pk_fma_f32 v[44:45], v[44:45], v[24:25], v[48:49] op_sel_hi:[1,0,0]
  v_cvt_pk_bf16_f32 v188, v40, v41
  v_lshlrev_b32 v34, 16, v193
  v_and_b32 v35, s44, v193
  v_pk_fma_f32 v[46:47], v[46:47], v[24:25], v[48:49] op_sel_hi:[1,0,0]
  v_cvt_pk_bf16_f32 v189, v42, v43
  v_lshlrev_b32 v36, 16, v194
  v_and_b32 v37, s44, v194
  v_pk_fma_f32 v[32:33], v[32:33], v[24:25], v[48:49] op_sel_hi:[1,0,0]
  v_cvt_pk_bf16_f32 v190, v44, v45
  v_lshlrev_b32 v38, 16, v195
  v_and_b32 v39, s44, v195
  v_pk_fma_f32 v[34:35], v[34:35], v[24:25], v[48:49] op_sel_hi:[1,0,0]
  v_cvt_pk_bf16_f32 v191, v46, v47
  v_lshlrev_b32 v40, 16, v196
  v_and_b32 v41, s44, v196
  v_pk_fma_f32 v[36:37], v[36:37], v[24:25], v[48:49] op_sel_hi:[1,0,0]
  v_cvt_pk_bf16_f32 v192, v32, v33
  v_lshlrev_b32 v42, 16, v197
  v_and_b32 v43, s44, v197
  v_pk_fma_f32 v[38:39], v[38:39], v[24:25], v[48:49] op_sel_hi:[1,0,0]
  v_cvt_pk_bf16_f32 v193, v34, v35
  v_lshlrev_b32 v44, 16, v198
  v_and_b32 v45, s44, v198
  v_pk_fma_f32 v[40:41], v[40:41], v[24:25], v[48:49] op_sel_hi:[1,0,0]
  v_cvt_pk_bf16_f32 v194, v36, v37
  v_lshlrev_b32 v46, 16, v199
  v_and_b32 v47, s44, v199
  v_pk_fma_f32 v[42:43], v[42:43], v[24:25], v[48:49] op_sel_hi:[1,0,0]
  v_cvt_pk_bf16_f32 v195, v38, v39
  v_lshlrev_b32 v32, 16, v200
  v_and_b32 v33, s44, v200
  v_pk_fma_f32 v[44:45], v[44:45], v[24:25], v[48:49] op_sel_hi:[1,0,0]
  v_cvt_pk_bf16_f32 v196, v40, v41
  v_lshlrev_b32 v34, 16, v201
  v_and_b32 v35, s44, v201
  v_pk_fma_f32 v[46:47], v[46:47], v[24:25], v[48:49] op_sel_hi:[1,0,0]
  v_cvt_pk_bf16_f32 v197, v42, v43
  v_lshlrev_b32 v36, 16, v202
  v_and_b32 v37, s44, v202
  v_pk_fma_f32 v[32:33], v[32:33], v[24:25], v[48:49] op_sel_hi:[1,0,0]
  v_cvt_pk_bf16_f32 v198, v44, v45
  v_lshlrev_b32 v38, 16, v203
  v_and_b32 v39, s44, v203
  v_pk_fma_f32 v[34:35], v[34:35], v[24:25], v[48:49] op_sel_hi:[1,0,0]
  v_cvt_pk_bf16_f32 v199, v46, v47
  s_add_u32 s3, s65, 6
  s_and_b32 s3, s3, 7
  s_mul_i32 s3, s3, 229376
  s_add_u32 s3, s3, s48
  s_add_u32 m0, s46, 98304
  s_nop 0
  buffer_load_dwordx4 v2, s[20:23], s3 offen lds
  buffer_load_dwordx4 v3, s[20:23], s3 offen offset:1024 lds
  buffer_load_dwordx4 v4, s[24:27], s3 offen offset:2048 lds
  buffer_load_dwordx4 v5, s[24:27], s3 offen offset:3072 lds
  v_lshlrev_b32 v40, 16, v204
  v_and_b32 v41, s44, v204
  v_pk_fma_f32 v[36:37], v[36:37], v[24:25], v[48:49] op_sel_hi:[1,0,0]
  v_cvt_pk_bf16_f32 v200, v32, v33
  v_lshlrev_b32 v42, 16, v205
  v_and_b32 v43, s44, v205
  v_pk_fma_f32 v[38:39], v[38:39], v[24:25], v[48:49] op_sel_hi:[1,0,0]
  v_cvt_pk_bf16_f32 v201, v34, v35
  v_lshlrev_b32 v44, 16, v206
  v_and_b32 v45, s44, v206
  v_pk_fma_f32 v[40:41], v[40:41], v[24:25], v[48:49] op_sel_hi:[1,0,0]
  v_cvt_pk_bf16_f32 v202, v36, v37
  v_lshlrev_b32 v46, 16, v207
  v_and_b32 v47, s44, v207
  v_pk_fma_f32 v[42:43], v[42:43], v[24:25], v[48:49] op_sel_hi:[1,0,0]
  v_cvt_pk_bf16_f32 v203, v38, v39
  v_lshlrev_b32 v32, 16, v208
  v_and_b32 v33, s44, v208
  v_pk_fma_f32 v[44:45], v[44:45], v[24:25], v[48:49] op_sel_hi:[1,0,0]
  v_cvt_pk_bf16_f32 v204, v40, v41
  v_lshlrev_b32 v34, 16, v209
  v_and_b32 v35, s44, v209
  v_pk_fma_f32 v[46:47], v[46:47], v[24:25], v[48:49] op_sel_hi:[1,0,0]
  v_cvt_pk_bf16_f32 v205, v42, v43
  v_lshlrev_b32 v36, 16, v210
  v_and_b32 v37, s44, v210
  v_pk_fma_f32 v[32:33], v[32:33], v[24:25], v[48:49] op_sel_hi:[1,0,0]
  v_cvt_pk_bf16_f32 v206, v44, v45
  v_lshlrev_b32 v38, 16, v211
  v_and_b32 v39, s44, v211
  v_pk_fma_f32 v[34:35], v[34:35], v[24:25], v[48:49] op_sel_hi:[1,0,0]
  v_cvt_pk_bf16_f32 v207, v46, v47
  v_lshlrev_b32 v40, 16, v212
  v_and_b32 v41, s44, v212
  v_pk_fma_f32 v[36:37], v[36:37], v[24:25], v[48:49] op_sel_hi:[1,0,0]
  v_cvt_pk_bf16_f32 v208, v32, v33
  v_lshlrev_b32 v42, 16, v213
  v_and_b32 v43, s44, v213
  v_pk_fma_f32 v[38:39], v[38:39], v[24:25], v[48:49] op_sel_hi:[1,0,0]
  v_cvt_pk_bf16_f32 v209, v34, v35
  v_lshlrev_b32 v44, 16, v214
  v_and_b32 v45, s44, v214
  v_pk_fma_f32 v[40:41], v[40:41], v[24:25], v[48:49] op_sel_hi:[1,0,0]
  v_cvt_pk_bf16_f32 v210, v36, v37
  v_lshlrev_b32 v46, 16, v215
  v_and_b32 v47, s44, v215
  v_pk_fma_f32 v[42:43], v[42:43], v[24:25], v[48:49] op_sel_hi:[1,0,0]
  v_cvt_pk_bf16_f32 v211, v38, v39
  v_lshlrev_b32 v32, 16, v216
  v_and_b32 v33, s44, v216
  v_pk_fma_f32 v[44:45], v[44:45], v[24:25], v[48:49] op_sel_hi:[1,0,0]
  v_cvt_pk_bf16_f32 v212, v40, v41
  v_lshlrev_b32 v34, 16, v217
  v_and_b32 v35, s44, v217
  v_pk_fma_f32 v[46:47], v[46:47], v[24:25], v[48:49] op_sel_hi:[1,0,0]
  v_cvt_pk_bf16_f32 v213, v42, v43
  v_lshlrev_b32 v36, 16, v218
  v_and_b32 v37, s44, v218
  v_pk_fma_f32 v[32:33], v[32:33], v[24:25], v[48:49] op_sel_hi:[1,0,0]
  v_cvt_pk_bf16_f32 v214, v44, v45
  v_lshlrev_b32 v38, 16, v219
  v_and_b32 v39, s44, v219
  v_pk_fma_f32 v[34:35], v[34:35], v[24:25], v[48:49] op_sel_hi:[1,0,0]
  v_cvt_pk_bf16_f32 v215, v46, v47
  v_lshlrev_b32 v40, 16, v220
  v_and_b32 v41, s44, v220
  v_pk_fma_f32 v[36:37], v[36:37], v[24:25], v[48:49] op_sel_hi:[1,0,0]
  v_cvt_pk_bf16_f32 v216, v32, v33
  v_lshlrev_b32 v42, 16, v221
  v_and_b32 v43, s44, v221
  v_pk_fma_f32 v[38:39], v[38:39], v[24:25], v[48:49] op_sel_hi:[1,0,0]
  v_cvt_pk_bf16_f32 v217, v34, v35
  s_add_u32 s3, s65, 7
  s_and_b32 s3, s3, 7
  s_mul_i32 s3, s3, 229376
  s_add_u32 s3, s3, s48
  s_add_u32 m0, s46, 114688
  s_nop 0
  buffer_load_dwordx4 v2, s[20:23], s3 offen lds
  buffer_load_dwordx4 v3, s[20:23], s3 offen offset:1024 lds
  buffer_load_dwordx4 v4, s[24:27], s3 offen offset:2048 lds
  buffer_load_dwordx4 v5, s[24:27], s3 offen offset:3072 lds
  v_lshlrev_b32 v44, 16, v222
  v_and_b32 v45, s44, v222
  v_pk_fma_f32 v[40:41], v[40:41], v[24:25], v[48:49] op_sel_hi:[1,0,0]
  v_cvt_pk_bf16_f32 v218, v36, v37
  v_lshlrev_b32 v46, 16, v223
  v_and_b32 v47, s44, v223
  v_pk_fma_f32 v[42:43], v[42:43], v[24:25], v[48:49] op_sel_hi:[1,0,0]
  v_cvt_pk_bf16_f32 v219, v38, v39
  v_lshlrev_b32 v32, 16, v224
  v_and_b32 v33, s44, v224
  v_pk_fma_f32 v[44:45], v[44:45], v[24:25], v[48:49] op_sel_hi:[1,0,0]
  v_cvt_pk_bf16_f32 v220, v40, v41
  v_lshlrev_b32 v34, 16, v225
  v_and_b32 v35, s44, v225
  v_pk_fma_f32 v[46:47], v[46:47], v[24:25], v[48:49] op_sel_hi:[1,0,0]
  v_cvt_pk_bf16_f32 v221, v42, v43
  v_lshlrev_b32 v36, 16, v226
  v_and_b32 v37, s44, v226
  v_pk_fma_f32 v[32:33], v[32:33], v[24:25], v[48:49] op_sel_hi:[1,0,0]
  v_cvt_pk_bf16_f32 v222, v44, v45
  v_lshlrev_b32 v38, 16, v227
  v_and_b32 v39, s44, v227
  v_pk_fma_f32 v[34:35], v[34:35], v[24:25], v[48:49] op_sel_hi:[1,0,0]
  v_cvt_pk_bf16_f32 v223, v46, v47
  v_lshlrev_b32 v40, 16, v228
  v_and_b32 v41, s44, v228
  v_pk_fma_f32 v[36:37], v[36:37], v[24:25], v[48:49] op_sel_hi:[1,0,0]
  v_cvt_pk_bf16_f32 v224, v32, v33
  v_lshlrev_b32 v42, 16, v229
  v_and_b32 v43, s44, v229
  v_pk_fma_f32 v[38:39], v[38:39], v[24:25], v[48:49] op_sel_hi:[1,0,0]
  v_cvt_pk_bf16_f32 v225, v34, v35
  v_lshlrev_b32 v44, 16, v230
  v_and_b32 v45, s44, v230
  v_pk_fma_f32 v[40:41], v[40:41], v[24:25], v[48:49] op_sel_hi:[1,0,0]
  v_cvt_pk_bf16_f32 v226, v36, v37
  v_lshlrev_b32 v46, 16, v231
  v_and_b32 v47, s44, v231
  v_pk_fma_f32 v[42:43], v[42:43], v[24:25], v[48:49] op_sel_hi:[1,0,0]
  v_cvt_pk_bf16_f32 v227, v38, v39
  v_lshlrev_b32 v32, 16, v232
  v_and_b32 v33, s44, v232
  v_pk_fma_f32 v[44:45], v[44:45], v[24:25], v[48:49] op_sel_hi:[1,0,0]
  v_cvt_pk_bf16_f32 v228, v40, v41
  v_lshlrev_b32 v34, 16, v233
  v_and_b32 v35, s44, v233
  v_pk_fma_f32 v[46:47], v[46:47], v[24:25], v[48:49] op_sel_hi:[1,0,0]
  v_cvt_pk_bf16_f32 v229, v42, v43
  v_lshlrev_b32 v36, 16, v234
  v_and_b32 v37, s44, v234
  v_pk_fma_f32 v[32:33], v[32:33], v[24:25], v[48:49] op_sel_hi:[1,0,0]
  v_cvt_pk_bf16_f32 v230, v44, v45
  v_lshlrev_b32 v38, 16, v235
  v_and_b32 v39, s44, v235
  v_pk_fma_f32 v[34:35], v[34:35], v[24:25], v[48:49] op_sel_hi:[1,0,0]
  v_cvt_pk_bf16_f32 v231, v46, v47
  v_lshlrev_b32 v40, 16, v236
  v_and_b32 v41, s44, v236
  v_pk_fma_f32 v[36:37], v[36:37], v[24:25], v[48:49] op_sel_hi:[1,0,0]
  v_cvt_pk_bf16_f32 v232, v32, v33
  v_lshlrev_b32 v42, 16, v237
  v_and_b32 v43, s44, v237
  v_pk_fma_f32 v[38:39], v[38:39], v[24:25], v[48:49] op_sel_hi:[1,0,0]
  v_cvt_pk_bf16_f32 v233, v34, v35
  v_lshlrev_b32 v44, 16, v238
  v_and_b32 v45, s44, v238
  v_pk_fma_f32 v[40:41], v[40:41], v[24:25], v[48:49] op_sel_hi:[1,0,0]
  v_cvt_pk_bf16_f32 v234, v36, v37
  v_lshlrev_b32 v46, 16, v239
  v_and_b32 v47, s44, v239
  v_pk_fma_f32 v[42:43], v[42:43], v[24:25], v[48:49] op_sel_hi:[1,0,0]
  v_cvt_pk_bf16_f32 v235, v38, v39
  v_lshlrev_b32 v32, 16, v240
  v_and_b32 v33, s44, v240
  v_pk_fma_f32 v[44:45], v[44:45], v[24:25], v[48:49] op_sel_hi:[1,0,0]
  v_cvt_pk_bf16_f32 v236, v40, v41
  v_lshlrev_b32 v34, 16, v241
  v_and_b32 v35, s44, v241
  v_pk_fma_f32 v[46:47], v[46:47], v[24:25], v[48:49] op_sel_hi:[1,0,0]
  v_cvt_pk_bf16_f32 v237, v42, v43
  v_lshlrev_b32 v36, 16, v242
  v_and_b32 v37, s44, v242
  v_pk_fma_f32 v[32:33], v[32:33], v[24:25], v[48:49] op_sel_hi:[1,0,0]
  v_cvt_pk_bf16_f32 v238, v44, v45
  v_lshlrev_b32 v38, 16, v243
  v_and_b32 v39, s44, v243
  v_pk_fma_f32 v[34:35], v[34:35], v[24:25], v[48:49] op_sel_hi:[1,0,0]
  v_cvt_pk_bf16_f32 v239, v46, v47
  v_lshlrev_b32 v40, 16, v244
  v_and_b32 v41, s44, v244
  v_pk_fma_f32 v[36:37], v[36:37], v[24:25], v[48:49] op_sel_hi:[1,0,0]
  v_cvt_pk_bf16_f32 v240, v32, v33
  v_lshlrev_b32 v42, 16, v245
  v_and_b32 v43, s44, v245
  v_pk_fma_f32 v[38:39], v[38:39], v[24:25], v[48:49] op_sel_hi:[1,0,0]
  v_cvt_pk_bf16_f32 v241, v34, v35
  v_lshlrev_b32 v44, 16, v246
  v_and_b32 v45, s44, v246
  v_pk_fma_f32 v[40:41], v[40:41], v[24:25], v[48:49] op_sel_hi:[1,0,0]
  v_cvt_pk_bf16_f32 v242, v36, v37
  v_lshlrev_b32 v46, 16, v247
  v_and_b32 v47, s44, v247
  v_pk_fma_f32 v[42:43], v[42:43], v[24:25], v[48:49] op_sel_hi:[1,0,0]
  v_cvt_pk_bf16_f32 v243, v38, v39
  v_lshlrev_b32 v32, 16, v248
  v_and_b32 v33, s44, v248
  v_pk_fma_f32 v[44:45], v[44:45], v[24:25], v[48:49] op_sel_hi:[1,0,0]
  v_cvt_pk_bf16_f32 v244, v40, v41
  v_lshlrev_b32 v34, 16, v249
  v_and_b32 v35, s44, v249
  v_pk_fma_f32 v[46:47], v[46:47], v[24:25], v[48:49] op_sel_hi:[1,0,0]
  v_cvt_pk_bf16_f32 v245, v42, v43
  s_waitcnt vmcnt(29)
  s_waitcnt vmcnt(24)
  s_barrier
  v_add_u32 v17, 0, v13
  v_xor_b32 v18, 32, v17
  v_xor_b32 v19, 64, v17
  v_xor_b32 v20, 96, v17
  ds_read_b64_tr_b16 a[0:1], v17 offset:0
  ds_read_b64_tr_b16 a[2:3], v17 offset:512
  ds_read_b64_tr_b16 a[4:5], v18 offset:0
  ds_read_b64_tr_b16 a[6:7], v18 offset:512
  ds_read_b64_tr_b16 a[8:9], v19 offset:0
  ds_read_b64_tr_b16 a[10:11], v19 offset:512
  ds_read_b64_tr_b16 a[12:13], v20 offset:0
  ds_read_b64_tr_b16 a[14:15], v20 offset:512
  ds_read_b64_tr_b16 a[16:17], v17 offset:4096
  ds_read_b64_tr_b16 a[18:19], v17 offset:4608
  ds_read_b64_tr_b16 a[20:21], v18 offset:4096
  ds_read_b64_tr_b16 a[22:23], v18 offset:4608
  v_lshlrev_b32 v36, 16, v250
  v_and_b32 v37, s44, v250
  v_pk_fma_f32 v[32:33], v[32:33], v[24:25], v[48:49] op_sel_hi:[1,0,0]
  v_cvt_pk_bf16_f32 v246, v44, v45
  v_lshlrev_b32 v38, 16, v251
  v_and_b32 v39, s44, v251
  v_pk_fma_f32 v[34:35], v[34:35], v[24:25], v[48:49] op_sel_hi:[1,0,0]
  v_cvt_pk_bf16_f32 v247, v46, v47
  v_lshlrev_b32 v40, 16, v252
  v_and_b32 v41, s44, v252
  v_pk_fma_f32 v[36:37], v[36:37], v[24:25], v[48:49] op_sel_hi:[1,0,0]
  v_cvt_pk_bf16_f32 v248, v32, v33
  v_lshlrev_b32 v42, 16, v253
  v_and_b32 v43, s44, v253
  v_pk_fma_f32 v[38:39], v[38:39], v[24:25], v[48:49] op_sel_hi:[1,0,0]
  v_cvt_pk_bf16_f32 v249, v34, v35
  v_lshlrev_b32 v44, 16, v254
  v_and_b32 v45, s44, v254
  v_pk_fma_f32 v[40:41], v[40:41], v[24:25], v[48:49] op_sel_hi:[1,0,0]
  v_cvt_pk_bf16_f32 v250, v36, v37
  v_lshlrev_b32 v46, 16, v255
  v_and_b32 v47, s44, v255
  v_pk_fma_f32 v[42:43], v[42:43], v[24:25], v[48:49] op_sel_hi:[1,0,0]
  v_cvt_pk_bf16_f32 v251, v38, v39
  v_pk_fma_f32 v[44:45], v[44:45], v[24:25], v[48:49] op_sel_hi:[1,0,0]
  v_cvt_pk_bf16_f32 v252, v40, v41
  v_pk_fma_f32 v[46:47], v[46:47], v[24:25], v[48:49] op_sel_hi:[1,0,0]
  v_cvt_pk_bf16_f32 v253, v42, v43
  v_cvt_pk_bf16_f32 v254, v44, v45
  v_cvt_pk_bf16_f32 v255, v46, v47
  s_waitcnt lgkmcnt(8)
  v_mfma_f32_32x32x16_bf16 v[64:79], a[0:3], v[128:131], 0
  ds_read_b64_tr_b16 a[24:25], v19 offset:4096
  ds_read_b64_tr_b16 a[26:27], v19 offset:4608
  s_add_u32 s4, s51, 0
  v_mfma_f32_32x32x16_bf16 v[80:95], a[4:7], v[128:131], 0
  ds_read_b64_tr_b16 a[28:29], v20 offset:4096
  ds_read_b64_tr_b16 a[30:31], v20 offset:4608
  s_add_u32 m0, s46, 131072
  s_nop 0
  buffer_load_dwordx4 v6, s[28:31], s4 offen lds
  s_waitcnt lgkmcnt(8)
  v_mfma_f32_32x32x16_bf16 v[96:111], a[8:11], v[128:131], 0
  ds_read_b64_tr_b16 a[0:1], v17 offset:8192
  ds_read_b64_tr_b16 a[2:3], v17 offset:8704
  buffer_load_dwordx4 v7, s[28:31], s4 offen offset:1024 lds
  v_mfma_f32_32x32x16_bf16 v[112:127], a[12:15], v[128:131], 0
  ds_read_b64_tr_b16 a[4:5], v18 offset:8192
  ds_read_b64_tr_b16 a[6:7], v18 offset:8704
  buffer_load_dwordx4 v8, s[28:31], s4 offen offset:2048 lds
  s_waitcnt lgkmcnt(8)
  v_mfma_f32_32x32x16_bf16 v[64:79], a[16:19], v[132:135], v[64:79]
  ds_read_b64_tr_b16 a[8:9], v19 offset:8192
  ds_read_b64_tr_b16 a[10:11], v19 offset:8704
  buffer_load_dwordx4 v9, s[28:31], s4 offen offset:3072 lds
  v_mfma_f32_32x32x16_bf16 v[80:95], a[20:23], v[132:135], v[80:95]
  ds_read_b64_tr_b16 a[12:13], v20 offset:8192
  ds_read_b64_tr_b16 a[14:15], v20 offset:8704
  s_add_u32 s4, s51, 32768
  s_waitcnt lgkmcnt(8)
  v_mfma_f32_32x32x16_bf16 v[96:111], a[24:27], v[132:135], v[96:111]
  ds_read_b64_tr_b16 a[16:17], v17 offset:12288
  ds_read_b64_tr_b16 a[18:19], v17 offset:12800
  s_add_u32 m0, s46, 147456
  s_nop 0
  buffer_load_dwordx4 v6, s[28:31], s4 offen lds
  v_mfma_f32_32x32x16_bf16 v[112:127], a[28:31], v[132:135], v[112:127]
  ds_read_b64_tr_b16 a[20:21], v18 offset:12288
  ds_read_b64_tr_b16 a[22:23], v18 offset:12800
  buffer_load_dwordx4 v7, s[28:31], s4 offen offset:1024 lds
  s_waitcnt lgkmcnt(8)
  v_mfma_f32_32x32x16_bf16 v[64:79], a[0:3], v[136:139], v[64:79]
  ds_read_b64_tr_b16 a[24:25], v19 offset:12288
  ds_read_b64_tr_b16 a[26:27], v19 offset:12800
  buffer_load_dwordx4 v8, s[28:31], s4 offen offset:2048 lds
  v_mfma_f32_32x32x16_bf16 v[80:95], a[4:7], v[136:139], v[80:95]
  ds_read_b64_tr_b16 a[28:29], v20 offset:12288
  ds_read_b64_tr_b16 a[30:31], v20 offset:12800
  buffer_load_dwordx4 v9, s[28:31], s4 offen offset:3072 lds
  s_waitcnt lgkmcnt(8)
  v_mfma_f32_32x32x16_bf16 v[96:111], a[8:11], v[136:139], v[96:111]
  s_barrier
  v_add_u32 v17, 16384, v13
  v_xor_b32 v18, 32, v17
  v_xor_b32 v19, 64, v17
  v_xor_b32 v20, 96, v17
  ds_read_b64_tr_b16 a[0:1], v17 offset:0
  ds_read_b64_tr_b16 a[2:3], v17 offset:512
  s_and_b32 s6, s2, 3
  s_lshl_b32 s6, s6, 6
  s_mov_b64 exec, 1
  v_mov_b32 v61, 1
  buffer_atomic_add v61, v25, s[40:43], s6 offen
  s_mov_b64 exec, -1
  s_nop 3
  v_mfma_f32_32x32x16_bf16 v[112:127], a[12:15], v[136:139], v[112:127]
  ds_read_b64_tr_b16 a[4:5], v18 offset:0
  ds_read_b64_tr_b16 a[6:7], v18 offset:512
  s_waitcnt lgkmcnt(8)
  v_mfma_f32_32x32x16_bf16 v[64:79], a[16:19], v[140:143], v[64:79]
  ds_read_b64_tr_b16 a[8:9], v19 offset:0
  ds_read_b64_tr_b16 a[10:11], v19 offset:512
  v_mfma_f32_32x32x16_bf16 v[80:95], a[20:23], v[140:143], v[80:95]
  ds_read_b64_tr_b16 a[12:13], v20 offset:0
  ds_read_b64_tr_b16 a[14:15], v20 offset:512
  s_waitcnt lgkmcnt(8)
  v_mfma_f32_32x32x16_bf16 v[96:111], a[24:27], v[140:143], v[96:111]
  ds_read_b64_tr_b16 a[16:17], v17 offset:4096
  ds_read_b64_tr_b16 a[18:19], v17 offset:4608
  v_mfma_f32_32x32x16_bf16 v[112:127], a[28:31], v[140:143], v[112:127]
  ds_read_b64_tr_b16 a[20:21], v18 offset:4096
  ds_read_b64_tr_b16 a[22:23], v18 offset:4608
  s_waitcnt lgkmcnt(8)
  v_mfma_f32_32x32x16_bf16 v[64:79], a[0:3], v[144:147], v[64:79]
  ds_read_b64_tr_b16 a[24:25], v19 offset:4096
  ds_read_b64_tr_b16 a[26:27], v19 offset:4608
  v_mfma_f32_32x32x16_bf16 v[80:95], a[4:7], v[144:147], v[80:95]
  ds_read_b64_tr_b16 a[28:29], v20 offset:4096
  ds_read_b64_tr_b16 a[30:31], v20 offset:4608
  s_waitcnt lgkmcnt(8)
  v_mfma_f32_32x32x16_bf16 v[96:111], a[8:11], v[144:147], v[96:111]
  ds_read_b64_tr_b16 a[0:1], v17 offset:8192
  ds_read_b64_tr_b16 a[2:3], v17 offset:8704
  v_mfma_f32_32x32x16_bf16 v[112:127], a[12:15], v[144:147], v[112:127]
  ds_read_b64_tr_b16 a[4:5], v18 offset:8192
  ds_read_b64_tr_b16 a[6:7], v18 offset:8704
  s_waitcnt lgkmcnt(8)
  v_mfma_f32_32x32x16_bf16 v[64:79], a[16:19], v[148:151], v[64:79]
  ds_read_b64_tr_b16 a[8:9], v19 offset:8192
  ds_read_b64_tr_b16 a[10:11], v19 offset:8704
  v_mfma_f32_32x32x16_bf16 v[80:95], a[20:23], v[148:151], v[80:95]
  ds_read_b64_tr_b16 a[12:13], v20 offset:8192
  ds_read_b64_tr_b16 a[14:15], v20 offset:8704
  s_waitcnt lgkmcnt(8)
  v_mfma_f32_32x32x16_bf16 v[96:111], a[24:27], v[148:151], v[96:111]
  ds_read_b64_tr_b16 a[16:17], v17 offset:12288
  ds_read_b64_tr_b16 a[18:19], v17 offset:12800
  v_mfma_f32_32x32x16_bf16 v[112:127], a[28:31], v[148:151], v[112:127]
  ds_read_b64_tr_b16 a[20:21], v18 offset:12288
  ds_read_b64_tr_b16 a[22:23], v18 offset:12800
  s_waitcnt lgkmcnt(8)
  v_mfma_f32_32x32x16_bf16 v[64:79], a[0:3], v[152:155], v[64:79]
  ds_read_b64_tr_b16 a[24:25], v19 offset:12288
  ds_read_b64_tr_b16 a[26:27], v19 offset:12800
  v_mfma_f32_32x32x16_bf16 v[80:95], a[4:7], v[152:155], v[80:95]
  ds_read_b64_tr_b16 a[28:29], v20 offset:12288
  ds_read_b64_tr_b16 a[30:31], v20 offset:12800
  s_waitcnt lgkmcnt(8)
  v_mfma_f32_32x32x16_bf16 v[96:111], a[8:11], v[152:155], v[96:111]
  s_waitcnt vmcnt(29)
  s_barrier
  v_add_u32 v17, 32768, v13
  v_xor_b32 v18, 32, v17
  v_xor_b32 v19, 64, v17
  v_xor_b32 v20, 96, v17
  ds_read_b64_tr_b16 a[0:1], v17 offset:0
  ds_read_b64_tr_b16 a[2:3], v17 offset:512
  s_add_u32 s3, s65, 0
  s_and_b32 s3, s3, 7
  s_mul_i32 s3, s3, 229376
  s_add_u32 s3, s3, s49
  v_mfma_f32_32x32x16_bf16 v[112:127], a[12:15], v[152:155], v[112:127]
  ds_read_b64_tr_b16 a[4:5], v18 offset:0
  ds_read_b64_tr_b16 a[6:7], v18 offset:512
  s_add_u32 m0, s46, 0
  s_nop 0
  buffer_load_dwordx4 v2, s[20:23], s3 offen lds
  s_waitcnt lgkmcnt(8)
  v_mfma_f32_32x32x16_bf16 v[64:79], a[16:19], v[156:159], v[64:79]
  ds_read_b64_tr_b16 a[8:9], v19 offset:0
  ds_read_b64_tr_b16 a[10:11], v19 offset:512
  buffer_load_dwordx4 v3, s[20:23], s3 offen offset:1024 lds
  v_mfma_f32_32x32x16_bf16 v[80:95], a[20:23], v[156:159], v[80:95]
  ds_read_b64_tr_b16 a[12:13], v20 offset:0
  ds_read_b64_tr_b16 a[14:15], v20 offset:512
  buffer_load_dwordx4 v4, s[24:27], s3 offen offset:2048 lds
  s_waitcnt lgkmcnt(8)
  v_mfma_f32_32x32x16_bf16 v[96:111], a[24:27], v[156:159], v[96:111]
  ds_read_b64_tr_b16 a[16:17], v17 offset:4096
  ds_read_b64_tr_b16 a[18:19], v17 offset:4608
  buffer_load_dwordx4 v5, s[24:27], s3 offen offset:3072 lds
  s_lshl_b32 s5, s2, 2
  s_add_u32 s5, s5, s45
  v_lshlrev_b32 v60, 7, v30
  s_mov_b32 s7, 0x7ffffff0
  s_mov_b32 s92, s12
  s_mov_b32 s93, s13
  s_mov_b32 s94, s14
  s_mov_b32 s95, s15
  s_sub_u32 s6, s5, 0
  s_lshl_b32 s44, s6, 13
  s_add_u32 s44, s44, 4096
  s_cmp_lt_u32 s6, 192
  s_cselect_b32 s7, s44, s7
  s_cselect_b32 s92, s12, s92
  s_cselect_b32 s93, s13, s93
  s_cselect_b32 s94, s14, s94
  s_sub_u32 s6, s5, 192
  s_lshl_b32 s44, s6, 13
  s_add_u32 s44, s44, 4096
  s_cmp_lt_u32 s6, 224
  s_cselect_b32 s7, s44, s7
  s_cselect_b32 s92, s20, s92
  s_cselect_b32 s93, s21, s93
  s_cselect_b32 s94, s22, s94
  s_sub_u32 s6, s5, 416
  s_lshl_b32 s44, s6, 13
  s_add_u32 s44, s44, 4096
  s_cmp_lt_u32 s6, 224
  s_cselect_b32 s7, s44, s7
  s_cselect_b32 s92, s24, s92
  s_cselect_b32 s93, s25, s93
  s_cselect_b32 s94, s26, s94
  s_sub_u32 s6, s5, 640
  s_lshl_b32 s44, s6, 13
  s_add_u32 s44, s44, 4096
  s_cmp_lt_u32 s6, 224
  s_cselect_b32 s7, s44, s7
  s_cselect_b32 s92, s28, s92
  s_cselect_b32 s93, s29, s93
  s_cselect_b32 s94, s30, s94
  s_sub_u32 s6, s5, 864
  s_lshl_b32 s44, s6, 13
  s_add_u32 s44, s44, 4096
  s_cmp_lt_u32 s6, 64
  s_cselect_b32 s7, s44, s7
  s_cselect_b32 s92, s16, s92
  s_cselect_b32 s93, s17, s93
  s_cselect_b32 s94, s18, s94
  s_mov_b32 s95, 0x20000
  v_add_u32 v60, s7, v60
  buffer_load_dword v55, v60, s[92:95], 0 offen
  v_mfma_f32_32x32x16_bf16 v[112:127], a[28:31], v[156:159], v[112:127]
  ds_read_b64_tr_b16 a[20:21], v18 offset:4096
  ds_read_b64_tr_b16 a[22:23], v18 offset:4608
  s_waitcnt lgkmcnt(8)
  v_mfma_f32_32x32x16_bf16 v[64:79], a[0:3], v[160:163], v[64:79]
  ds_read_b64_tr_b16 a[24:25], v19 offset:4096
  ds_read_b64_tr_b16 a[26:27], v19 offset:4608
  v_mfma_f32_32x32x16_bf16 v[80:95], a[4:7], v[160:163], v[80:95]
  ds_read_b64_tr_b16 a[28:29], v20 offset:4096
  ds_read_b64_tr_b16 a[30:31], v20 offset:4608
  s_waitcnt lgkmcnt(8)
  v_mfma_f32_32x32x16_bf16 v[96:111], a[8:11], v[160:163], v[96:111]
  ds_read_b64_tr_b16 a[0:1], v17 offset:8192
  ds_read_b64_tr_b16 a[2:3], v17 offset:8704
  v_mfma_f32_32x32x16_bf16 v[112:127], a[12:15], v[160:163], v[112:127]
  ds_read_b64_tr_b16 a[4:5], v18 offset:8192
  ds_read_b64_tr_b16 a[6:7], v18 offset:8704
  s_waitcnt lgkmcnt(8)
  v_mfma_f32_32x32x16_bf16 v[64:79], a[16:19], v[164:167], v[64:79]
  ds_read_b64_tr_b16 a[8:9], v19 offset:8192
  ds_read_b64_tr_b16 a[10:11], v19 offset:8704
  v_mfma_f32_32x32x16_bf16 v[80:95], a[20:23], v[164:167], v[80:95]
  ds_read_b64_tr_b16 a[12:13], v20 offset:8192
  ds_read_b64_tr_b16 a[14:15], v20 offset:8704
  s_waitcnt lgkmcnt(8)
  v_mfma_f32_32x32x16_bf16 v[96:111], a[24:27], v[164:167], v[96:111]
  ds_read_b64_tr_b16 a[16:17], v17 offset:12288
  ds_read_b64_tr_b16 a[18:19], v17 offset:12800
  v_mfma_f32_32x32x16_bf16 v[112:127], a[28:31], v[164:167], v[112:127]
  ds_read_b64_tr_b16 a[20:21], v18 offset:12288
  ds_read_b64_tr_b16 a[22:23], v18 offset:12800
  s_waitcnt lgkmcnt(8)
  v_mfma_f32_32x32x16_bf16 v[64:79], a[0:3], v[168:171], v[64:79]
  ds_read_b64_tr_b16 a[24:25], v19 offset:12288
  ds_read_b64_tr_b16 a[26:27], v19 offset:12800
  v_mfma_f32_32x32x16_bf16 v[80:95], a[4:7], v[168:171], v[80:95]
  ds_read_b64_tr_b16 a[28:29], v20 offset:12288
  ds_read_b64_tr_b16 a[30:31], v20 offset:12800
  s_waitcnt lgkmcnt(8)
  v_mfma_f32_32x32x16_bf16 v[96:111], a[8:11], v[168:171], v[96:111]
  s_waitcnt vmcnt(30)
  s_barrier
  v_add_u32 v17, 49152, v13
  v_xor_b32 v18, 32, v17
  v_xor_b32 v19, 64, v17
  v_xor_b32 v20, 96, v17
  ds_read_b64_tr_b16 a[0:1], v17 offset:0
  ds_read_b64_tr_b16 a[2:3], v17 offset:512
  s_add_u32 s3, s65, 1
  s_and_b32 s3, s3, 7
  s_mul_i32 s3, s3, 229376
  s_add_u32 s3, s3, s49
  v_mfma_f32_32x32x16_bf16 v[112:127], a[12:15], v[168:171], v[112:127]
  ds_read_b64_tr_b16 a[4:5], v18 offset:0
  ds_read_b64_tr_b16 a[6:7], v18 offset:512
  s_add_u32 m0, s46, 16384
  s_nop 0
  buffer_load_dwordx4 v2, s[20:23], s3 offen lds
  s_waitcnt lgkmcnt(8)
  v_mfma_f32_32x32x16_bf16 v[64:79], a[16:19], v[172:175], v[64:79]
  ds_read_b64_tr_b16 a[8:9], v19 offset:0
  ds_read_b64_tr_b16 a[10:11], v19 offset:512
  buffer_load_dwordx4 v3, s[20:23], s3 offen offset:1024 lds
  v_mfma_f32_32x32x16_bf16 v[80:95], a[20:23], v[172:175], v[80:95]
  ds_read_b64_tr_b16 a[12:13], v20 offset:0
  ds_read_b64_tr_b16 a[14:15], v20 offset:512
  buffer_load_dwordx4 v4, s[24:27], s3 offen offset:2048 lds
  s_waitcnt lgkmcnt(8)
  v_mfma_f32_32x32x16_bf16 v[96:111], a[24:27], v[172:175], v[96:111]
  ds_read_b64_tr_b16 a[16:17], v17 offset:4096
  ds_read_b64_tr_b16 a[18:19], v17 offset:4608
  buffer_load_dwordx4 v5, s[24:27], s3 offen offset:3072 lds
  v_mfma_f32_32x32x16_bf16 v[112:127], a[28:31], v[172:175], v[112:127]
  ds_read_b64_tr_b16 a[20:21], v18 offset:4096
  ds_read_b64_tr_b16 a[22:23], v18 offset:4608
  s_waitcnt lgkmcnt(8)
  v_mfma_f32_32x32x16_bf16 v[64:79], a[0:3], v[176:179], v[64:79]
  ds_read_b64_tr_b16 a[24:25], v19 offset:4096
  ds_read_b64_tr_b16 a[26:27], v19 offset:4608
  s_waitcnt vmcnt(14)
  v_add_u32 v21, 131072, v16
  v_xor_b32 v22, 64, v21
  ds_read_b64_tr_b16 a[32:33], v21 offset:0
  ds_read_b64_tr_b16 a[34:35], v21 offset:1024
  v_mfma_f32_32x32x16_bf16 v[80:95], a[4:7], v[176:179], v[80:95]
  ds_read_b64_tr_b16 a[28:29], v20 offset:4096
  ds_read_b64_tr_b16 a[30:31], v20 offset:4608
  ds_read_b64_tr_b16 a[36:37], v22 offset:0
  ds_read_b64_tr_b16 a[38:39], v22 offset:1024
  s_waitcnt lgkmcnt(12)
  v_mfma_f32_32x32x16_bf16 v[96:111], a[8:11], v[176:179], v[96:111]
  ds_read_b64_tr_b16 a[0:1], v17 offset:8192
  ds_read_b64_tr_b16 a[2:3], v17 offset:8704
  ds_read_b64_tr_b16 a[40:41], v21 offset:2048
  ds_read_b64_tr_b16 a[42:43], v21 offset:3072
  v_mfma_f32_32x32x16_bf16 v[112:127], a[12:15], v[176:179], v[112:127]
  ds_read_b64_tr_b16 a[4:5], v18 offset:8192
  ds_read_b64_tr_b16 a[6:7], v18 offset:8704
  ds_read_b64_tr_b16 a[44:45], v22 offset:2048
  ds_read_b64_tr_b16 a[46:47], v22 offset:3072
  s_waitcnt lgkmcnt(15)
  v_mfma_f32_32x32x16_bf16 v[64:79], a[16:19], v[180:183], v[64:79]
  ds_read_b64_tr_b16 a[8:9], v19 offset:8192
  ds_read_b64_tr_b16 a[10:11], v19 offset:8704
  v_mfma_f32_32x32x16_bf16 v[80:95], a[20:23], v[180:183], v[80:95]
  ds_read_b64_tr_b16 a[12:13], v20 offset:8192
  ds_read_b64_tr_b16 a[14:15], v20 offset:8704
  s_waitcnt lgkmcnt(4)
  s_add_u32 s4, s51, 327680
  v_mfma_f32_32x32x16_bf16 v[96:111], a[24:27], v[180:183], v[96:111]
  ds_read_b64_tr_b16 a[16:17], v17 offset:12288
  ds_read_b64_tr_b16 a[18:19], v17 offset:12800
  s_add_u32 m0, s46, 131072
  s_nop 0
  buffer_load_dwordx4 v6, s[28:31], s4 offen lds
  v_mfma_f32_32x32x16_bf16 v[112:127], a[28:31], v[180:183], v[112:127]
  ds_read_b64_tr_b16 a[20:21], v18 offset:12288
  ds_read_b64_tr_b16 a[22:23], v18 offset:12800
  buffer_load_dwordx4 v7, s[28:31], s4 offen offset:1024 lds
  v_mfma_f32_32x32x16_bf16 v[64:79], a[0:3], v[184:187], v[64:79]
  ds_read_b64_tr_b16 a[24:25], v19 offset:12288
  ds_read_b64_tr_b16 a[26:27], v19 offset:12800
  buffer_load_dwordx4 v8, s[28:31], s4 offen offset:2048 lds
  v_mfma_f32_32x32x16_bf16 v[80:95], a[4:7], v[184:187], v[80:95]
  ds_read_b64_tr_b16 a[28:29], v20 offset:12288
  ds_read_b64_tr_b16 a[30:31], v20 offset:12800
  buffer_load_dwordx4 v9, s[28:31], s4 offen offset:3072 lds
  v_lshlrev_b32 v60, 6, v30
  v_add_u32 v60, v60, v25
  s_mov_b64 exec, 0xf
  buffer_load_dword v31, v60, s[40:43], 0 offen sc1
  s_mov_b64 exec, -1
  s_waitcnt lgkmcnt(8)
  s_nop 2
  v_mfma_f32_32x32x16_bf16 v[96:111], a[8:11], v[184:187], v[96:111]
  s_barrier
  v_add_u32 v17, 65536, v13
  v_xor_b32 v18, 32, v17
  v_xor_b32 v19, 64, v17
  v_xor_b32 v20, 96, v17
  ds_read_b64_tr_b16 a[0:1], v17 offset:0
  ds_read_b64_tr_b16 a[2:3], v17 offset:512
  s_add_u32 s3, s65, 2
  s_and_b32 s3, s3, 7
  s_mul_i32 s3, s3, 229376
  s_add_u32 s3, s3, s49
  v_mfma_f32_32x32x16_bf16 v[112:127], a[12:15], v[184:187], v[112:127]
  ds_read_b64_tr_b16 a[4:5], v18 offset:0
  ds_read_b64_tr_b16 a[6:7], v18 offset:512
  s_add_u32 m0, s46, 32768
  s_nop 0
  buffer_load_dwordx4 v2, s[20:23], s3 offen lds
  s_waitcnt lgkmcnt(8)
  v_mfma_f32_32x32x16_bf16 v[64:79], a[16:19], v[188:191], v[64:79]
  ds_read_b64_tr_b16 a[8:9], v19 offset:0
  ds_read_b64_tr_b16 a[10:11], v19 offset:512
  buffer_load_dwordx4 v3, s[20:23], s3 offen offset:1024 lds
  v_mfma_f32_32x32x16_bf16 v[80:95], a[20:23], v[188:191], v[80:95]
  ds_read_b64_tr_b16 a[12:13], v20 offset:0
  ds_read_b64_tr_b16 a[14:15], v20 offset:512
  buffer_load_dwordx4 v4, s[24:27], s3 offen offset:2048 lds
  s_waitcnt lgkmcnt(8)
  v_mfma_f32_32x32x16_bf16 v[96:111], a[24:27], v[188:191], v[96:111]
  ds_read_b64_tr_b16 a[16:17], v17 offset:4096
  ds_read_b64_tr_b16 a[18:19], v17 offset:4608
  buffer_load_dwordx4 v5, s[24:27], s3 offen offset:3072 lds
  v_mfma_f32_32x32x16_bf16 v[112:127], a[28:31], v[188:191], v[112:127]
  ds_read_b64_tr_b16 a[20:21], v18 offset:4096
  ds_read_b64_tr_b16 a[22:23], v18 offset:4608
  s_waitcnt lgkmcnt(8)
  v_mfma_f32_32x32x16_bf16 v[64:79], a[0:3], v[192:195], v[64:79]
  ds_read_b64_tr_b16 a[24:25], v19 offset:4096
  ds_read_b64_tr_b16 a[26:27], v19 offset:4608
  s_waitcnt vmcnt(19)
  v_add_u32 v21, 147456, v16
  v_xor_b32 v22, 64, v21
  ds_read_b64_tr_b16 a[48:49], v21 offset:0
  ds_read_b64_tr_b16 a[50:51], v21 offset:1024
  v_mfma_f32_32x32x16_bf16 v[80:95], a[4:7], v[192:195], v[80:95]
  ds_read_b64_tr_b16 a[28:29], v20 offset:4096
  ds_read_b64_tr_b16 a[30:31], v20 offset:4608
  ds_read_b64_tr_b16 a[52:53], v22 offset:0
  ds_read_b64_tr_b16 a[54:55], v22 offset:1024
  s_waitcnt lgkmcnt(12)
  v_mfma_f32_32x32x16_bf16 v[96:111], a[8:11], v[192:195], v[96:111]
  ds_read_b64_tr_b16 a[0:1], v17 offset:8192
  ds_read_b64_tr_b16 a[2:3], v17 offset:8704
  ds_read_b64_tr_b16 a[56:57], v21 offset:2048
  ds_read_b64_tr_b16 a[58:59], v21 offset:3072
  v_mfma_f32_32x32x16_bf16 v[112:127], a[12:15], v[192:195], v[112:127]
  ds_read_b64_tr_b16 a[4:5], v18 offset:8192
  ds_read_b64_tr_b16 a[6:7], v18 offset:8704
  ds_read_b64_tr_b16 a[60:61], v22 offset:2048
  ds_read_b64_tr_b16 a[62:63], v22 offset:3072
  s_waitcnt lgkmcnt(15)
  v_mfma_f32_32x32x16_bf16 v[64:79], a[16:19], v[196:199], v[64:79]
  ds_read_b64_tr_b16 a[8:9], v19 offset:8192
  ds_read_b64_tr_b16 a[10:11], v19 offset:8704
  v_mfma_f32_32x32x16_bf16 v[80:95], a[20:23], v[196:199], v[80:95]
  ds_read_b64_tr_b16 a[12:13], v20 offset:8192
  ds_read_b64_tr_b16 a[14:15], v20 offset:8704
  s_waitcnt lgkmcnt(4)
  s_add_u32 s4, s51, 360448
  v_mfma_f32_32x32x16_bf16 v[96:111], a[24:27], v[196:199], v[96:111]
  ds_read_b64_tr_b16 a[16:17], v17 offset:12288
  ds_read_b64_tr_b16 a[18:19], v17 offset:12800
  s_add_u32 m0, s46, 147456
  s_nop 0
  buffer_load_dwordx4 v6, s[28:31], s4 offen lds
  v_mfma_f32_32x32x16_bf16 v[112:127], a[28:31], v[196:199], v[112:127]
  ds_read_b64_tr_b16 a[20:21], v18 offset:12288
  ds_read_b64_tr_b16 a[22:23], v18 offset:12800
  buffer_load_dwordx4 v7, s[28:31], s4 offen offset:1024 lds
  v_mfma_f32_32x32x16_bf16 v[64:79], a[0:3], v[200:203], v[64:79]
  ds_read_b64_tr_b16 a[24:25], v19 offset:12288
  ds_read_b64_tr_b16 a[26:27], v19 offset:12800
  buffer_load_dwordx4 v8, s[28:31], s4 offen offset:2048 lds
  v_mfma_f32_32x32x16_bf16 v[80:95], a[4:7], v[200:203], v[80:95]
  ds_read_b64_tr_b16 a[28:29], v20 offset:12288
  ds_read_b64_tr_b16 a[30:31], v20 offset:12800
  buffer_load_dwordx4 v9, s[28:31], s4 offen offset:3072 lds
  s_waitcnt lgkmcnt(8)
  v_mfma_f32_32x32x16_bf16 v[96:111], a[8:11], v[200:203], v[96:111]
  s_barrier
  v_add_u32 v17, 81920, v13
  v_xor_b32 v18, 32, v17
  v_xor_b32 v19, 64, v17
  v_xor_b32 v20, 96, v17
  ds_read_b64_tr_b16 a[0:1], v17 offset:0
  ds_read_b64_tr_b16 a[2:3], v17 offset:512
  s_add_u32 s3, s65, 3
  s_and_b32 s3, s3, 7
  s_mul_i32 s3, s3, 229376
  s_add_u32 s3, s3, s49
  v_mfma_f32_32x32x16_bf16 v[112:127], a[12:15], v[200:203], v[112:127]
  ds_read_b64_tr_b16 a[4:5], v18 offset:0
  ds_read_b64_tr_b16 a[6:7], v18 offset:512
  s_add_u32 m0, s46, 49152
  s_nop 0
  buffer_load_dwordx4 v2, s[20:23], s3 offen lds
  s_waitcnt lgkmcnt(8)
  v_mfma_f32_32x32x16_bf16 v[64:79], a[16:19], v[204:207], v[64:79]
  ds_read_b64_tr_b16 a[8:9], v19 offset:0
  ds_read_b64_tr_b16 a[10:11], v19 offset:512
  buffer_load_dwordx4 v3, s[20:23], s3 offen offset:1024 lds
  v_mfma_f32_32x32x16_bf16 v[80:95], a[20:23], v[204:207], v[80:95]
  ds_read_b64_tr_b16 a[12:13], v20 offset:0
  ds_read_b64_tr_b16 a[14:15], v20 offset:512
  buffer_load_dwordx4 v4, s[24:27], s3 offen offset:2048 lds
  s_waitcnt lgkmcnt(8)
  v_mfma_f32_32x32x16_bf16 v[96:111], a[24:27], v[204:207], v[96:111]
  ds_read_b64_tr_b16 a[16:17], v17 offset:4096
  ds_read_b64_tr_b16 a[18:19], v17 offset:4608
  buffer_load_dwordx4 v5, s[24:27], s3 offen offset:3072 lds
  v_mfma_f32_32x32x16_bf16 v[112:127], a[28:31], v[204:207], v[112:127]
  ds_read_b64_tr_b16 a[20:21], v18 offset:4096
  ds_read_b64_tr_b16 a[22:23], v18 offset:4608
  s_waitcnt lgkmcnt(8)
  v_mfma_f32_32x32x16_bf16 v[64:79], a[0:3], v[208:211], v[64:79]
  ds_read_b64_tr_b16 a[24:25], v19 offset:4096
  ds_read_b64_tr_b16 a[26:27], v19 offset:4608
  s_waitcnt vmcnt(13)
  v_add_u32 v21, 131072, v16
  v_xor_b32 v22, 64, v21
  ds_read_b64_tr_b16 a[64:65], v21 offset:0
  ds_read_b64_tr_b16 a[66:67], v21 offset:1024
  v_mfma_f32_32x32x16_bf16 v[80:95], a[4:7], v[208:211], v[80:95]
  ds_read_b64_tr_b16 a[28:29], v20 offset:4096
  ds_read_b64_tr_b16 a[30:31], v20 offset:4608
  ds_read_b64_tr_b16 a[68:69], v22 offset:0
  ds_read_b64_tr_b16 a[70:71], v22 offset:1024
  s_waitcnt lgkmcnt(12)
  v_mfma_f32_32x32x16_bf16 v[96:111], a[8:11], v[208:211], v[96:111]
  ds_read_b64_tr_b16 a[0:1], v17 offset:8192
  ds_read_b64_tr_b16 a[2:3], v17 offset:8704
  ds_read_b64_tr_b16 a[72:73], v21 offset:2048
  ds_read_b64_tr_b16 a[74:75], v21 offset:3072
  v_mfma_f32_32x32x16_bf16 v[112:127], a[12:15], v[208:211], v[112:127]
  ds_read_b64_tr_b16 a[4:5], v18 offset:8192
  ds_read_b64_tr_b16 a[6:7], v18 offset:8704
  ds_read_b64_tr_b16 a[76:77], v22 offset:2048
  ds_read_b64_tr_b16 a[78:79], v22 offset:3072
  s_waitcnt lgkmcnt(15)
  v_mfma_f32_32x32x16_bf16 v[64:79], a[16:19], v[212:215], v[64:79]
  ds_read_b64_tr_b16 a[8:9], v19 offset:8192
  ds_read_b64_tr_b16 a[10:11], v19 offset:8704
  v_mfma_f32_32x32x16_bf16 v[80:95], a[20:23], v[212:215], v[80:95]
  ds_read_b64_tr_b16 a[12:13], v20 offset:8192
  ds_read_b64_tr_b16 a[14:15], v20 offset:8704
  s_waitcnt lgkmcnt(4)
  s_add_u32 s4, s51, 65536
  v_mfma_f32_32x32x16_bf16 v[96:111], a[24:27], v[212:215], v[96:111]
  ds_read_b64_tr_b16 a[16:17], v17 offset:12288
  ds_read_b64_tr_b16 a[18:19], v17 offset:12800
  s_add_u32 m0, s46, 131072
  s_nop 0
  buffer_load_dwordx4 v6, s[28:31], s4 offen lds
  v_mfma_f32_32x32x16_bf16 v[112:127], a[28:31], v[212:215], v[112:127]
  ds_read_b64_tr_b16 a[20:21], v18 offset:12288
  ds_read_b64_tr_b16 a[22:23], v18 offset:12800
  buffer_load_dwordx4 v7, s[28:31], s4 offen offset:1024 lds
  v_mfma_f32_32x32x16_bf16 v[64:79], a[0:3], v[216:219], v[64:79]
  ds_read_b64_tr_b16 a[24:25], v19 offset:12288
  ds_read_b64_tr_b16 a[26:27], v19 offset:12800
  buffer_load_dwordx4 v8, s[28:31], s4 offen offset:2048 lds
  v_mfma_f32_32x32x16_bf16 v[80:95], a[4:7], v[216:219], v[80:95]
  ds_read_b64_tr_b16 a[28:29], v20 offset:12288
  ds_read_b64_tr_b16 a[30:31], v20 offset:12800
  buffer_load_dwordx4 v9, s[28:31], s4 offen offset:3072 lds
  s_waitcnt lgkmcnt(8)
  v_mfma_f32_32x32x16_bf16 v[96:111], a[8:11], v[216:219], v[96:111]
  s_barrier
  v_add_u32 v17, 98304, v13
  v_xor_b32 v18, 32, v17
  v_xor_b32 v19, 64, v17
  v_xor_b32 v20, 96, v17
  ds_read_b64_tr_b16 a[0:1], v17 offset:0
  ds_read_b64_tr_b16 a[2:3], v17 offset:512
  s_add_u32 s3, s65, 4
  s_and_b32 s3, s3, 7
  s_mul_i32 s3, s3, 229376
  s_add_u32 s3, s3, s49
  v_mfma_f32_32x32x16_bf16 v[112:127], a[12:15], v[216:219], v[112:127]
  ds_read_b64_tr_b16 a[4:5], v18 offset:0
  ds_read_b64_tr_b16 a[6:7], v18 offset:512
  s_add_u32 m0, s46, 65536
  s_nop 0
  buffer_load_dwordx4 v2, s[20:23], s3 offen lds
  s_waitcnt lgkmcnt(8)
  v_mfma_f32_32x32x16_bf16 v[64:79], a[16:19], v[220:223], v[64:79]
  ds_read_b64_tr_b16 a[8:9], v19 offset:0
  ds_read_b64_tr_b16 a[10:11], v19 offset:512
  buffer_load_dwordx4 v3, s[20:23], s3 offen offset:1024 lds
  v_mfma_f32_32x32x16_bf16 v[80:95], a[20:23], v[220:223], v[80:95]
  ds_read_b64_tr_b16 a[12:13], v20 offset:0
  ds_read_b64_tr_b16 a[14:15], v20 offset:512
  buffer_load_dwordx4 v4, s[24:27], s3 offen offset:2048 lds
  s_waitcnt lgkmcnt(8)
  v_mfma_f32_32x32x16_bf16 v[96:111], a[24:27], v[220:223], v[96:111]
  ds_read_b64_tr_b16 a[16:17], v17 offset:4096
  ds_read_b64_tr_b16 a[18:19], v17 offset:4608
  buffer_load_dwordx4 v5, s[24:27], s3 offen offset:3072 lds
  v_mfma_f32_32x32x16_bf16 v[112:127], a[28:31], v[220:223], v[112:127]
  ds_read_b64_tr_b16 a[20:21], v18 offset:4096
  ds_read_b64_tr_b16 a[22:23], v18 offset:4608
  s_waitcnt lgkmcnt(8)
  v_mfma_f32_32x32x16_bf16 v[64:79], a[0:3], v[224:227], v[64:79]
  ds_read_b64_tr_b16 a[24:25], v19 offset:4096
  ds_read_b64_tr_b16 a[26:27], v19 offset:4608
  s_waitcnt vmcnt(12)
  v_add_u32 v21, 147456, v16
  v_xor_b32 v22, 64, v21
  ds_read_b64_tr_b16 a[80:81], v21 offset:0
  ds_read_b64_tr_b16 a[82:83], v21 offset:1024
  v_mfma_f32_32x32x16_bf16 v[80:95], a[4:7], v[224:227], v[80:95]
  ds_read_b64_tr_b16 a[28:29], v20 offset:4096
  ds_read_b64_tr_b16 a[30:31], v20 offset:4608
  ds_read_b64_tr_b16 a[84:85], v22 offset:0
  ds_read_b64_tr_b16 a[86:87], v22 offset:1024
  s_waitcnt lgkmcnt(12)
  v_mfma_f32_32x32x16_bf16 v[96:111], a[8:11], v[224:227], v[96:111]
  ds_read_b64_tr_b16 a[0:1], v17 offset:8192
  ds_read_b64_tr_b16 a[2:3], v17 offset:8704
  ds_read_b64_tr_b16 a[88:89], v21 offset:2048
  ds_read_b64_tr_b16 a[90:91], v21 offset:3072
  v_mfma_f32_32x32x16_bf16 v[112:127], a[12:15], v[224:227], v[112:127]
  ds_read_b64_tr_b16 a[4:5], v18 offset:8192
  ds_read_b64_tr_b16 a[6:7], v18 offset:8704
  ds_read_b64_tr_b16 a[92:93], v22 offset:2048
  ds_read_b64_tr_b16 a[94:95], v22 offset:3072
  s_waitcnt lgkmcnt(15)
  v_mfma_f32_32x32x16_bf16 v[64:79], a[16:19], v[228:231], v[64:79]
  ds_read_b64_tr_b16 a[8:9], v19 offset:8192
  ds_read_b64_tr_b16 a[10:11], v19 offset:8704
  v_mfma_f32_32x32x16_bf16 v[80:95], a[20:23], v[228:231], v[80:95]
  ds_read_b64_tr_b16 a[12:13], v20 offset:8192
  ds_read_b64_tr_b16 a[14:15], v20 offset:8704
  s_waitcnt lgkmcnt(4)
  s_add_u32 s4, s51, 98304
  v_mfma_f32_32x32x16_bf16 v[96:111], a[24:27], v[228:231], v[96:111]
  ds_read_b64_tr_b16 a[16:17], v17 offset:12288
  ds_read_b64_tr_b16 a[18:19], v17 offset:12800
  s_add_u32 m0, s46, 147456
  s_nop 0
  buffer_load_dwordx4 v6, s[28:31], s4 offen lds
  v_mfma_f32_32x32x16_bf16 v[112:127], a[28:31], v[228:231], v[112:127]
  ds_read_b64_tr_b16 a[20:21], v18 offset:12288
  ds_read_b64_tr_b16 a[22:23], v18 offset:12800
  buffer_load_dwordx4 v7, s[28:31], s4 offen offset:1024 lds
  v_mfma_f32_32x32x16_bf16 v[64:79], a[0:3], v[232:235], v[64:79]
  ds_read_b64_tr_b16 a[24:25], v19 offset:12288
  ds_read_b64_tr_b16 a[26:27], v19 offset:12800
  buffer_load_dwordx4 v8, s[28:31], s4 offen offset:2048 lds
  v_mfma_f32_32x32x16_bf16 v[80:95], a[4:7], v[232:235], v[80:95]
  ds_read_b64_tr_b16 a[28:29], v20 offset:12288
  ds_read_b64_tr_b16 a[30:31], v20 offset:12800
  buffer_load_dwordx4 v9, s[28:31], s4 offen offset:3072 lds
  s_cmp_eq_u32 s45, 0
  s_cselect_b32 s44, 64, 0
  s_mov_b64 exec, 0xf
  v_cmp_le_u32 vcc, s44, v31
  s_mov_b64 exec, -1
  s_nop 2
  s_cmp_eq_u64 vcc, 0xf
  s_cbranch_scc0 L_Q_slow_1
L_Q_pback_2:
  s_waitcnt lgkmcnt(8)
  v_mfma_f32_32x32x16_bf16 v[96:111], a[8:11], v[232:235], v[96:111]
  s_barrier
  v_add_u32 v17, 114688, v13
  v_xor_b32 v18, 32, v17
  v_xor_b32 v19, 64, v17
  v_xor_b32 v20, 96, v17
  ds_read_b64_tr_b16 a[0:1], v17 offset:0
  ds_read_b64_tr_b16 a[2:3], v17 offset:512
  s_add_u32 s3, s65, 5
  s_and_b32 s3, s3, 7
  s_mul_i32 s3, s3, 229376
  s_add_u32 s3, s3, s49
  v_mfma_f32_32x32x16_bf16 v[112:127], a[12:15], v[232:235], v[112:127]
  ds_read_b64_tr_b16 a[4:5], v18 offset:0
  ds_read_b64_tr_b16 a[6:7], v18 offset:512
  s_add_u32 m0, s46, 81920
  s_nop 0
  buffer_load_dwordx4 v2, s[20:23], s3 offen lds
  s_waitcnt lgkmcnt(8)
  v_mfma_f32_32x32x16_bf16 v[64:79], a[16:19], v[236:239], v[64:79]
  ds_read_b64_tr_b16 a[8:9], v19 offset:0
  ds_read_b64_tr_b16 a[10:11], v19 offset:512
  buffer_load_dwordx4 v3, s[20:23], s3 offen offset:1024 lds
  v_mfma_f32_32x32x16_bf16 v[80:95], a[20:23], v[236:239], v[80:95]
  ds_read_b64_tr_b16 a[12:13], v20 offset:0
  ds_read_b64_tr_b16 a[14:15], v20 offset:512
  buffer_load_dwordx4 v4, s[24:27], s3 offen offset:2048 lds
  s_waitcnt lgkmcnt(8)
  v_mfma_f32_32x32x16_bf16 v[96:111], a[24:27], v[236:239], v[96:111]
  ds_read_b64_tr_b16 a[16:17], v17 offset:4096
  ds_read_b64_tr_b16 a[18:19], v17 offset:4608
  buffer_load_dwordx4 v5, s[24:27], s3 offen offset:3072 lds
  v_mfma_f32_32x32x16_bf16 v[112:127], a[28:31], v[236:239], v[112:127]
  ds_read_b64_tr_b16 a[20:21], v18 offset:4096
  ds_read_b64_tr_b16 a[22:23], v18 offset:4608
  s_waitcnt lgkmcnt(8)
  v_mfma_f32_32x32x16_bf16 v[64:79], a[0:3], v[240:243], v[64:79]
  ds_read_b64_tr_b16 a[24:25], v19 offset:4096
  ds_read_b64_tr_b16 a[26:27], v19 offset:4608
  s_waitcnt vmcnt(12)
  v_add_u32 v21, 131072, v16
  v_xor_b32 v22, 64, v21
  ds_read_b64_tr_b16 a[96:97], v21 offset:0
  ds_read_b64_tr_b16 a[98:99], v21 offset:1024
  v_mfma_f32_32x32x16_bf16 v[80:95], a[4:7], v[240:243], v[80:95]
  ds_read_b64_tr_b16 a[28:29], v20 offset:4096
  ds_read_b64_tr_b16 a[30:31], v20 offset:4608
  ds_read_b64_tr_b16 a[100:101], v22 offset:0
  ds_read_b64_tr_b16 a[102:103], v22 offset:1024
  s_waitcnt lgkmcnt(12)
  v_mfma_f32_32x32x16_bf16 v[96:111], a[8:11], v[240:243], v[96:111]
  ds_read_b64_tr_b16 a[0:1], v17 offset:8192
  ds_read_b64_tr_b16 a[2:3], v17 offset:8704
  ds_read_b64_tr_b16 a[104:105], v21 offset:2048
  ds_read_b64_tr_b16 a[106:107], v21 offset:3072
  v_mfma_f32_32x32x16_bf16 v[112:127], a[12:15], v[240:243], v[112:127]
  ds_read_b64_tr_b16 a[4:5], v18 offset:8192
  ds_read_b64_tr_b16 a[6:7], v18 offset:8704
  ds_read_b64_tr_b16 a[108:109], v22 offset:2048
  ds_read_b64_tr_b16 a[110:111], v22 offset:3072
  s_waitcnt lgkmcnt(15)
  v_mfma_f32_32x32x16_bf16 v[64:79], a[16:19], v[244:247], v[64:79]
  ds_read_b64_tr_b16 a[8:9], v19 offset:8192
  ds_read_b64_tr_b16 a[10:11], v19 offset:8704
  v_mfma_f32_32x32x16_bf16 v[80:95], a[20:23], v[244:247], v[80:95]
  ds_read_b64_tr_b16 a[12:13], v20 offset:8192
  ds_read_b64_tr_b16 a[14:15], v20 offset:8704
  s_waitcnt lgkmcnt(4)
  s_add_u32 s4, s51, 393216
  v_mfma_f32_32x32x16_bf16 v[96:111], a[24:27], v[244:247], v[96:111]
  ds_read_b64_tr_b16 a[16:17], v17 offset:12288
  ds_read_b64_tr_b16 a[18:19], v17 offset:12800
  s_add_u32 m0, s46, 131072
  s_nop 0
  buffer_load_dwordx4 v6, s[28:31], s4 offen lds
  v_mfma_f32_32x32x16_bf16 v[112:127], a[28:31], v[244:247], v[112:127]
  ds_read_b64_tr_b16 a[20:21], v18 offset:12288
  ds_read_b64_tr_b16 a[22:23], v18 offset:12800
  buffer_load_dwordx4 v7, s[28:31], s4 offen offset:1024 lds
  v_mfma_f32_32x32x16_bf16 v[64:79], a[0:3], v[248:251], v[64:79]
  ds_read_b64_tr_b16 a[24:25], v19 offset:12288
  ds_read_b64_tr_b16 a[26:27], v19 offset:12800
  buffer_load_dwordx4 v8, s[28:31], s4 offen offset:2048 lds
  v_mfma_f32_32x32x16_bf16 v[80:95], a[4:7], v[248:251], v[80:95]
  ds_read_b64_tr_b16 a[28:29], v20 offset:12288
  ds_read_b64_tr_b16 a[30:31], v20 offset:12800
  buffer_load_dwordx4 v9, s[28:31], s4 offen offset:3072 lds
  s_waitcnt lgkmcnt(8)
  v_mfma_f32_32x32x16_bf16 v[96:111], a[8:11], v[248:251], v[96:111]
  s_barrier
  v_add_u32 v17, 0, v13
  v_xor_b32 v18, 32, v17
  v_xor_b32 v19, 64, v17
  v_xor_b32 v20, 96, v17
  ds_read_b64_tr_b16 a[0:1], v17 offset:0
  ds_read_b64_tr_b16 a[2:3], v17 offset:512
  s_add_u32 s3, s65, 6
  s_and_b32 s3, s3, 7
  s_mul_i32 s3, s3, 229376
  s_add_u32 s3, s3, s49
  v_mfma_f32_32x32x16_bf16 v[112:127], a[12:15], v[248:251], v[112:127]
  ds_read_b64_tr_b16 a[4:5], v18 offset:0
  ds_read_b64_tr_b16 a[6:7], v18 offset:512
  s_add_u32 m0, s46, 98304
  s_nop 0
  buffer_load_dwordx4 v2, s[20:23], s3 offen lds
  s_waitcnt lgkmcnt(8)
  v_mfma_f32_32x32x16_bf16 v[64:79], a[16:19], v[252:255], v[64:79]
  ds_read_b64_tr_b16 a[8:9], v19 offset:0
  ds_read_b64_tr_b16 a[10:11], v19 offset:512
  buffer_load_dwordx4 v3, s[20:23], s3 offen offset:1024 lds
  v_mfma_f32_32x32x16_bf16 v[80:95], a[20:23], v[252:255], v[80:95]
  ds_read_b64_tr_b16 a[12:13], v20 offset:0
  ds_read_b64_tr_b16 a[14:15], v20 offset:512
  buffer_load_dwordx4 v4, s[24:27], s3 offen offset:2048 lds
  s_waitcnt lgkmcnt(8)
  v_mfma_f32_32x32x16_bf16 v[96:111], a[24:27], v[252:255], v[96:111]
  ds_read_b64_tr_b16 a[16:17], v17 offset:4096
  ds_read_b64_tr_b16 a[18:19], v17 offset:4608
  buffer_load_dwordx4 v5, s[24:27], s3 offen offset:3072 lds
  v_mfma_f32_32x32x16_bf16 v[112:127], a[28:31], v[252:255], v[112:127]
  ds_read_b64_tr_b16 a[20:21], v18 offset:4096
  ds_read_b64_tr_b16 a[22:23], v18 offset:4608
  v_pk_mul_f32 v[48:49], v[64:65], v[72:73]
  v_pk_mul_f32 v[50:51], v[66:67], v[74:75]
  v_pk_mul_f32 v[52:53], v[68:69], v[76:77]
  v_pk_mul_f32 v[54:55], v[70:71], v[78:79]
  v_cvt_pk_bf16_f32 v32, v48, v49
  v_cvt_pk_bf16_f32 v33, v50, v51
  v_cvt_pk_bf16_f32 v34, v52, v53
  v_cvt_pk_bf16_f32 v35, v54, v55
  buffer_store_dwordx4 v[32:35], v1, s[36:39], s54 offen sc1
  v_pk_mul_f32 v[48:49], v[80:81], v[88:89]
  v_pk_mul_f32 v[50:51], v[82:83], v[90:91]
  v_pk_mul_f32 v[52:53], v[84:85], v[92:93]
  v_pk_mul_f32 v[54:55], v[86:87], v[94:95]
  v_cvt_pk_bf16_f32 v36, v48, v49
  v_cvt_pk_bf16_f32 v37, v50, v51
  v_cvt_pk_bf16_f32 v38, v52, v53
  v_cvt_pk_bf16_f32 v39, v54, v55
  buffer_store_dwordx4 v[36:39], v1, s[36:39], s54 offen offset:2048 sc1
  v_pk_mul_f32 v[48:49], v[96:97], v[104:105]
  v_pk_mul_f32 v[50:51], v[98:99], v[106:107]
  v_pk_mul_f32 v[52:53], v[100:101], v[108:109]
  v_pk_mul_f32 v[54:55], v[102:103], v[110:111]
  v_cvt_pk_bf16_f32 v40, v48, v49
  v_cvt_pk_bf16_f32 v41, v50, v51
  v_cvt_pk_bf16_f32 v42, v52, v53
  v_cvt_pk_bf16_f32 v43, v54, v55
  s_add_u32 s7, s54, 4096
  buffer_store_dwordx4 v[40:43], v1, s[36:39], s7 offen sc1
  v_pk_mul_f32 v[48:49], v[112:113], v[120:121]
  v_pk_mul_f32 v[50:51], v[114:115], v[122:123]
  v_pk_mul_f32 v[52:53], v[116:117], v[124:125]
  v_pk_mul_f32 v[54:55], v[118:119], v[126:127]
  v_cvt_pk_bf16_f32 v44, v48, v49
  v_cvt_pk_bf16_f32 v45, v50, v51
  v_cvt_pk_bf16_f32 v46, v52, v53
  v_cvt_pk_bf16_f32 v47, v54, v55
  buffer_store_dwordx4 v[44:47], v1, s[36:39], s7 offen offset:2048 sc1
  v_bitop3_b32 v26, v32, v33, s72 bitop3:0x96
  v_bitop3_b32 v26, v34, v35, v26 bitop3:0x96
  v_bitop3_b32 v26, v36, v37, v26 bitop3:0x96
  v_bitop3_b32 v26, v38, v39, v26 bitop3:0x96
  v_bitop3_b32 v26, v40, v41, v26 bitop3:0x96
  v_bitop3_b32 v26, v42, v43, v26 bitop3:0x96
  v_bitop3_b32 v26, v44, v45, v26 bitop3:0x96
  v_bitop3_b32 v26, v46, v47, v26 bitop3:0x96
  s_sub_u32 s6, s54, s53
  s_lshr_b32 s6, s6, 2
  s_add_u32 s6, s6, s73
  buffer_store_dword v26, v0, s[36:39], s6 offen sc1
  s_waitcnt lgkmcnt(8)
  v_mfma_f32_32x32x16_bf16 v[64:79], a[0:3], v[128:131], 0
  ds_read_b64_tr_b16 a[24:25], v19 offset:4096
  ds_read_b64_tr_b16 a[26:27], v19 offset:4608
  s_waitcnt vmcnt(17)
  v_add_u32 v21, 147456, v16
  v_xor_b32 v22, 64, v21
  ds_read_b64_tr_b16 a[112:113], v21 offset:0
  ds_read_b64_tr_b16 a[114:115], v21 offset:1024
  v_mfma_f32_32x32x16_bf16 v[80:95], a[4:7], v[128:131], 0
  ds_read_b64_tr_b16 a[28:29], v20 offset:4096
  ds_read_b64_tr_b16 a[30:31], v20 offset:4608
  ds_read_b64_tr_b16 a[116:117], v22 offset:0
  ds_read_b64_tr_b16 a[118:119], v22 offset:1024
  s_waitcnt lgkmcnt(12)
  v_mfma_f32_32x32x16_bf16 v[96:111], a[8:11], v[128:131], 0
  ds_read_b64_tr_b16 a[0:1], v17 offset:8192
  ds_read_b64_tr_b16 a[2:3], v17 offset:8704
  ds_read_b64_tr_b16 a[120:121], v21 offset:2048
  ds_read_b64_tr_b16 a[122:123], v21 offset:3072
  v_mfma_f32_32x32x16_bf16 v[112:127], a[12:15], v[128:131], 0
  ds_read_b64_tr_b16 a[4:5], v18 offset:8192
  ds_read_b64_tr_b16 a[6:7], v18 offset:8704
  ds_read_b64_tr_b16 a[124:125], v22 offset:2048
  ds_read_b64_tr_b16 a[126:127], v22 offset:3072
  s_waitcnt lgkmcnt(15)
  v_mfma_f32_32x32x16_bf16 v[64:79], a[16:19], v[132:135], v[64:79]
  ds_read_b64_tr_b16 a[8:9], v19 offset:8192
  ds_read_b64_tr_b16 a[10:11], v19 offset:8704
  v_mfma_f32_32x32x16_bf16 v[80:95], a[20:23], v[132:135], v[80:95]
  ds_read_b64_tr_b16 a[12:13], v20 offset:8192
  ds_read_b64_tr_b16 a[14:15], v20 offset:8704
  s_waitcnt lgkmcnt(4)
  s_add_u32 s4, s51, 425984
  v_mfma_f32_32x32x16_bf16 v[96:111], a[24:27], v[132:135], v[96:111]
  ds_read_b64_tr_b16 a[16:17], v17 offset:12288
  ds_read_b64_tr_b16 a[18:19], v17 offset:12800
  s_add_u32 m0, s46, 147456
  s_nop 0
  buffer_load_dwordx4 v6, s[28:31], s4 offen lds
  v_mfma_f32_32x32x16_bf16 v[112:127], a[28:31], v[132:135], v[112:127]
  ds_read_b64_tr_b16 a[20:21], v18 offset:12288
  ds_read_b64_tr_b16 a[22:23], v18 offset:12800
  buffer_load_dwordx4 v7, s[28:31], s4 offen offset:1024 lds
  v_mfma_f32_32x32x16_bf16 v[64:79], a[0:3], v[136:139], v[64:79]
  ds_read_b64_tr_b16 a[24:25], v19 offset:12288
  ds_read_b64_tr_b16 a[26:27], v19 offset:12800
  buffer_load_dwordx4 v8, s[28:31], s4 offen offset:2048 lds
  v_mfma_f32_32x32x16_bf16 v[80:95], a[4:7], v[136:139], v[80:95]
  ds_read_b64_tr_b16 a[28:29], v20 offset:12288
  ds_read_b64_tr_b16 a[30:31], v20 offset:12800
  buffer_load_dwordx4 v9, s[28:31], s4 offen offset:3072 lds
  s_waitcnt lgkmcnt(8)
  v_mfma_f32_32x32x16_bf16 v[96:111], a[8:11], v[136:139], v[96:111]
  s_barrier
  v_add_u32 v17, 16384, v13
  v_xor_b32 v18, 32, v17
  v_xor_b32 v19, 64, v17
  v_xor_b32 v20, 96, v17
  ds_read_b64_tr_b16 a[0:1], v17 offset:0
  ds_read_b64_tr_b16 a[2:3], v17 offset:512
  s_add_u32 s3, s65, 7
  s_and_b32 s3, s3, 7
  s_mul_i32 s3, s3, 229376
  s_add_u32 s3, s3, s49
  v_mfma_f32_32x32x16_bf16 v[112:127], a[12:15], v[136:139], v[112:127]
  ds_read_b64_tr_b16 a[4:5], v18 offset:0
  ds_read_b64_tr_b16 a[6:7], v18 offset:512
  s_add_u32 m0, s46, 114688
  s_nop 0
  buffer_load_dwordx4 v2, s[20:23], s3 offen lds
  s_waitcnt lgkmcnt(8)
  v_mfma_f32_32x32x16_bf16 v[64:79], a[16:19], v[140:143], v[64:79]
  ds_read_b64_tr_b16 a[8:9], v19 offset:0
  ds_read_b64_tr_b16 a[10:11], v19 offset:512
  buffer_load_dwordx4 v3, s[20:23], s3 offen offset:1024 lds
  v_mfma_f32_32x32x16_bf16 v[80:95], a[20:23], v[140:143], v[80:95]
  ds_read_b64_tr_b16 a[12:13], v20 offset:0
  ds_read_b64_tr_b16 a[14:15], v20 offset:512
  buffer_load_dwordx4 v4, s[24:27], s3 offen offset:2048 lds
  s_waitcnt lgkmcnt(8)
  v_mfma_f32_32x32x16_bf16 v[96:111], a[24:27], v[140:143], v[96:111]
  ds_read_b64_tr_b16 a[16:17], v17 offset:4096
  ds_read_b64_tr_b16 a[18:19], v17 offset:4608
  buffer_load_dwordx4 v5, s[24:27], s3 offen offset:3072 lds
  v_mfma_f32_32x32x16_bf16 v[112:127], a[28:31], v[140:143], v[112:127]
  ds_read_b64_tr_b16 a[20:21], v18 offset:4096
  ds_read_b64_tr_b16 a[22:23], v18 offset:4608
  s_waitcnt lgkmcnt(8)
  v_mfma_f32_32x32x16_bf16 v[64:79], a[0:3], v[144:147], v[64:79]
  ds_read_b64_tr_b16 a[24:25], v19 offset:4096
  ds_read_b64_tr_b16 a[26:27], v19 offset:4608
  s_waitcnt vmcnt(17)
  v_add_u32 v21, 131072, v16
  v_xor_b32 v22, 64, v21
  ds_read_b64_tr_b16 a[128:129], v21 offset:0
  ds_read_b64_tr_b16 a[130:131], v21 offset:1024
  v_mfma_f32_32x32x16_bf16 v[80:95], a[4:7], v[144:147], v[80:95]
  ds_read_b64_tr_b16 a[28:29], v20 offset:4096
  ds_read_b64_tr_b16 a[30:31], v20 offset:4608
  ds_read_b64_tr_b16 a[132:133], v22 offset:0
  ds_read_b64_tr_b16 a[134:135], v22 offset:1024
  s_waitcnt lgkmcnt(12)
  v_mfma_f32_32x32x16_bf16 v[96:111], a[8:11], v[144:147], v[96:111]
  ds_read_b64_tr_b16 a[0:1], v17 offset:8192
  ds_read_b64_tr_b16 a[2:3], v17 offset:8704
  ds_read_b64_tr_b16 a[136:137], v21 offset:2048
  ds_read_b64_tr_b16 a[138:139], v21 offset:3072
  v_mfma_f32_32x32x16_bf16 v[112:127], a[12:15], v[144:147], v[112:127]
  ds_read_b64_tr_b16 a[4:5], v18 offset:8192
  ds_read_b64_tr_b16 a[6:7], v18 offset:8704
  ds_read_b64_tr_b16 a[140:141], v22 offset:2048
  ds_read_b64_tr_b16 a[142:143], v22 offset:3072
  s_waitcnt lgkmcnt(15)
  v_mfma_f32_32x32x16_bf16 v[64:79], a[16:19], v[148:151], v[64:79]
  ds_read_b64_tr_b16 a[8:9], v19 offset:8192
  ds_read_b64_tr_b16 a[10:11], v19 offset:8704
  v_mfma_f32_32x32x16_bf16 v[80:95], a[20:23], v[148:151], v[80:95]
  ds_read_b64_tr_b16 a[12:13], v20 offset:8192
  ds_read_b64_tr_b16 a[14:15], v20 offset:8704
  s_waitcnt lgkmcnt(4)
  s_add_u32 s4, s51, 131072
  v_mfma_f32_32x32x16_bf16 v[96:111], a[24:27], v[148:151], v[96:111]
  ds_read_b64_tr_b16 a[16:17], v17 offset:12288
  ds_read_b64_tr_b16 a[18:19], v17 offset:12800
  s_add_u32 m0, s46, 131072
  s_nop 0
  buffer_load_dwordx4 v6, s[28:31], s4 offen lds
  v_mfma_f32_32x32x16_bf16 v[112:127], a[28:31], v[148:151], v[112:127]
  ds_read_b64_tr_b16 a[20:21], v18 offset:12288
  ds_read_b64_tr_b16 a[22:23], v18 offset:12800
  buffer_load_dwordx4 v7, s[28:31], s4 offen offset:1024 lds
  v_mfma_f32_32x32x16_bf16 v[64:79], a[0:3], v[152:155], v[64:79]
  ds_read_b64_tr_b16 a[24:25], v19 offset:12288
  ds_read_b64_tr_b16 a[26:27], v19 offset:12800
  buffer_load_dwordx4 v8, s[28:31], s4 offen offset:2048 lds
  v_mfma_f32_32x32x16_bf16 v[80:95], a[4:7], v[152:155], v[80:95]
  ds_read_b64_tr_b16 a[28:29], v20 offset:12288
  ds_read_b64_tr_b16 a[30:31], v20 offset:12800
  buffer_load_dwordx4 v9, s[28:31], s4 offen offset:3072 lds
  v_lshrrev_b32 v60, 2, v30
  v_lshlrev_b32 v60, 7, v60
  v_and_b32 v59, 3, v30
  v_lshl_add_u32 v60, v59, 2, v60
  s_lshl_b32 s6, s62, 8
  s_lshl_b32 s7, s45, 4
  s_add_u32 s6, s6, s7
  s_add_u32 s6, s6, 10552320
  s_mov_b64 exec, 0xff
  buffer_load_dword v58, v60, s[36:39], s6 offen sc1
  s_mov_b64 exec, -1
  s_waitcnt lgkmcnt(8)
  s_nop 2
  v_mfma_f32_32x32x16_bf16 v[96:111], a[8:11], v[152:155], v[96:111]
  s_barrier
  v_add_u32 v17, 32768, v13
  v_xor_b32 v18, 32, v17
  v_xor_b32 v19, 64, v17
  v_xor_b32 v20, 96, v17
  ds_read_b64_tr_b16 a[0:1], v17 offset:0
  ds_read_b64_tr_b16 a[2:3], v17 offset:512
  v_add_u32 v2, 4096, v11
  v_add_u32 v3, 27648, v11
  v_add_u32 v4, 51200, v11
  v_add_u32 v5, 74752, v11
  s_add_u32 s3, s66, 0
  s_and_b32 s3, s3, 3
  s_mul_i32 s3, s3, 393216
  s_add_u32 s3, s3, s50
  v_mfma_f32_32x32x16_bf16 v[112:127], a[12:15], v[152:155], v[112:127]
  ds_read_b64_tr_b16 a[4:5], v18 offset:0
  ds_read_b64_tr_b16 a[6:7], v18 offset:512
  s_add_u32 m0, s46, 0
  s_nop 0
  buffer_load_dwordx4 v2, s[12:15], s3 offen lds
  s_waitcnt lgkmcnt(8)
  v_mfma_f32_32x32x16_bf16 v[64:79], a[16:19], v[156:159], v[64:79]
  ds_read_b64_tr_b16 a[8:9], v19 offset:0
  ds_read_b64_tr_b16 a[10:11], v19 offset:512
  buffer_load_dwordx4 v3, s[12:15], s3 offen offset:1024 lds
  v_mfma_f32_32x32x16_bf16 v[80:95], a[20:23], v[156:159], v[80:95]
  ds_read_b64_tr_b16 a[12:13], v20 offset:0
  ds_read_b64_tr_b16 a[14:15], v20 offset:512
  buffer_load_dwordx4 v4, s[12:15], s3 offen offset:2048 lds
  s_waitcnt lgkmcnt(8)
  v_mfma_f32_32x32x16_bf16 v[96:111], a[24:27], v[156:159], v[96:111]
  ds_read_b64_tr_b16 a[16:17], v17 offset:4096
  ds_read_b64_tr_b16 a[18:19], v17 offset:4608
  buffer_load_dwordx4 v5, s[12:15], s3 offen offset:3072 lds
  v_mfma_f32_32x32x16_bf16 v[112:127], a[28:31], v[156:159], v[112:127]
  ds_read_b64_tr_b16 a[20:21], v18 offset:4096
  ds_read_b64_tr_b16 a[22:23], v18 offset:4608
  s_waitcnt lgkmcnt(8)
  v_mfma_f32_32x32x16_bf16 v[64:79], a[0:3], v[160:163], v[64:79]
  ds_read_b64_tr_b16 a[24:25], v19 offset:4096
  ds_read_b64_tr_b16 a[26:27], v19 offset:4608
  s_waitcnt vmcnt(13)
  v_add_u32 v21, 147456, v16
  v_xor_b32 v22, 64, v21
  ds_read_b64_tr_b16 a[144:145], v21 offset:0
  ds_read_b64_tr_b16 a[146:147], v21 offset:1024
  v_mfma_f32_32x32x16_bf16 v[80:95], a[4:7], v[160:163], v[80:95]
  ds_read_b64_tr_b16 a[28:29], v20 offset:4096
  ds_read_b64_tr_b16 a[30:31], v20 offset:4608
  ds_read_b64_tr_b16 a[148:149], v22 offset:0
  ds_read_b64_tr_b16 a[150:151], v22 offset:1024
  s_waitcnt lgkmcnt(12)
  v_mfma_f32_32x32x16_bf16 v[96:111], a[8:11], v[160:163], v[96:111]
  ds_read_b64_tr_b16 a[0:1], v17 offset:8192
  ds_read_b64_tr_b16 a[2:3], v17 offset:8704
  ds_read_b64_tr_b16 a[152:153], v21 offset:2048
  ds_read_b64_tr_b16 a[154:155], v21 offset:3072
  v_mfma_f32_32x32x16_bf16 v[112:127], a[12:15], v[160:163], v[112:127]
  ds_read_b64_tr_b16 a[4:5], v18 offset:8192
  ds_read_b64_tr_b16 a[6:7], v18 offset:8704
  ds_read_b64_tr_b16 a[156:157], v22 offset:2048
  ds_read_b64_tr_b16 a[158:159], v22 offset:3072
  s_waitcnt lgkmcnt(15)
  v_mfma_f32_32x32x16_bf16 v[64:79], a[16:19], v[164:167], v[64:79]
  ds_read_b64_tr_b16 a[8:9], v19 offset:8192
  ds_read_b64_tr_b16 a[10:11], v19 offset:8704
  v_mfma_f32_32x32x16_bf16 v[80:95], a[20:23], v[164:167], v[80:95]
  ds_read_b64_tr_b16 a[12:13], v20 offset:8192
  ds_read_b64_tr_b16 a[14:15], v20 offset:8704
  s_waitcnt lgkmcnt(4)
  s_add_u32 s4, s51, 163840
  v_mfma_f32_32x32x16_bf16 v[96:111], a[24:27], v[164:167], v[96:111]
  ds_read_b64_tr_b16 a[16:17], v17 offset:12288
  ds_read_b64_tr_b16 a[18:19], v17 offset:12800
  s_add_u32 m0, s46, 147456
  s_nop 0
  buffer_load_dwordx4 v6, s[28:31], s4 offen lds
  v_mfma_f32_32x32x16_bf16 v[112:127], a[28:31], v[164:167], v[112:127]
  ds_read_b64_tr_b16 a[20:21], v18 offset:12288
  ds_read_b64_tr_b16 a[22:23], v18 offset:12800
  buffer_load_dwordx4 v7, s[28:31], s4 offen offset:1024 lds
  v_mfma_f32_32x32x16_bf16 v[64:79], a[0:3], v[168:171], v[64:79]
  ds_read_b64_tr_b16 a[24:25], v19 offset:12288
  ds_read_b64_tr_b16 a[26:27], v19 offset:12800
  buffer_load_dwordx4 v8, s[28:31], s4 offen offset:2048 lds
  v_mfma_f32_32x32x16_bf16 v[80:95], a[4:7], v[168:171], v[80:95]
  ds_read_b64_tr_b16 a[28:29], v20 offset:12288
  ds_read_b64_tr_b16 a[30:31], v20 offset:12800
  buffer_load_dwordx4 v9, s[28:31], s4 offen offset:3072 lds
  s_waitcnt lgkmcnt(8)
  v_mfma_f32_32x32x16_bf16 v[96:111], a[8:11], v[168:171], v[96:111]
  s_barrier
  v_add_u32 v17, 49152, v13
  v_xor_b32 v18, 32, v17
  v_xor_b32 v19, 64, v17
  v_xor_b32 v20, 96, v17
  ds_read_b64_tr_b16 a[0:1], v17 offset:0
  ds_read_b64_tr_b16 a[2:3], v17 offset:512
  s_add_u32 s3, s66, 1
  s_and_b32 s3, s3, 3
  s_mul_i32 s3, s3, 393216
  s_add_u32 s3, s3, s50
  v_mfma_f32_32x32x16_bf16 v[112:127], a[12:15], v[168:171], v[112:127]
  ds_read_b64_tr_b16 a[4:5], v18 offset:0
  ds_read_b64_tr_b16 a[6:7], v18 offset:512
  s_add_u32 m0, s46, 16384
  s_nop 0
  buffer_load_dwordx4 v2, s[12:15], s3 offen lds
  s_waitcnt lgkmcnt(8)
  v_mfma_f32_32x32x16_bf16 v[64:79], a[16:19], v[172:175], v[64:79]
  ds_read_b64_tr_b16 a[8:9], v19 offset:0
  ds_read_b64_tr_b16 a[10:11], v19 offset:512
  buffer_load_dwordx4 v3, s[12:15], s3 offen offset:1024 lds
  v_mfma_f32_32x32x16_bf16 v[80:95], a[20:23], v[172:175], v[80:95]
  ds_read_b64_tr_b16 a[12:13], v20 offset:0
  ds_read_b64_tr_b16 a[14:15], v20 offset:512
  buffer_load_dwordx4 v4, s[12:15], s3 offen offset:2048 lds
  s_waitcnt lgkmcnt(8)
  v_mfma_f32_32x32x16_bf16 v[96:111], a[24:27], v[172:175], v[96:111]
  ds_read_b64_tr_b16 a[16:17], v17 offset:4096
  ds_read_b64_tr_b16 a[18:19], v17 offset:4608
  buffer_load_dwordx4 v5, s[12:15], s3 offen offset:3072 lds
  v_mfma_f32_32x32x16_bf16 v[112:127], a[28:31], v[172:175], v[112:127]
  ds_read_b64_tr_b16 a[20:21], v18 offset:4096
  ds_read_b64_tr_b16 a[22:23], v18 offset:4608
  s_waitcnt lgkmcnt(8)
  v_mfma_f32_32x32x16_bf16 v[64:79], a[0:3], v[176:179], v[64:79]
  ds_read_b64_tr_b16 a[24:25], v19 offset:4096
  ds_read_b64_tr_b16 a[26:27], v19 offset:4608
  s_waitcnt vmcnt(13)
  v_add_u32 v21, 131072, v16
  v_xor_b32 v22, 64, v21
  ds_read_b64_tr_b16 a[160:161], v21 offset:0
  ds_read_b64_tr_b16 a[162:163], v21 offset:1024
  v_mfma_f32_32x32x16_bf16 v[80:95], a[4:7], v[176:179], v[80:95]
  ds_read_b64_tr_b16 a[28:29], v20 offset:4096
  ds_read_b64_tr_b16 a[30:31], v20 offset:4608
  ds_read_b64_tr_b16 a[164:165], v22 offset:0
  ds_read_b64_tr_b16 a[166:167], v22 offset:1024
  s_waitcnt lgkmcnt(12)
  v_mfma_f32_32x32x16_bf16 v[96:111], a[8:11], v[176:179], v[96:111]
  ds_read_b64_tr_b16 a[0:1], v17 offset:8192
  ds_read_b64_tr_b16 a[2:3], v17 offset:8704
  ds_read_b64_tr_b16 a[168:169], v21 offset:2048
  ds_read_b64_tr_b16 a[170:171], v21 offset:3072
  v_mfma_f32_32x32x16_bf16 v[112:127], a[12:15], v[176:179], v[112:127]
  ds_read_b64_tr_b16 a[4:5], v18 offset:8192
  ds_read_b64_tr_b16 a[6:7], v18 offset:8704
  ds_read_b64_tr_b16 a[172:173], v22 offset:2048
  ds_read_b64_tr_b16 a[174:175], v22 offset:3072
  s_waitcnt lgkmcnt(15)
  v_mfma_f32_32x32x16_bf16 v[64:79], a[16:19], v[180:183], v[64:79]
  ds_read_b64_tr_b16 a[8:9], v19 offset:8192
  ds_read_b64_tr_b16 a[10:11], v19 offset:8704
  v_mfma_f32_32x32x16_bf16 v[80:95], a[20:23], v[180:183], v[80:95]
  ds_read_b64_tr_b16 a[12:13], v20 offset:8192
  ds_read_b64_tr_b16 a[14:15], v20 offset:8704
  s_waitcnt lgkmcnt(4)
  s_add_u32 s4, s51, 262144
  v_mfma_f32_32x32x16_bf16 v[96:111], a[24:27], v[180:183], v[96:111]
  ds_read_b64_tr_b16 a[16:17], v17 offset:12288
  ds_read_b64_tr_b16 a[18:19], v17 offset:12800
  s_add_u32 m0, s46, 131072
  s_nop 0
  buffer_load_dwordx4 v6, s[28:31], s4 offen lds
  v_mfma_f32_32x32x16_bf16 v[112:127], a[28:31], v[180:183], v[112:127]
  ds_read_b64_tr_b16 a[20:21], v18 offset:12288
  ds_read_b64_tr_b16 a[22:23], v18 offset:12800
  buffer_load_dwordx4 v7, s[28:31], s4 offen offset:1024 lds
  v_mfma_f32_32x32x16_bf16 v[64:79], a[0:3], v[184:187], v[64:79]
  ds_read_b64_tr_b16 a[24:25], v19 offset:12288
  ds_read_b64_tr_b16 a[26:27], v19 offset:12800
  buffer_load_dwordx4 v8, s[28:31], s4 offen offset:2048 lds
  v_mfma_f32_32x32x16_bf16 v[80:95], a[4:7], v[184:187], v[80:95]
  ds_read_b64_tr_b16 a[28:29], v20 offset:12288
  ds_read_b64_tr_b16 a[30:31], v20 offset:12800
  buffer_load_dwordx4 v9, s[28:31], s4 offen offset:3072 lds
  s_waitcnt lgkmcnt(8)
  v_mfma_f32_32x32x16_bf16 v[96:111], a[8:11], v[184:187], v[96:111]
  s_barrier
  v_add_u32 v17, 65536, v13
  v_xor_b32 v18, 32, v17
  v_xor_b32 v19, 64, v17
  v_xor_b32 v20, 96, v17
  ds_read_b64_tr_b16 a[0:1], v17 offset:0
  ds_read_b64_tr_b16 a[2:3], v17 offset:512
  s_add_u32 s3, s66, 2
  s_and_b32 s3, s3, 3
  s_mul_i32 s3, s3, 393216
  s_add_u32 s3, s3, s50
  v_mfma_f32_32x32x16_bf16 v[112:127], a[12:15], v[184:187], v[112:127]
  ds_read_b64_tr_b16 a[4:5], v18 offset:0
  ds_read_b64_tr_b16 a[6:7], v18 offset:512
  s_add_u32 m0, s46, 32768
  s_nop 0
  buffer_load_dwordx4 v2, s[12:15], s3 offen lds
  s_waitcnt lgkmcnt(8)
  v_mfma_f32_32x32x16_bf16 v[64:79], a[16:19], v[188:191], v[64:79]
  ds_read_b64_tr_b16 a[8:9], v19 offset:0
  ds_read_b64_tr_b16 a[10:11], v19 offset:512
  buffer_load_dwordx4 v3, s[12:15], s3 offen offset:1024 lds
  v_mfma_f32_32x32x16_bf16 v[80:95], a[20:23], v[188:191], v[80:95]
  ds_read_b64_tr_b16 a[12:13], v20 offset:0
  ds_read_b64_tr_b16 a[14:15], v20 offset:512
  buffer_load_dwordx4 v4, s[12:15], s3 offen offset:2048 lds
  s_waitcnt lgkmcnt(8)
  v_mfma_f32_32x32x16_bf16 v[96:111], a[24:27], v[188:191], v[96:111]
  ds_read_b64_tr_b16 a[16:17], v17 offset:4096
  ds_read_b64_tr_b16 a[18:19], v17 offset:4608
  buffer_load_dwordx4 v5, s[12:15], s3 offen offset:3072 lds
  v_mfma_f32_32x32x16_bf16 v[112:127], a[28:31], v[188:191], v[112:127]
  ds_read_b64_tr_b16 a[20:21], v18 offset:4096
  ds_read_b64_tr_b16 a[22:23], v18 offset:4608
  s_waitcnt lgkmcnt(8)
  v_mfma_f32_32x32x16_bf16 v[64:79], a[0:3], v[192:195], v[64:79]
  ds_read_b64_tr_b16 a[24:25], v19 offset:4096
  ds_read_b64_tr_b16 a[26:27], v19 offset:4608
  s_waitcnt vmcnt(12)
  v_add_u32 v21, 147456, v16
  v_xor_b32 v22, 64, v21
  ds_read_b64_tr_b16 a[176:177], v21 offset:0
  ds_read_b64_tr_b16 a[178:179], v21 offset:1024
  v_mfma_f32_32x32x16_bf16 v[80:95], a[4:7], v[192:195], v[80:95]
  ds_read_b64_tr_b16 a[28:29], v20 offset:4096
  ds_read_b64_tr_b16 a[30:31], v20 offset:4608
  ds_read_b64_tr_b16 a[180:181], v22 offset:0
  ds_read_b64_tr_b16 a[182:183], v22 offset:1024
  s_waitcnt lgkmcnt(12)
  v_mfma_f32_32x32x16_bf16 v[96:111], a[8:11], v[192:195], v[96:111]
  ds_read_b64_tr_b16 a[0:1], v17 offset:8192
  ds_read_b64_tr_b16 a[2:3], v17 offset:8704
  ds_read_b64_tr_b16 a[184:185], v21 offset:2048
  ds_read_b64_tr_b16 a[186:187], v21 offset:3072
  v_mfma_f32_32x32x16_bf16 v[112:127], a[12:15], v[192:195], v[112:127]
  ds_read_b64_tr_b16 a[4:5], v18 offset:8192
  ds_read_b64_tr_b16 a[6:7], v18 offset:8704
  ds_read_b64_tr_b16 a[188:189], v22 offset:2048
  ds_read_b64_tr_b16 a[190:191], v22 offset:3072
  s_waitcnt lgkmcnt(15)
  v_mfma_f32_32x32x16_bf16 v[64:79], a[16:19], v[196:199], v[64:79]
  ds_read_b64_tr_b16 a[8:9], v19 offset:8192
  ds_read_b64_tr_b16 a[10:11], v19 offset:8704
  v_mfma_f32_32x32x16_bf16 v[80:95], a[20:23], v[196:199], v[80:95]
  ds_read_b64_tr_b16 a[12:13], v20 offset:8192
  ds_read_b64_tr_b16 a[14:15], v20 offset:8704
  s_waitcnt lgkmcnt(4)
  s_add_u32 s4, s51, 294912
  v_mfma_f32_32x32x16_bf16 v[96:111], a[24:27], v[196:199], v[96:111]
  ds_read_b64_tr_b16 a[16:17], v17 offset:12288
  ds_read_b64_tr_b16 a[18:19], v17 offset:12800
  s_add_u32 m0, s46, 147456
  s_nop 0
  buffer_load_dwordx4 v6, s[28:31], s4 offen lds
  v_mfma_f32_32x32x16_bf16 v[112:127], a[28:31], v[196:199], v[112:127]
  ds_read_b64_tr_b16 a[20:21], v18 offset:12288
  ds_read_b64_tr_b16 a[22:23], v18 offset:12800
  buffer_load_dwordx4 v7, s[28:31], s4 offen offset:1024 lds
  v_mfma_f32_32x32x16_bf16 v[64:79], a[0:3], v[200:203], v[64:79]
  ds_read_b64_tr_b16 a[24:25], v19 offset:12288
  ds_read_b64_tr_b16 a[26:27], v19 offset:12800
  buffer_load_dwordx4 v8, s[28:31], s4 offen offset:2048 lds
  v_mfma_f32_32x32x16_bf16 v[80:95], a[4:7], v[200:203], v[80:95]
  ds_read_b64_tr_b16 a[28:29], v20 offset:12288
  ds_read_b64_tr_b16 a[30:31], v20 offset:12800
  buffer_load_dwordx4 v9, s[28:31], s4 offen offset:3072 lds
  s_waitcnt lgkmcnt(8)
  v_mfma_f32_32x32x16_bf16 v[96:111], a[8:11], v[200:203], v[96:111]
  s_barrier
  v_add_u32 v17, 81920, v13
  v_xor_b32 v18, 32, v17
  v_xor_b32 v19, 64, v17
  v_xor_b32 v20, 96, v17
  ds_read_b64_tr_b16 a[0:1], v17 offset:0
  ds_read_b64_tr_b16 a[2:3], v17 offset:512
  s_add_u32 s3, s66, 3
  s_and_b32 s3, s3, 3
  s_mul_i32 s3, s3, 393216
  s_add_u32 s3, s3, s50
  v_mfma_f32_32x32x16_bf16 v[112:127], a[12:15], v[200:203], v[112:127]
  ds_read_b64_tr_b16 a[4:5], v18 offset:0
  ds_read_b64_tr_b16 a[6:7], v18 offset:512
  s_add_u32 m0, s46, 49152
  s_nop 0
  buffer_load_dwordx4 v2, s[12:15], s3 offen lds
  s_waitcnt lgkmcnt(8)
  v_mfma_f32_32x32x16_bf16 v[64:79], a[16:19], v[204:207], v[64:79]
  ds_read_b64_tr_b16 a[8:9], v19 offset:0
  ds_read_b64_tr_b16 a[10:11], v19 offset:512
  buffer_load_dwordx4 v3, s[12:15], s3 offen offset:1024 lds
  v_mfma_f32_32x32x16_bf16 v[80:95], a[20:23], v[204:207], v[80:95]
  ds_read_b64_tr_b16 a[12:13], v20 offset:0
  ds_read_b64_tr_b16 a[14:15], v20 offset:512
  buffer_load_dwordx4 v4, s[12:15], s3 offen offset:2048 lds
  s_waitcnt lgkmcnt(8)
  v_mfma_f32_32x32x16_bf16 v[96:111], a[24:27], v[204:207], v[96:111]
  ds_read_b64_tr_b16 a[16:17], v17 offset:4096
  ds_read_b64_tr_b16 a[18:19], v17 offset:4608
  buffer_load_dwordx4 v5, s[12:15], s3 offen offset:3072 lds
  v_mfma_f32_32x32x16_bf16 v[112:127], a[28:31], v[204:207], v[112:127]
  ds_read_b64_tr_b16 a[20:21], v18 offset:4096
  ds_read_b64_tr_b16 a[22:23], v18 offset:4608
  s_waitcnt lgkmcnt(8)
  v_mfma_f32_32x32x16_bf16 v[64:79], a[0:3], v[208:211], v[64:79]
  ds_read_b64_tr_b16 a[24:25], v19 offset:4096
  ds_read_b64_tr_b16 a[26:27], v19 offset:4608
  s_waitcnt vmcnt(12)
  v_add_u32 v21, 131072, v16
  v_xor_b32 v22, 64, v21
  ds_read_b64_tr_b16 a[192:193], v21 offset:0
  ds_read_b64_tr_b16 a[194:195], v21 offset:1024
  v_mfma_f32_32x32x16_bf16 v[80:95], a[4:7], v[208:211], v[80:95]
  ds_read_b64_tr_b16 a[28:29], v20 offset:4096
  ds_read_b64_tr_b16 a[30:31], v20 offset:4608
  ds_read_b64_tr_b16 a[196:197], v22 offset:0
  ds_read_b64_tr_b16 a[198:199], v22 offset:1024
  s_waitcnt lgkmcnt(12)
  v_mfma_f32_32x32x16_bf16 v[96:111], a[8:11], v[208:211], v[96:111]
  ds_read_b64_tr_b16 a[0:1], v17 offset:8192
  ds_read_b64_tr_b16 a[2:3], v17 offset:8704
  ds_read_b64_tr_b16 a[200:201], v21 offset:2048
  ds_read_b64_tr_b16 a[202:203], v21 offset:3072
  v_mfma_f32_32x32x16_bf16 v[112:127], a[12:15], v[208:211], v[112:127]
  ds_read_b64_tr_b16 a[4:5], v18 offset:8192
  ds_read_b64_tr_b16 a[6:7], v18 offset:8704
  ds_read_b64_tr_b16 a[204:205], v22 offset:2048
  ds_read_b64_tr_b16 a[206:207], v22 offset:3072
  s_waitcnt lgkmcnt(15)
  v_mfma_f32_32x32x16_bf16 v[64:79], a[16:19], v[212:215], v[64:79]
  ds_read_b64_tr_b16 a[8:9], v19 offset:8192
  ds_read_b64_tr_b16 a[10:11], v19 offset:8704
  v_mfma_f32_32x32x16_bf16 v[80:95], a[20:23], v[212:215], v[80:95]
  ds_read_b64_tr_b16 a[12:13], v20 offset:8192
  ds_read_b64_tr_b16 a[14:15], v20 offset:8704
  s_waitcnt lgkmcnt(4)
  s_add_u32 s4, s51, 196608
  v_mfma_f32_32x32x16_bf16 v[96:111], a[24:27], v[212:215], v[96:111]
  ds_read_b64_tr_b16 a[16:17], v17 offset:12288
  ds_read_b64_tr_b16 a[18:19], v17 offset:12800
  s_add_u32 m0, s46, 131072
  s_nop 0
  buffer_load_dwordx4 v6, s[28:31], s4 offen lds
  v_mfma_f32_32x32x16_bf16 v[112:127], a[28:31], v[212:215], v[112:127]
  ds_read_b64_tr_b16 a[20:21], v18 offset:12288
  ds_read_b64_tr_b16 a[22:23], v18 offset:12800
  buffer_load_dwordx4 v7, s[28:31], s4 offen offset:1024 lds
  v_mfma_f32_32x32x16_bf16 v[64:79], a[0:3], v[216:219], v[64:79]
  ds_read_b64_tr_b16 a[24:25], v19 offset:12288
  ds_read_b64_tr_b16 a[26:27], v19 offset:12800
  buffer_load_dwordx4 v8, s[28:31], s4 offen offset:2048 lds
  v_mfma_f32_32x32x16_bf16 v[80:95], a[4:7], v[216:219], v[80:95]
  ds_read_b64_tr_b16 a[28:29], v20 offset:12288
  ds_read_b64_tr_b16 a[30:31], v20 offset:12800
  buffer_load_dwordx4 v9, s[28:31], s4 offen offset:3072 lds
  v_readlane_b32 s76, v58, 0
  v_readlane_b32 s77, v58, 1
  v_readlane_b32 s78, v58, 2
  v_readlane_b32 s79, v58, 3
  v_readlane_b32 s80, v58, 4
  v_readlane_b32 s81, v58, 5
  v_readlane_b32 s82, v58, 6
  v_readlane_b32 s83, v58, 7
  s_nop 0
  s_xor_b32 s76, s76, s80
  s_xor_b32 s77, s77, s81
  s_xor_b32 s78, s78, s82
  s_xor_b32 s79, s79, s83
  s_waitcnt lgkmcnt(8)
  v_mfma_f32_32x32x16_bf16 v[96:111], a[8:11], v[216:219], v[96:111]
  s_barrier
  v_add_u32 v17, 98304, v13
  v_xor_b32 v18, 32, v17
  v_xor_b32 v19, 64, v17
  v_xor_b32 v20, 96, v17
  ds_read_b64_tr_b16 a[0:1], v17 offset:0
  ds_read_b64_tr_b16 a[2:3], v17 offset:512
  v_mfma_f32_32x32x16_bf16 v[112:127], a[12:15], v[216:219], v[112:127]
  ds_read_b64_tr_b16 a[4:5], v18 offset:0
  ds_read_b64_tr_b16 a[6:7], v18 offset:512
  s_waitcnt lgkmcnt(8)
  v_mfma_f32_32x32x16_bf16 v[64:79], a[16:19], v[220:223], v[64:79]
  ds_read_b64_tr_b16 a[8:9], v19 offset:0
  ds_read_b64_tr_b16 a[10:11], v19 offset:512
  v_mfma_f32_32x32x16_bf16 v[80:95], a[20:23], v[220:223], v[80:95]
  ds_read_b64_tr_b16 a[12:13], v20 offset:0
  ds_read_b64_tr_b16 a[14:15], v20 offset:512
  s_waitcnt lgkmcnt(8)
  v_mfma_f32_32x32x16_bf16 v[96:111], a[24:27], v[220:223], v[96:111]
  ds_read_b64_tr_b16 a[16:17], v17 offset:4096
  ds_read_b64_tr_b16 a[18:19], v17 offset:4608
  v_mfma_f32_32x32x16_bf16 v[112:127], a[28:31], v[220:223], v[112:127]
  ds_read_b64_tr_b16 a[20:21], v18 offset:4096
  ds_read_b64_tr_b16 a[22:23], v18 offset:4608
  s_waitcnt lgkmcnt(8)
  v_mfma_f32_32x32x16_bf16 v[64:79], a[0:3], v[224:227], v[64:79]
  ds_read_b64_tr_b16 a[24:25], v19 offset:4096
  ds_read_b64_tr_b16 a[26:27], v19 offset:4608
  s_waitcnt vmcnt(8)
  v_add_u32 v21, 147456, v16
  v_xor_b32 v22, 64, v21
  ds_read_b64_tr_b16 a[208:209], v21 offset:0
  ds_read_b64_tr_b16 a[210:211], v21 offset:1024
  v_mfma_f32_32x32x16_bf16 v[80:95], a[4:7], v[224:227], v[80:95]
  ds_read_b64_tr_b16 a[28:29], v20 offset:4096
  ds_read_b64_tr_b16 a[30:31], v20 offset:4608
  ds_read_b64_tr_b16 a[212:213], v22 offset:0
  ds_read_b64_tr_b16 a[214:215], v22 offset:1024
  s_waitcnt lgkmcnt(12)
  v_mfma_f32_32x32x16_bf16 v[96:111], a[8:11], v[224:227], v[96:111]
  ds_read_b64_tr_b16 a[0:1], v17 offset:8192
  ds_read_b64_tr_b16 a[2:3], v17 offset:8704
  ds_read_b64_tr_b16 a[216:217], v21 offset:2048
  ds_read_b64_tr_b16 a[218:219], v21 offset:3072
  v_mfma_f32_32x32x16_bf16 v[112:127], a[12:15], v[224:227], v[112:127]
  ds_read_b64_tr_b16 a[4:5], v18 offset:8192
  ds_read_b64_tr_b16 a[6:7], v18 offset:8704
  ds_read_b64_tr_b16 a[220:221], v22 offset:2048
  ds_read_b64_tr_b16 a[222:223], v22 offset:3072
  s_waitcnt lgkmcnt(15)
  v_mfma_f32_32x32x16_bf16 v[64:79], a[16:19], v[228:231], v[64:79]
  ds_read_b64_tr_b16 a[8:9], v19 offset:8192
  ds_read_b64_tr_b16 a[10:11], v19 offset:8704
  v_mfma_f32_32x32x16_bf16 v[80:95], a[20:23], v[228:231], v[80:95]
  ds_read_b64_tr_b16 a[12:13], v20 offset:8192
  ds_read_b64_tr_b16 a[14:15], v20 offset:8704
  s_waitcnt lgkmcnt(4)
  s_add_u32 s4, s51, 229376
  v_mfma_f32_32x32x16_bf16 v[96:111], a[24:27], v[228:231], v[96:111]
  ds_read_b64_tr_b16 a[16:17], v17 offset:12288
  ds_read_b64_tr_b16 a[18:19], v17 offset:12800
  s_add_u32 m0, s46, 147456
  s_nop 0
  buffer_load_dwordx4 v6, s[28:31], s4 offen lds
  v_mfma_f32_32x32x16_bf16 v[112:127], a[28:31], v[228:231], v[112:127]
  ds_read_b64_tr_b16 a[20:21], v18 offset:12288
  ds_read_b64_tr_b16 a[22:23], v18 offset:12800
  buffer_load_dwordx4 v7, s[28:31], s4 offen offset:1024 lds
  v_mfma_f32_32x32x16_bf16 v[64:79], a[0:3], v[232:235], v[64:79]
  ds_read_b64_tr_b16 a[24:25], v19 offset:12288
  ds_read_b64_tr_b16 a[26:27], v19 offset:12800
  buffer_load_dwordx4 v8, s[28:31], s4 offen offset:2048 lds
  v_mfma_f32_32x32x16_bf16 v[80:95], a[4:7], v[232:235], v[80:95]
  ds_read_b64_tr_b16 a[28:29], v20 offset:12288
  ds_read_b64_tr_b16 a[30:31], v20 offset:12800
  buffer_load_dwordx4 v9, s[28:31], s4 offen offset:3072 lds
  s_waitcnt lgkmcnt(8)
  v_mfma_f32_32x32x16_bf16 v[96:111], a[8:11], v[232:235], v[96:111]
  s_barrier
  v_add_u32 v17, 114688, v13
  v_xor_b32 v18, 32, v17
  v_xor_b32 v19, 64, v17
  v_xor_b32 v20, 96, v17
  ds_read_b64_tr_b16 a[0:1], v17 offset:0
  ds_read_b64_tr_b16 a[2:3], v17 offset:512
  v_mfma_f32_32x32x16_bf16 v[112:127], a[12:15], v[232:235], v[112:127]
  ds_read_b64_tr_b16 a[4:5], v18 offset:0
  ds_read_b64_tr_b16 a[6:7], v18 offset:512
  s_waitcnt lgkmcnt(8)
  v_mfma_f32_32x32x16_bf16 v[64:79], a[16:19], v[236:239], v[64:79]
  ds_read_b64_tr_b16 a[8:9], v19 offset:0
  ds_read_b64_tr_b16 a[10:11], v19 offset:512
  v_mfma_f32_32x32x16_bf16 v[80:95], a[20:23], v[236:239], v[80:95]
  ds_read_b64_tr_b16 a[12:13], v20 offset:0
  ds_read_b64_tr_b16 a[14:15], v20 offset:512
  s_waitcnt lgkmcnt(8)
  v_mfma_f32_32x32x16_bf16 v[96:111], a[24:27], v[236:239], v[96:111]
  ds_read_b64_tr_b16 a[16:17], v17 offset:4096
  ds_read_b64_tr_b16 a[18:19], v17 offset:4608
  v_mfma_f32_32x32x16_bf16 v[112:127], a[28:31], v[236:239], v[112:127]
  ds_read_b64_tr_b16 a[20:21], v18 offset:4096
  ds_read_b64_tr_b16 a[22:23], v18 offset:4608
  s_waitcnt lgkmcnt(8)
  v_mfma_f32_32x32x16_bf16 v[64:79], a[0:3], v[240:243], v[64:79]
  ds_read_b64_tr_b16 a[24:25], v19 offset:4096
  ds_read_b64_tr_b16 a[26:27], v19 offset:4608
  s_waitcnt vmcnt(4)
  v_add_u32 v21, 131072, v16
  v_xor_b32 v22, 64, v21
  ds_read_b64_tr_b16 a[224:225], v21 offset:0
  ds_read_b64_tr_b16 a[226:227], v21 offset:1024
  v_mfma_f32_32x32x16_bf16 v[80:95], a[4:7], v[240:243], v[80:95]
  ds_read_b64_tr_b16 a[28:29], v20 offset:4096
  ds_read_b64_tr_b16 a[30:31], v20 offset:4608
  ds_read_b64_tr_b16 a[228:229], v22 offset:0
  ds_read_b64_tr_b16 a[230:231], v22 offset:1024
  s_waitcnt lgkmcnt(12)
  v_mfma_f32_32x32x16_bf16 v[96:111], a[8:11], v[240:243], v[96:111]
  ds_read_b64_tr_b16 a[0:1], v17 offset:8192
  ds_read_b64_tr_b16 a[2:3], v17 offset:8704
  ds_read_b64_tr_b16 a[232:233], v21 offset:2048
  ds_read_b64_tr_b16 a[234:235], v21 offset:3072
  v_mfma_f32_32x32x16_bf16 v[112:127], a[12:15], v[240:243], v[112:127]
  ds_read_b64_tr_b16 a[4:5], v18 offset:8192
  ds_read_b64_tr_b16 a[6:7], v18 offset:8704
  ds_read_b64_tr_b16 a[236:237], v22 offset:2048
  ds_read_b64_tr_b16 a[238:239], v22 offset:3072
  s_waitcnt lgkmcnt(15)
  v_mfma_f32_32x32x16_bf16 v[64:79], a[16:19], v[244:247], v[64:79]
  ds_read_b64_tr_b16 a[8:9], v19 offset:8192
  ds_read_b64_tr_b16 a[10:11], v19 offset:8704
  v_mfma_f32_32x32x16_bf16 v[80:95], a[20:23], v[244:247], v[80:95]
  ds_read_b64_tr_b16 a[12:13], v20 offset:8192
  ds_read_b64_tr_b16 a[14:15], v20 offset:8704
  s_waitcnt lgkmcnt(4)
  s_add_u32 s4, s52, 0
  v_mfma_f32_32x32x16_bf16 v[96:111], a[24:27], v[244:247], v[96:111]
  ds_read_b64_tr_b16 a[16:17], v17 offset:12288
  ds_read_b64_tr_b16 a[18:19], v17 offset:12800
  s_add_u32 m0, s46, 131072
  s_nop 0
  buffer_load_dwordx4 v6, s[16:19], s4 offen lds
  v_mfma_f32_32x32x16_bf16 v[112:127], a[28:31], v[244:247], v[112:127]
  ds_read_b64_tr_b16 a[20:21], v18 offset:12288
  ds_read_b64_tr_b16 a[22:23], v18 offset:12800
  buffer_load_dwordx4 v7, s[16:19], s4 offen offset:1024 lds
  v_mfma_f32_32x32x16_bf16 v[64:79], a[0:3], v[248:251], v[64:79]
  ds_read_b64_tr_b16 a[24:25], v19 offset:12288
  ds_read_b64_tr_b16 a[26:27], v19 offset:12800
  buffer_load_dwordx4 v8, s[16:19], s4 offen offset:2048 lds
  v_mfma_f32_32x32x16_bf16 v[80:95], a[4:7], v[248:251], v[80:95]
  ds_read_b64_tr_b16 a[28:29], v20 offset:12288
  ds_read_b64_tr_b16 a[30:31], v20 offset:12800
  buffer_load_dwordx4 v9, s[16:19], s4 offen offset:3072 lds
  s_waitcnt lgkmcnt(8)
  v_mfma_f32_32x32x16_bf16 v[96:111], a[8:11], v[248:251], v[96:111]
  s_barrier
  v_add_u32 v17, 0, v14
  v_xor_b32 v18, 64, v17
  ds_read_b64_tr_b16 a[0:1], v17 offset:0
  ds_read_b64_tr_b16 a[2:3], v17 offset:512
  s_add_u32 s4, s52, 65536
  v_mfma_f32_32x32x16_bf16 v[112:127], a[12:15], v[248:251], v[112:127]
  ds_read_b64_tr_b16 a[4:5], v18 offset:0
  ds_read_b64_tr_b16 a[6:7], v18 offset:512
  s_add_u32 m0, s46, 65536
  s_nop 0
  buffer_load_dwordx4 v6, s[16:19], s4 offen lds
  s_waitcnt lgkmcnt(8)
  v_mfma_f32_32x32x16_bf16 v[64:79], a[16:19], v[252:255], v[64:79]
  ds_read_b64_tr_b16 a[8:9], v17 offset:2048
  ds_read_b64_tr_b16 a[10:11], v17 offset:2560
  buffer_load_dwordx4 v7, s[16:19], s4 offen offset:1024 lds
  v_mfma_f32_32x32x16_bf16 v[80:95], a[20:23], v[252:255], v[80:95]
  ds_read_b64_tr_b16 a[12:13], v18 offset:2048
  ds_read_b64_tr_b16 a[14:15], v18 offset:2560
  buffer_load_dwordx4 v8, s[16:19], s4 offen offset:2048 lds
  s_waitcnt lgkmcnt(8)
  v_mfma_f32_32x32x16_bf16 v[96:111], a[24:27], v[252:255], v[96:111]
  ds_read_b64_tr_b16 a[16:17], v17 offset:4096
  ds_read_b64_tr_b16 a[18:19], v17 offset:4608
  buffer_load_dwordx4 v9, s[16:19], s4 offen offset:3072 lds
  v_mfma_f32_32x32x16_bf16 v[112:127], a[28:31], v[252:255], v[112:127]
  ds_read_b64_tr_b16 a[20:21], v18 offset:4096
  ds_read_b64_tr_b16 a[22:23], v18 offset:4608
  v_pk_mul_f32 v[48:49], v[64:65], v[72:73]
  v_pk_mul_f32 v[50:51], v[66:67], v[74:75]
  v_pk_mul_f32 v[52:53], v[68:69], v[76:77]
  v_pk_mul_f32 v[54:55], v[70:71], v[78:79]
  v_cvt_pk_bf16_f32 v32, v48, v49
  v_cvt_pk_bf16_f32 v33, v50, v51
  v_cvt_pk_bf16_f32 v34, v52, v53
  v_cvt_pk_bf16_f32 v35, v54, v55
  buffer_store_dwordx4 v[32:35], v1, s[36:39], s55 offen sc1
  v_pk_mul_f32 v[48:49], v[80:81], v[88:89]
  v_pk_mul_f32 v[50:51], v[82:83], v[90:91]
  v_pk_mul_f32 v[52:53], v[84:85], v[92:93]
  v_pk_mul_f32 v[54:55], v[86:87], v[94:95]
  v_cvt_pk_bf16_f32 v36, v48, v49
  v_cvt_pk_bf16_f32 v37, v50, v51
  v_cvt_pk_bf16_f32 v38, v52, v53
  v_cvt_pk_bf16_f32 v39, v54, v55
  buffer_store_dwordx4 v[36:39], v1, s[36:39], s55 offen offset:2048 sc1
  v_pk_mul_f32 v[48:49], v[96:97], v[104:105]
  v_pk_mul_f32 v[50:51], v[98:99], v[106:107]
  v_pk_mul_f32 v[52:53], v[100:101], v[108:109]
  v_pk_mul_f32 v[54:55], v[102:103], v[110:111]
  v_cvt_pk_bf16_f32 v40, v48, v49
  v_cvt_pk_bf16_f32 v41, v50, v51
  v_cvt_pk_bf16_f32 v42, v52, v53
  v_cvt_pk_bf16_f32 v43, v54, v55
  s_add_u32 s7, s55, 4096
  buffer_store_dwordx4 v[40:43], v1, s[36:39], s7 offen sc1
  v_pk_mul_f32 v[48:49], v[112:113], v[120:121]
  v_pk_mul_f32 v[50:51], v[114:115], v[122:123]
  v_pk_mul_f32 v[52:53], v[116:117], v[124:125]
  v_pk_mul_f32 v[54:55], v[118:119], v[126:127]
  v_cvt_pk_bf16_f32 v44, v48, v49
  v_cvt_pk_bf16_f32 v45, v50, v51
  v_cvt_pk_bf16_f32 v46, v52, v53
  v_cvt_pk_bf16_f32 v47, v54, v55
  buffer_store_dwordx4 v[44:47], v1, s[36:39], s7 offen offset:2048 sc1
  v_bitop3_b32 v26, v32, v33, s72 bitop3:0x96
  v_bitop3_b32 v26, v34, v35, v26 bitop3:0x96
  v_bitop3_b32 v26, v36, v37, v26 bitop3:0x96
  v_bitop3_b32 v26, v38, v39, v26 bitop3:0x96
  v_bitop3_b32 v26, v40, v41, v26 bitop3:0x96
  v_bitop3_b32 v26, v42, v43, v26 bitop3:0x96
  v_bitop3_b32 v26, v44, v45, v26 bitop3:0x96
  v_bitop3_b32 v26, v46, v47, v26 bitop3:0x96
  s_sub_u32 s6, s55, s53
  s_lshr_b32 s6, s6, 2
  s_add_u32 s6, s6, s73
  buffer_store_dword v26, v0, s[36:39], s6 offen sc1
  s_waitcnt lgkmcnt(8)
  v_mfma_f32_32x32x16_bf16 v[64:79], a[0:3], v[128:131], 0
  ds_read_b64_tr_b16 a[24:25], v17 offset:6144
  ds_read_b64_tr_b16 a[26:27], v17 offset:6656
  s_waitcnt vmcnt(13)
  v_add_u32 v21, 147456, v16
  v_xor_b32 v22, 64, v21
  ds_read_b64_tr_b16 a[240:241], v21 offset:0
  ds_read_b64_tr_b16 a[242:243], v21 offset:1024
  v_mfma_f32_32x32x16_bf16 v[80:95], a[4:7], v[128:131], 0
  ds_read_b64_tr_b16 a[28:29], v18 offset:6144
  ds_read_b64_tr_b16 a[30:31], v18 offset:6656
  ds_read_b64_tr_b16 a[244:245], v22 offset:0
  ds_read_b64_tr_b16 a[246:247], v22 offset:1024
  s_waitcnt lgkmcnt(12)
  v_mfma_f32_32x32x16_bf16 v[64:79], a[8:11], v[132:135], v[64:79]
  ds_read_b64_tr_b16 a[0:1], v17 offset:8192
  ds_read_b64_tr_b16 a[2:3], v17 offset:8704
  ds_read_b64_tr_b16 a[248:249], v21 offset:2048
  ds_read_b64_tr_b16 a[250:251], v21 offset:3072
  v_mfma_f32_32x32x16_bf16 v[80:95], a[12:15], v[132:135], v[80:95]
  ds_read_b64_tr_b16 a[4:5], v18 offset:8192
  ds_read_b64_tr_b16 a[6:7], v18 offset:8704
  ds_read_b64_tr_b16 a[252:253], v22 offset:2048
  ds_read_b64_tr_b16 a[254:255], v22 offset:3072
  s_waitcnt lgkmcnt(15)
  v_mfma_f32_32x32x16_bf16 v[64:79], a[16:19], v[136:139], v[64:79]
  ds_read_b64_tr_b16 a[8:9], v17 offset:10240
  ds_read_b64_tr_b16 a[10:11], v17 offset:10752
  v_mfma_f32_32x32x16_bf16 v[80:95], a[20:23], v[136:139], v[80:95]
  ds_read_b64_tr_b16 a[12:13], v18 offset:10240
  ds_read_b64_tr_b16 a[14:15], v18 offset:10752
  s_waitcnt lgkmcnt(4)
  s_add_u32 s4, s52, 32768
  v_mfma_f32_32x32x16_bf16 v[64:79], a[24:27], v[140:143], v[64:79]
  ds_read_b64_tr_b16 a[16:17], v17 offset:12288
  ds_read_b64_tr_b16 a[18:19], v17 offset:12800
  s_add_u32 m0, s46, 147456
  s_nop 0
  buffer_load_dwordx4 v6, s[16:19], s4 offen lds
  v_mfma_f32_32x32x16_bf16 v[80:95], a[28:31], v[140:143], v[80:95]
  ds_read_b64_tr_b16 a[20:21], v18 offset:12288
  ds_read_b64_tr_b16 a[22:23], v18 offset:12800
  buffer_load_dwordx4 v7, s[16:19], s4 offen offset:1024 lds
  s_add_u32 s6, s57, 0
  buffer_load_dwordx4 v[128:131], v1, s[36:39], s6 offen sc1
  buffer_load_dwordx4 v[132:135], v1, s[36:39], s6 offen offset:1024 sc1
  buffer_load_dwordx4 v[136:139], v1, s[36:39], s6 offen offset:2048 sc1
  buffer_load_dwordx4 v[140:143], v1, s[36:39], s6 offen offset:3072 sc1
  v_mfma_f32_32x32x16_bf16 v[64:79], a[0:3], v[144:147], v[64:79]
  ds_read_b64_tr_b16 a[24:25], v17 offset:14336
  ds_read_b64_tr_b16 a[26:27], v17 offset:14848
  buffer_load_dwordx4 v8, s[16:19], s4 offen offset:2048 lds
  v_mfma_f32_32x32x16_bf16 v[80:95], a[4:7], v[144:147], v[80:95]
  ds_read_b64_tr_b16 a[28:29], v18 offset:14336
  ds_read_b64_tr_b16 a[30:31], v18 offset:14848
  buffer_load_dwordx4 v9, s[16:19], s4 offen offset:3072 lds
  s_waitcnt lgkmcnt(8)
  v_mfma_f32_32x32x16_bf16 v[64:79], a[8:11], v[148:151], v[64:79]
  s_barrier
  v_add_u32 v17, 16384, v14
  v_xor_b32 v18, 64, v17
  ds_read_b64_tr_b16 a[0:1], v17 offset:0
  ds_read_b64_tr_b16 a[2:3], v17 offset:512
  s_add_u32 s4, s52, 98304
  v_mfma_f32_32x32x16_bf16 v[80:95], a[12:15], v[148:151], v[80:95]
  ds_read_b64_tr_b16 a[4:5], v18 offset:0
  ds_read_b64_tr_b16 a[6:7], v18 offset:512
  s_add_u32 m0, s46, 81920
  s_nop 0
  buffer_load_dwordx4 v6, s[16:19], s4 offen lds
  s_waitcnt lgkmcnt(8)
  v_mfma_f32_32x32x16_bf16 v[64:79], a[16:19], v[152:155], v[64:79]
  ds_read_b64_tr_b16 a[8:9], v17 offset:2048
  ds_read_b64_tr_b16 a[10:11], v17 offset:2560
  buffer_load_dwordx4 v7, s[16:19], s4 offen offset:1024 lds
  v_mfma_f32_32x32x16_bf16 v[80:95], a[20:23], v[152:155], v[80:95]
  ds_read_b64_tr_b16 a[12:13], v18 offset:2048
  ds_read_b64_tr_b16 a[14:15], v18 offset:2560
  buffer_load_dwordx4 v8, s[16:19], s4 offen offset:2048 lds
  s_waitcnt lgkmcnt(8)
  v_mfma_f32_32x32x16_bf16 v[64:79], a[24:27], v[156:159], v[64:79]
  ds_read_b64_tr_b16 a[16:17], v17 offset:4096
  ds_read_b64_tr_b16 a[18:19], v17 offset:4608
  buffer_load_dwordx4 v9, s[16:19], s4 offen offset:3072 lds
  v_mfma_f32_32x32x16_bf16 v[80:95], a[28:31], v[156:159], v[80:95]
  ds_read_b64_tr_b16 a[20:21], v18 offset:4096
  ds_read_b64_tr_b16 a[22:23], v18 offset:4608
  s_add_u32 s6, s57, 4096
  buffer_load_dwordx4 v[144:147], v1, s[36:39], s6 offen sc1
  buffer_load_dwordx4 v[148:151], v1, s[36:39], s6 offen offset:1024 sc1
  buffer_load_dwordx4 v[152:155], v1, s[36:39], s6 offen offset:2048 sc1
  buffer_load_dwordx4 v[156:159], v1, s[36:39], s6 offen offset:3072 sc1
  s_add_u32 s6, s74, 0
  buffer_load_dword v2, v0, s[36:39], s6 offen sc1
  buffer_load_dword v3, v0, s[36:39], s6 offen offset:256 sc1
  s_waitcnt lgkmcnt(8)
  v_mfma_f32_32x32x16_bf16 v[64:79], a[0:3], v[160:163], v[64:79]
  ds_read_b64_tr_b16 a[24:25], v17 offset:6144
  ds_read_b64_tr_b16 a[26:27], v17 offset:6656
  v_mfma_f32_32x32x16_bf16 v[80:95], a[4:7], v[160:163], v[80:95]
  ds_read_b64_tr_b16 a[28:29], v18 offset:6144
  ds_read_b64_tr_b16 a[30:31], v18 offset:6656
  s_waitcnt lgkmcnt(8)
  v_mfma_f32_32x32x16_bf16 v[64:79], a[8:11], v[164:167], v[64:79]
  ds_read_b64_tr_b16 a[0:1], v17 offset:8192
  ds_read_b64_tr_b16 a[2:3], v17 offset:8704
  v_mfma_f32_32x32x16_bf16 v[80:95], a[12:15], v[164:167], v[80:95]
  ds_read_b64_tr_b16 a[4:5], v18 offset:8192
  ds_read_b64_tr_b16 a[6:7], v18 offset:8704
  s_waitcnt lgkmcnt(8)
  v_mfma_f32_32x32x16_bf16 v[64:79], a[16:19], v[168:171], v[64:79]
  ds_read_b64_tr_b16 a[8:9], v17 offset:10240
  ds_read_b64_tr_b16 a[10:11], v17 offset:10752
  v_mfma_f32_32x32x16_bf16 v[80:95], a[20:23], v[168:171], v[80:95]
  ds_read_b64_tr_b16 a[12:13], v18 offset:10240
  ds_read_b64_tr_b16 a[14:15], v18 offset:10752
  s_waitcnt lgkmcnt(8)
  v_mfma_f32_32x32x16_bf16 v[64:79], a[24:27], v[172:175], v[64:79]
  ds_read_b64_tr_b16 a[16:17], v17 offset:12288
  ds_read_b64_tr_b16 a[18:19], v17 offset:12800
  v_mfma_f32_32x32x16_bf16 v[80:95], a[28:31], v[172:175], v[80:95]
  ds_read_b64_tr_b16 a[20:21], v18 offset:12288
  ds_read_b64_tr_b16 a[22:23], v18 offset:12800
  s_add_u32 s6, s57, 40960
  buffer_load_dwordx4 v[160:163], v1, s[36:39], s6 offen sc1
  buffer_load_dwordx4 v[164:167], v1, s[36:39], s6 offen offset:1024 sc1
  buffer_load_dwordx4 v[168:171], v1, s[36:39], s6 offen offset:2048 sc1
  buffer_load_dwordx4 v[172:175], v1, s[36:39], s6 offen offset:3072 sc1
  s_waitcnt lgkmcnt(8)
  v_mfma_f32_32x32x16_bf16 v[64:79], a[0:3], v[176:179], v[64:79]
  ds_read_b64_tr_b16 a[24:25], v17 offset:14336
  ds_read_b64_tr_b16 a[26:27], v17 offset:14848
  v_mfma_f32_32x32x16_bf16 v[80:95], a[4:7], v[176:179], v[80:95]
  ds_read_b64_tr_b16 a[28:29], v18 offset:14336
  ds_read_b64_tr_b16 a[30:31], v18 offset:14848
  v_add_u32 v60, v0, v25
  s_lshl_b32 s7, s60, 7
  s_add_u32 s7, s7, 10551296
  s_mov_b64 exec, 0xffff
  buffer_load_dword v31, v60, s[36:39], s7 offen sc1
  s_mov_b64 exec, -1
  s_waitcnt lgkmcnt(8)
  s_nop 2
  v_mfma_f32_32x32x16_bf16 v[64:79], a[8:11], v[180:183], v[64:79]
  s_barrier
  v_add_u32 v17, 32768, v14
  v_xor_b32 v18, 64, v17
  ds_read_b64_tr_b16 a[0:1], v17 offset:0
  ds_read_b64_tr_b16 a[2:3], v17 offset:512
  v_mfma_f32_32x32x16_bf16 v[80:95], a[12:15], v[180:183], v[80:95]
  ds_read_b64_tr_b16 a[4:5], v18 offset:0
  ds_read_b64_tr_b16 a[6:7], v18 offset:512
  s_waitcnt lgkmcnt(8)
  v_mfma_f32_32x32x16_bf16 v[64:79], a[16:19], v[184:187], v[64:79]
  ds_read_b64_tr_b16 a[8:9], v17 offset:2048
  ds_read_b64_tr_b16 a[10:11], v17 offset:2560
  v_mfma_f32_32x32x16_bf16 v[80:95], a[20:23], v[184:187], v[80:95]
  ds_read_b64_tr_b16 a[12:13], v18 offset:2048
  ds_read_b64_tr_b16 a[14:15], v18 offset:2560
  s_waitcnt lgkmcnt(8)
  v_mfma_f32_32x32x16_bf16 v[64:79], a[24:27], v[188:191], v[64:79]
  ds_read_b64_tr_b16 a[16:17], v17 offset:4096
  ds_read_b64_tr_b16 a[18:19], v17 offset:4608
  v_mfma_f32_32x32x16_bf16 v[80:95], a[28:31], v[188:191], v[80:95]
  ds_read_b64_tr_b16 a[20:21], v18 offset:4096
  ds_read_b64_tr_b16 a[22:23], v18 offset:4608
  s_add_u32 s6, s57, 45056
  buffer_load_dwordx4 v[176:179], v1, s[36:39], s6 offen sc1
  buffer_load_dwordx4 v[180:183], v1, s[36:39], s6 offen offset:1024 sc1
  buffer_load_dwordx4 v[184:187], v1, s[36:39], s6 offen offset:2048 sc1
  buffer_load_dwordx4 v[188:191], v1, s[36:39], s6 offen offset:3072 sc1
  s_add_u32 s6, s74, 10240
  buffer_load_dword v4, v0, s[36:39], s6 offen sc1
  buffer_load_dword v5, v0, s[36:39], s6 offen offset:256 sc1
  s_waitcnt lgkmcnt(8)
  v_mfma_f32_32x32x16_bf16 v[64:79], a[0:3], v[192:195], v[64:79]
  ds_read_b64_tr_b16 a[24:25], v17 offset:6144
  ds_read_b64_tr_b16 a[26:27], v17 offset:6656
  v_mfma_f32_32x32x16_bf16 v[80:95], a[4:7], v[192:195], v[80:95]
  ds_read_b64_tr_b16 a[28:29], v18 offset:6144
  ds_read_b64_tr_b16 a[30:31], v18 offset:6656
  s_waitcnt lgkmcnt(8)
  v_mfma_f32_32x32x16_bf16 v[64:79], a[8:11], v[196:199], v[64:79]
  ds_read_b64_tr_b16 a[0:1], v17 offset:8192
  ds_read_b64_tr_b16 a[2:3], v17 offset:8704
  v_mfma_f32_32x32x16_bf16 v[80:95], a[12:15], v[196:199], v[80:95]
  ds_read_b64_tr_b16 a[4:5], v18 offset:8192
  ds_read_b64_tr_b16 a[6:7], v18 offset:8704
  s_waitcnt lgkmcnt(8)
  v_mfma_f32_32x32x16_bf16 v[64:79], a[16:19], v[200:203], v[64:79]
  ds_read_b64_tr_b16 a[8:9], v17 offset:10240
  ds_read_b64_tr_b16 a[10:11], v17 offset:10752
  v_mfma_f32_32x32x16_bf16 v[80:95], a[20:23], v[200:203], v[80:95]
  ds_read_b64_tr_b16 a[12:13], v18 offset:10240
  ds_read_b64_tr_b16 a[14:15], v18 offset:10752
  s_waitcnt lgkmcnt(8)
  v_mfma_f32_32x32x16_bf16 v[64:79], a[24:27], v[204:207], v[64:79]
  ds_read_b64_tr_b16 a[16:17], v17 offset:12288
  ds_read_b64_tr_b16 a[18:19], v17 offset:12800
  v_mfma_f32_32x32x16_bf16 v[80:95], a[28:31], v[204:207], v[80:95]
  ds_read_b64_tr_b16 a[20:21], v18 offset:12288
  ds_read_b64_tr_b16 a[22:23], v18 offset:12800
  s_add_u32 s6, s57, 8192
  buffer_load_dwordx4 v[192:195], v1, s[36:39], s6 offen sc1
  buffer_load_dwordx4 v[196:199], v1, s[36:39], s6 offen offset:1024 sc1
  buffer_load_dwordx4 v[200:203], v1, s[36:39], s6 offen offset:2048 sc1
  buffer_load_dwordx4 v[204:207], v1, s[36:39], s6 offen offset:3072 sc1
  s_waitcnt lgkmcnt(8)
  v_mfma_f32_32x32x16_bf16 v[64:79], a[0:3], v[208:211], v[64:79]
  ds_read_b64_tr_b16 a[24:25], v17 offset:14336
  ds_read_b64_tr_b16 a[26:27], v17 offset:14848
  v_mfma_f32_32x32x16_bf16 v[80:95], a[4:7], v[208:211], v[80:95]
  ds_read_b64_tr_b16 a[28:29], v18 offset:14336
  ds_read_b64_tr_b16 a[30:31], v18 offset:14848
  s_cmp_eq_u32 s45, 0
  s_cselect_b32 s44, 1, 0
  s_waitcnt vmcnt(10)
  s_mov_b64 exec, 0xffff
  v_cmp_le_u32 vcc, s44, v31
  s_mov_b64 exec, -1
  s_nop 2
  s_cmp_eq_u64 vcc, 0xffff
  s_cbranch_scc0 L_Q_slow_4
L_Q_pback_5:
  s_waitcnt lgkmcnt(8)
  v_mfma_f32_32x32x16_bf16 v[64:79], a[8:11], v[212:215], v[64:79]
  s_barrier
  v_add_u32 v17, 49152, v14
  v_xor_b32 v18, 64, v17
  ds_read_b64_tr_b16 a[0:1], v17 offset:0
  ds_read_b64_tr_b16 a[2:3], v17 offset:512
  v_mfma_f32_32x32x16_bf16 v[80:95], a[12:15], v[212:215], v[80:95]
  ds_read_b64_tr_b16 a[4:5], v18 offset:0
  ds_read_b64_tr_b16 a[6:7], v18 offset:512
  buffer_load_dwordx4 v[96:99], v1, s[36:39], s68 offen sc1
  buffer_load_dwordx4 v[100:103], v1, s[36:39], s68 offen offset:1024 sc1
  buffer_load_dwordx4 v[104:107], v1, s[36:39], s68 offen offset:2048 sc1
  buffer_load_dwordx4 v[108:111], v1, s[36:39], s68 offen offset:3072 sc1
  v_bfe_u32 v57, v30, 4, 1
  v_xor_b32 v57, 1, v57
  v_lshlrev_b32 v57, 6, v57
  v_lshrrev_b32 v58, 5, v30
  v_lshl_add_u32 v57, v58, 4, v57
  s_add_u32 s6, s68, 4096
  buffer_load_dwordx4 v[112:115], v57, s[36:39], s6 offen offset:0 sc1
  buffer_load_dwordx4 v[116:119], v57, s[36:39], s6 offen offset:32 sc1
  buffer_load_dwordx4 v[120:123], v57, s[36:39], s6 offen offset:128 sc1
  buffer_load_dwordx4 v[124:127], v57, s[36:39], s6 offen offset:160 sc1
  s_waitcnt lgkmcnt(8)
  v_mfma_f32_32x32x16_bf16 v[64:79], a[16:19], v[216:219], v[64:79]
  ds_read_b64_tr_b16 a[8:9], v17 offset:2048
  ds_read_b64_tr_b16 a[10:11], v17 offset:2560
  v_mfma_f32_32x32x16_bf16 v[80:95], a[20:23], v[216:219], v[80:95]
  ds_read_b64_tr_b16 a[12:13], v18 offset:2048
  ds_read_b64_tr_b16 a[14:15], v18 offset:2560
  s_waitcnt lgkmcnt(8)
  v_mfma_f32_32x32x16_bf16 v[64:79], a[24:27], v[220:223], v[64:79]
  ds_read_b64_tr_b16 a[16:17], v17 offset:4096
  ds_read_b64_tr_b16 a[18:19], v17 offset:4608
  v_mfma_f32_32x32x16_bf16 v[80:95], a[28:31], v[220:223], v[80:95]
  ds_read_b64_tr_b16 a[20:21], v18 offset:4096
  ds_read_b64_tr_b16 a[22:23], v18 offset:4608
  s_add_u32 s6, s57, 12288
  buffer_load_dwordx4 v[208:211], v1, s[36:39], s6 offen sc1
  buffer_load_dwordx4 v[212:215], v1, s[36:39], s6 offen offset:1024 sc1
  buffer_load_dwordx4 v[216:219], v1, s[36:39], s6 offen offset:2048 sc1
  buffer_load_dwordx4 v[220:223], v1, s[36:39], s6 offen offset:3072 sc1
  s_add_u32 s6, s74, 2048
  buffer_load_dword v6, v0, s[36:39], s6 offen sc1
  buffer_load_dword v7, v0, s[36:39], s6 offen offset:256 sc1
  s_waitcnt lgkmcnt(8)
  v_mfma_f32_32x32x16_bf16 v[64:79], a[0:3], v[224:227], v[64:79]
  ds_read_b64_tr_b16 a[24:25], v17 offset:6144
  ds_read_b64_tr_b16 a[26:27], v17 offset:6656
  v_mfma_f32_32x32x16_bf16 v[80:95], a[4:7], v[224:227], v[80:95]
  ds_read_b64_tr_b16 a[28:29], v18 offset:6144
  ds_read_b64_tr_b16 a[30:31], v18 offset:6656
  s_waitcnt lgkmcnt(8)
  v_mfma_f32_32x32x16_bf16 v[64:79], a[8:11], v[228:231], v[64:79]
  ds_read_b64_tr_b16 a[0:1], v17 offset:8192
  ds_read_b64_tr_b16 a[2:3], v17 offset:8704
  v_mfma_f32_32x32x16_bf16 v[80:95], a[12:15], v[228:231], v[80:95]
  ds_read_b64_tr_b16 a[4:5], v18 offset:8192
  ds_read_b64_tr_b16 a[6:7], v18 offset:8704
  s_waitcnt lgkmcnt(8)
  v_mfma_f32_32x32x16_bf16 v[64:79], a[16:19], v[232:235], v[64:79]
  ds_read_b64_tr_b16 a[8:9], v17 offset:10240
  ds_read_b64_tr_b16 a[10:11], v17 offset:10752
  v_mfma_f32_32x32x16_bf16 v[80:95], a[20:23], v[232:235], v[80:95]
  ds_read_b64_tr_b16 a[12:13], v18 offset:10240
  ds_read_b64_tr_b16 a[14:15], v18 offset:10752
  s_waitcnt lgkmcnt(8)
  v_mfma_f32_32x32x16_bf16 v[64:79], a[24:27], v[236:239], v[64:79]
  ds_read_b64_tr_b16 a[16:17], v17 offset:12288
  ds_read_b64_tr_b16 a[18:19], v17 offset:12800
  v_mfma_f32_32x32x16_bf16 v[80:95], a[28:31], v[236:239], v[80:95]
  ds_read_b64_tr_b16 a[20:21], v18 offset:12288
  ds_read_b64_tr_b16 a[22:23], v18 offset:12800
  s_add_u32 s6, s57, 49152
  buffer_load_dwordx4 v[224:227], v1, s[36:39], s6 offen sc1
  buffer_load_dwordx4 v[228:231], v1, s[36:39], s6 offen offset:1024 sc1
  buffer_load_dwordx4 v[232:235], v1, s[36:39], s6 offen offset:2048 sc1
  buffer_load_dwordx4 v[236:239], v1, s[36:39], s6 offen offset:3072 sc1
  s_waitcnt lgkmcnt(8)
  v_mfma_f32_32x32x16_bf16 v[64:79], a[0:3], v[240:243], v[64:79]
  ds_read_b64_tr_b16 a[24:25], v17 offset:14336
  ds_read_b64_tr_b16 a[26:27], v17 offset:14848
  v_mfma_f32_32x32x16_bf16 v[80:95], a[4:7], v[240:243], v[80:95]
  ds_read_b64_tr_b16 a[28:29], v18 offset:14336
  ds_read_b64_tr_b16 a[30:31], v18 offset:14848
  s_waitcnt lgkmcnt(8)
  v_mfma_f32_32x32x16_bf16 v[64:79], a[8:11], v[244:247], v[64:79]
  v_mfma_f32_32x32x16_bf16 v[80:95], a[12:15], v[244:247], v[80:95]
  s_waitcnt lgkmcnt(4)
  v_mfma_f32_32x32x16_bf16 v[64:79], a[16:19], v[248:251], v[64:79]
  v_mfma_f32_32x32x16_bf16 v[80:95], a[20:23], v[248:251], v[80:95]
  s_waitcnt lgkmcnt(0)
  v_mfma_f32_32x32x16_bf16 v[64:79], a[24:27], v[252:255], v[64:79]
  v_mfma_f32_32x32x16_bf16 v[80:95], a[28:31], v[252:255], v[80:95]
  s_add_u32 s6, s57, 53248
  buffer_load_dwordx4 v[240:243], v1, s[36:39], s6 offen sc1
  buffer_load_dwordx4 v[244:247], v1, s[36:39], s6 offen offset:1024 sc1
  buffer_load_dwordx4 v[248:251], v1, s[36:39], s6 offen offset:2048 sc1
  buffer_load_dwordx4 v[252:255], v1, s[36:39], s6 offen offset:3072 sc1
  s_add_u32 s6, s74, 12288
  buffer_load_dword v8, v0, s[36:39], s6 offen sc1
  buffer_load_dword v9, v0, s[36:39], s6 offen offset:256 sc1
  v_mov_b32 v62, 0x3fb8aa3b
  v_mov_b32 v63, 0x358637bd
  s_nop 0
  v_pk_mul_f32 v[26:27], v[64:65], v[62:63] op_sel_hi:[1,0]
  v_pk_mul_f32 v[28:29], v[66:67], v[62:63] op_sel_hi:[1,0]
  v_exp_f32 v26, v26 clamp
  v_exp_f32 v27, v27 clamp
  v_exp_f32 v28, v28 clamp
  v_exp_f32 v29, v29 clamp
  v_max_f32 v64, 0, v64
  v_max_f32 v65, 0, v65
  v_max_f32 v66, 0, v66
  v_max_f32 v67, 0, v67
  v_pk_add_f32 v[26:27], v[26:27], v[62:63] op_sel:[0,1] op_sel_hi:[1,1]
  v_pk_add_f32 v[28:29], v[28:29], v[62:63] op_sel:[0,1] op_sel_hi:[1,1]
  v_pk_add_f32 v[64:65], v[64:65], v[26:27]
  v_pk_add_f32 v[66:67], v[66:67], v[28:29]
  v_pk_mul_f32 v[26:27], v[68:69], v[62:63] op_sel_hi:[1,0]
  v_pk_mul_f32 v[28:29], v[70:71], v[62:63] op_sel_hi:[1,0]
  v_exp_f32 v26, v26 clamp
  v_exp_f32 v27, v27 clamp
  v_exp_f32 v28, v28 clamp
  v_exp_f32 v29, v29 clamp
  v_max_f32 v68, 0, v68
  v_max_f32 v69, 0, v69
  v_max_f32 v70, 0, v70
  v_max_f32 v71, 0, v71
  v_pk_add_f32 v[26:27], v[26:27], v[62:63] op_sel:[0,1] op_sel_hi:[1,1]
  v_pk_add_f32 v[28:29], v[28:29], v[62:63] op_sel:[0,1] op_sel_hi:[1,1]
  v_pk_add_f32 v[68:69], v[68:69], v[26:27]
  v_pk_add_f32 v[70:71], v[70:71], v[28:29]
  v_pk_mul_f32 v[26:27], v[72:73], v[62:63] op_sel_hi:[1,0]
  v_pk_mul_f32 v[28:29], v[74:75], v[62:63] op_sel_hi:[1,0]
  v_exp_f32 v26, v26 clamp
  v_exp_f32 v27, v27 clamp
  v_exp_f32 v28, v28 clamp
  v_exp_f32 v29, v29 clamp
  v_max_f32 v72, 0, v72
  v_max_f32 v73, 0, v73
  v_max_f32 v74, 0, v74
  v_max_f32 v75, 0, v75
  v_pk_add_f32 v[26:27], v[26:27], v[62:63] op_sel:[0,1] op_sel_hi:[1,1]
  v_pk_add_f32 v[28:29], v[28:29], v[62:63] op_sel:[0,1] op_sel_hi:[1,1]
  v_pk_add_f32 v[72:73], v[72:73], v[26:27]
  v_pk_add_f32 v[74:75], v[74:75], v[28:29]
  v_pk_mul_f32 v[26:27], v[76:77], v[62:63] op_sel_hi:[1,0]
  v_pk_mul_f32 v[28:29], v[78:79], v[62:63] op_sel_hi:[1,0]
  v_exp_f32 v26, v26 clamp
  v_exp_f32 v27, v27 clamp
  v_exp_f32 v28, v28 clamp
  v_exp_f32 v29, v29 clamp
  v_max_f32 v76, 0, v76
  v_max_f32 v77, 0, v77
  v_max_f32 v78, 0, v78
  v_max_f32 v79, 0, v79
  v_pk_add_f32 v[26:27], v[26:27], v[62:63] op_sel:[0,1] op_sel_hi:[1,1]
  v_pk_add_f32 v[28:29], v[28:29], v[62:63] op_sel:[0,1] op_sel_hi:[1,1]
  v_pk_add_f32 v[76:77], v[76:77], v[26:27]
  v_pk_add_f32 v[78:79], v[78:79], v[28:29]
  v_cvt_pk_bf16_f32 v32, v64, v65
  v_cvt_pk_bf16_f32 v33, v66, v67
  v_cvt_pk_bf16_f32 v34, v68, v69
  v_cvt_pk_bf16_f32 v35, v70, v71
  v_cvt_pk_bf16_f32 v36, v72, v73
  v_cvt_pk_bf16_f32 v37, v74, v75
  v_cvt_pk_bf16_f32 v38, v76, v77
  v_cvt_pk_bf16_f32 v39, v78, v79
  v_pk_mul_f32 v[26:27], v[80:81], v[62:63] op_sel_hi:[1,0]
  v_pk_mul_f32 v[28:29], v[82:83], v[62:63] op_sel_hi:[1,0]
  v_exp_f32 v26, v26 clamp
  v_exp_f32 v27, v27 clamp
  v_exp_f32 v28, v28 clamp
  v_exp_f32 v29, v29 clamp
  v_max_f32 v80, 0, v80
  v_max_f32 v81, 0, v81
  v_max_f32 v82, 0, v82
  v_max_f32 v83, 0, v83
  v_pk_add_f32 v[26:27], v[26:27], v[62:63] op_sel:[0,1] op_sel_hi:[1,1]
  v_pk_add_f32 v[28:29], v[28:29], v[62:63] op_sel:[0,1] op_sel_hi:[1,1]
  v_pk_add_f32 v[80:81], v[80:81], v[26:27]
  v_pk_add_f32 v[82:83], v[82:83], v[28:29]
  v_pk_mul_f32 v[26:27], v[84:85], v[62:63] op_sel_hi:[1,0]
  v_pk_mul_f32 v[28:29], v[86:87], v[62:63] op_sel_hi:[1,0]
  v_exp_f32 v26, v26 clamp
  v_exp_f32 v27, v27 clamp
  v_exp_f32 v28, v28 clamp
  v_exp_f32 v29, v29 clamp
  v_max_f32 v84, 0, v84
  v_max_f32 v85, 0, v85
  v_max_f32 v86, 0, v86
  v_max_f32 v87, 0, v87
  v_pk_add_f32 v[26:27], v[26:27], v[62:63] op_sel:[0,1] op_sel_hi:[1,1]
  v_pk_add_f32 v[28:29], v[28:29], v[62:63] op_sel:[0,1] op_sel_hi:[1,1]
  v_pk_add_f32 v[84:85], v[84:85], v[26:27]
  v_pk_add_f32 v[86:87], v[86:87], v[28:29]
  v_pk_mul_f32 v[26:27], v[88:89], v[62:63] op_sel_hi:[1,0]
  v_pk_mul_f32 v[28:29], v[90:91], v[62:63] op_sel_hi:[1,0]
  v_exp_f32 v26, v26 clamp
  v_exp_f32 v27, v27 clamp
  v_exp_f32 v28, v28 clamp
  v_exp_f32 v29, v29 clamp
  v_max_f32 v88, 0, v88
  v_max_f32 v89, 0, v89
  v_max_f32 v90, 0, v90
  v_max_f32 v91, 0, v91
  v_pk_add_f32 v[26:27], v[26:27], v[62:63] op_sel:[0,1] op_sel_hi:[1,1]
  v_pk_add_f32 v[28:29], v[28:29], v[62:63] op_sel:[0,1] op_sel_hi:[1,1]
  v_pk_add_f32 v[88:89], v[88:89], v[26:27]
  v_pk_add_f32 v[90:91], v[90:91], v[28:29]
  v_pk_mul_f32 v[26:27], v[92:93], v[62:63] op_sel_hi:[1,0]
  v_pk_mul_f32 v[28:29], v[94:95], v[62:63] op_sel_hi:[1,0]
  v_exp_f32 v26, v26 clamp
  v_exp_f32 v27, v27 clamp
  v_exp_f32 v28, v28 clamp
  v_exp_f32 v29, v29 clamp
  v_max_f32 v92, 0, v92
  v_max_f32 v93, 0, v93
  v_max_f32 v94, 0, v94
  v_max_f32 v95, 0, v95
  v_pk_add_f32 v[26:27], v[26:27], v[62:63] op_sel:[0,1] op_sel_hi:[1,1]
  v_pk_add_f32 v[28:29], v[28:29], v[62:63] op_sel:[0,1] op_sel_hi:[1,1]
  v_pk_add_f32 v[92:93], v[92:93], v[26:27]
  v_pk_add_f32 v[94:95], v[94:95], v[28:29]
  v_cvt_pk_bf16_f32 v40, v80, v81
  v_cvt_pk_bf16_f32 v41, v82, v83
  v_cvt_pk_bf16_f32 v42, v84, v85
  v_cvt_pk_bf16_f32 v43, v86, v87
  v_cvt_pk_bf16_f32 v44, v88, v89
  v_cvt_pk_bf16_f32 v45, v90, v91
  v_cvt_pk_bf16_f32 v46, v92, v93
  v_cvt_pk_bf16_f32 v47, v94, v95
  s_waitcnt vmcnt(16)
  v_cvt_pk_bf16_f32 v96, v96, v97
  v_cvt_pk_bf16_f32 v97, v98, v99
  v_cvt_pk_bf16_f32 v98, v100, v101
  v_cvt_pk_bf16_f32 v99, v102, v103
  v_cvt_pk_bf16_f32 v112, v112, v113
  v_cvt_pk_bf16_f32 v113, v114, v115
  v_cvt_pk_bf16_f32 v114, v116, v117
  v_cvt_pk_bf16_f32 v115, v118, v119
  v_cndmask_b32 v100, v112, v96, s[84:85]
  v_cndmask_b32 v116, v96, v112, s[84:85]
  v_cndmask_b32 v101, v113, v97, s[84:85]
  v_cndmask_b32 v117, v97, v113, s[84:85]
  v_cndmask_b32 v102, v114, v98, s[84:85]
  v_cndmask_b32 v118, v98, v114, s[84:85]
  v_cndmask_b32 v103, v115, v99, s[84:85]
  v_cndmask_b32 v119, v99, v115, s[84:85]
  v_cvt_pk_bf16_f32 v104, v104, v105
  v_cvt_pk_bf16_f32 v105, v106, v107
  v_cvt_pk_bf16_f32 v106, v108, v109
  v_cvt_pk_bf16_f32 v107, v110, v111
  v_cvt_pk_bf16_f32 v120, v120, v121
  v_cvt_pk_bf16_f32 v121, v122, v123
  v_cvt_pk_bf16_f32 v122, v124, v125
  v_cvt_pk_bf16_f32 v123, v126, v127
  v_cndmask_b32 v108, v120, v104, s[84:85]
  v_cndmask_b32 v124, v104, v120, s[84:85]
  v_cndmask_b32 v109, v121, v105, s[84:85]
  v_cndmask_b32 v125, v105, v121, s[84:85]
  v_cndmask_b32 v110, v122, v106, s[84:85]
  v_cndmask_b32 v126, v106, v122, s[84:85]
  v_cndmask_b32 v111, v123, v107, s[84:85]
  v_cndmask_b32 v127, v107, v123, s[84:85]
  v_mfma_f32_32x32x16_bf16 v[64:79], v[100:103], v[32:35], 0
  v_mfma_f32_32x32x16_bf16 v[80:95], v[116:119], v[36:39], 0
  s_nop 10
  v_add_f32 v26, 0x358637bd, v72
  v_rcp_f32 v26, v26
  s_nop 0
  v_pk_mul_f32 v[64:65], v[64:65], v[26:27] op_sel_hi:[1,0]
  v_pk_mul_f32 v[66:67], v[66:67], v[26:27] op_sel_hi:[1,0]
  v_pk_mul_f32 v[68:69], v[68:69], v[26:27] op_sel_hi:[1,0]
  v_pk_mul_f32 v[70:71], v[70:71], v[26:27] op_sel_hi:[1,0]
  v_cvt_pk_bf16_f32 v48, v64, v65
  v_cvt_pk_bf16_f32 v49, v66, v67
  v_cvt_pk_bf16_f32 v50, v68, v69
  v_cvt_pk_bf16_f32 v51, v70, v71
  buffer_store_dwordx4 v[48:51], v1, s[36:39], s56 offen sc1
  v_add_f32 v26, 0x358637bd, v80
  v_rcp_f32 v26, v26
  s_nop 0
  v_pk_mul_f32 v[88:89], v[88:89], v[26:27] op_sel_hi:[1,0]
  v_pk_mul_f32 v[90:91], v[90:91], v[26:27] op_sel_hi:[1,0]
  v_pk_mul_f32 v[92:93], v[92:93], v[26:27] op_sel_hi:[1,0]
  v_pk_mul_f32 v[94:95], v[94:95], v[26:27] op_sel_hi:[1,0]
  v_cvt_pk_bf16_f32 v52, v88, v89
  v_cvt_pk_bf16_f32 v53, v90, v91
  v_cvt_pk_bf16_f32 v54, v92, v93
  v_cvt_pk_bf16_f32 v55, v94, v95
  buffer_store_dwordx4 v[52:55], v1, s[36:39], s56 offen offset:2048 sc1
  v_mfma_f32_32x32x16_bf16 v[64:79], v[108:111], v[40:43], 0
  v_mfma_f32_32x32x16_bf16 v[80:95], v[124:127], v[44:47], 0
  s_nop 10
  v_add_f32 v26, 0x358637bd, v72
  v_rcp_f32 v26, v26
  s_nop 0
  v_pk_mul_f32 v[64:65], v[64:65], v[26:27] op_sel_hi:[1,0]
  v_pk_mul_f32 v[66:67], v[66:67], v[26:27] op_sel_hi:[1,0]
  v_pk_mul_f32 v[68:69], v[68:69], v[26:27] op_sel_hi:[1,0]
  v_pk_mul_f32 v[70:71], v[70:71], v[26:27] op_sel_hi:[1,0]
  v_cvt_pk_bf16_f32 v56, v64, v65
  v_cvt_pk_bf16_f32 v57, v66, v67
  v_cvt_pk_bf16_f32 v58, v68, v69
  v_cvt_pk_bf16_f32 v59, v70, v71
  s_add_u32 s7, s56, 4096
  buffer_store_dwordx4 v[56:59], v1, s[36:39], s7 offen sc1
  v_add_f32 v26, 0x358637bd, v80
  v_rcp_f32 v26, v26
  s_nop 0
  v_pk_mul_f32 v[88:89], v[88:89], v[26:27] op_sel_hi:[1,0]
  v_pk_mul_f32 v[90:91], v[90:91], v[26:27] op_sel_hi:[1,0]
  v_pk_mul_f32 v[92:93], v[92:93], v[26:27] op_sel_hi:[1,0]
  v_pk_mul_f32 v[94:95], v[94:95], v[26:27] op_sel_hi:[1,0]
  v_cvt_pk_bf16_f32 v60, v88, v89
  v_cvt_pk_bf16_f32 v61, v90, v91
  v_cvt_pk_bf16_f32 v62, v92, v93
  v_cvt_pk_bf16_f32 v63, v94, v95
  buffer_store_dwordx4 v[60:63], v1, s[36:39], s7 offen offset:2048 sc1
  v_bitop3_b32 v26, v48, v49, s72 bitop3:0x96
  v_bitop3_b32 v26, v50, v51, v26 bitop3:0x96
  v_bitop3_b32 v26, v52, v53, v26 bitop3:0x96
  v_bitop3_b32 v26, v54, v55, v26 bitop3:0x96
  v_bitop3_b32 v26, v56, v57, v26 bitop3:0x96
  v_bitop3_b32 v26, v58, v59, v26 bitop3:0x96
  v_bitop3_b32 v26, v60, v61, v26 bitop3:0x96
  v_bitop3_b32 v26, v62, v63, v26 bitop3:0x96
  s_sub_u32 s6, s56, s53
  s_lshr_b32 s6, s6, 2
  s_add_u32 s6, s6, s73
  buffer_store_dword v26, v0, s[36:39], s6 offen sc1
  v_lshrrev_b32 v32, 3, v30
  v_lshlrev_b32 v32, 10, v32
  v_and_b32 v33, 7, v30
  v_lshl_add_u32 v32, v33, 4, v32
  s_lshl_b32 s7, s62, 16
  s_lshl_b32 s44, s45, 14
  s_add_u32 s7, s7, s44
  s_lshl_b32 s44, s63, 7
  s_add_u32 s75, s7, s44
  s_add_u32 s7, s75, 4096
  buffer_load_dwordx4 v[48:51], v32, s[8:11], s7 offen
  s_add_u32 s7, s7, 8192
  buffer_load_dwordx4 v[52:55], v32, s[8:11], s7 offen
  v_bitop3_b32 v36, v128, v129, v130 bitop3:0x96
  v_bitop3_b32 v37, v145, v146, v147 bitop3:0x96
  v_bitop3_b32 v36, v131, v132, v36 bitop3:0x96
  v_bitop3_b32 v37, v148, v149, v37 bitop3:0x96
  v_bitop3_b32 v36, v133, v134, v36 bitop3:0x96
  v_bitop3_b32 v37, v150, v151, v37 bitop3:0x96
  v_bitop3_b32 v36, v135, v136, v36 bitop3:0x96
  v_bitop3_b32 v37, v152, v153, v37 bitop3:0x96
  v_bitop3_b32 v36, v137, v138, v36 bitop3:0x96
  v_bitop3_b32 v37, v154, v155, v37 bitop3:0x96
  v_bitop3_b32 v36, v139, v140, v36 bitop3:0x96
  v_bitop3_b32 v37, v156, v157, v37 bitop3:0x96
  v_bitop3_b32 v36, v141, v142, v36 bitop3:0x96
  v_bitop3_b32 v37, v158, v159, v37 bitop3:0x96
  v_bitop3_b32 v36, v143, v144, v36 bitop3:0x96
  v_bitop3_b32 v37, v2, v3, v37 bitop3:0x96
  v_bitop3_b32 v36, v36, v37, s76 bitop3:0x96
  v_cmp_ne_u32 vcc, 0, v36
  s_nop 3
  s_cbranch_vccnz L_Q_bad_7
L_Q_back_8:
  v_mfma_f32_32x32x16_bf16 v[64:79], a[32:35], v[128:131], 0
  v_mfma_f32_32x32x16_bf16 v[80:95], a[32:35], v[132:135], 0
  v_mfma_f32_32x32x16_bf16 v[96:111], a[36:39], v[128:131], 0
  v_mfma_f32_32x32x16_bf16 v[112:127], a[36:39], v[132:135], 0
  v_mfma_f32_32x32x16_bf16 v[64:79], a[40:43], v[136:139], v[64:79]
  v_mfma_f32_32x32x16_bf16 v[80:95], a[40:43], v[140:143], v[80:95]
  s_add_u32 s86, s57, 16384
  buffer_load_dwordx4 v[128:131], v1, s[36:39], s86 offen sc1
  v_mfma_f32_32x32x16_bf16 v[96:111], a[44:47], v[136:139], v[96:111]
  v_mfma_f32_32x32x16_bf16 v[112:127], a[44:47], v[140:143], v[112:127]
  buffer_load_dwordx4 v[132:135], v1, s[36:39], s86 offen offset:1024 sc1
  v_mfma_f32_32x32x16_bf16 v[64:79], a[48:51], v[144:147], v[64:79]
  v_bitop3_b32 v38, v160, v161, v162 bitop3:0x96
  v_bitop3_b32 v39, v177, v178, v179 bitop3:0x96
  v_mfma_f32_32x32x16_bf16 v[80:95], a[48:51], v[148:151], v[80:95]
  buffer_load_dwordx4 v[136:139], v1, s[36:39], s86 offen offset:2048 sc1
  v_bitop3_b32 v38, v163, v164, v38 bitop3:0x96
  v_bitop3_b32 v39, v180, v181, v39 bitop3:0x96
  v_bitop3_b32 v38, v165, v166, v38 bitop3:0x96
  v_mfma_f32_32x32x16_bf16 v[96:111], a[52:55], v[144:147], v[96:111]
  v_bitop3_b32 v39, v182, v183, v39 bitop3:0x96
  v_bitop3_b32 v38, v167, v168, v38 bitop3:0x96
  v_mfma_f32_32x32x16_bf16 v[112:127], a[52:55], v[148:151], v[112:127]
  buffer_load_dwordx4 v[140:143], v1, s[36:39], s86 offen offset:3072 sc1
  v_bitop3_b32 v39, v184, v185, v39 bitop3:0x96
  v_bitop3_b32 v38, v169, v170, v38 bitop3:0x96
  v_mfma_f32_32x32x16_bf16 v[64:79], a[56:59], v[152:155], v[64:79]
  v_bitop3_b32 v39, v186, v187, v39 bitop3:0x96
  v_bitop3_b32 v38, v171, v172, v38 bitop3:0x96
  v_mfma_f32_32x32x16_bf16 v[80:95], a[56:59], v[156:159], v[80:95]
  s_add_u32 s86, s57, 20480
  buffer_load_dwordx4 v[144:147], v1, s[36:39], s86 offen sc1
  v_bitop3_b32 v39, v188, v189, v39 bitop3:0x96
  v_bitop3_b32 v38, v173, v174, v38 bitop3:0x96
  v_mfma_f32_32x32x16_bf16 v[96:111], a[60:63], v[152:155], v[96:111]
  v_bitop3_b32 v39, v190, v191, v39 bitop3:0x96
  v_bitop3_b32 v38, v175, v176, v38 bitop3:0x96
  v_mfma_f32_32x32x16_bf16 v[112:127], a[60:63], v[156:159], v[112:127]
  buffer_load_dwordx4 v[148:151], v1, s[36:39], s86 offen offset:1024 sc1
  v_bitop3_b32 v39, v4, v5, v39 bitop3:0x96
  v_bitop3_b32 v38, v38, v39, s79 bitop3:0x96
  v_cmp_ne_u32 vcc, 0, v38
  s_nop 3
  s_cbranch_vccnz L_Q_bad_10
L_Q_back_11:
  v_mfma_f32_32x32x16_bf16 v[64:79], a[64:67], v[160:163], v[64:79]
  v_mfma_f32_32x32x16_bf16 v[80:95], a[64:67], v[164:167], v[80:95]
  buffer_load_dwordx4 v[152:155], v1, s[36:39], s86 offen offset:2048 sc1
  v_mfma_f32_32x32x16_bf16 v[96:111], a[68:71], v[160:163], v[96:111]
  v_mfma_f32_32x32x16_bf16 v[112:127], a[68:71], v[164:167], v[112:127]
  buffer_load_dwordx4 v[156:159], v1, s[36:39], s86 offen offset:3072 sc1
  v_mfma_f32_32x32x16_bf16 v[64:79], a[72:75], v[168:171], v[64:79]
  v_mfma_f32_32x32x16_bf16 v[80:95], a[72:75], v[172:175], v[80:95]
  s_add_u32 s6, s74, 4096
  buffer_load_dword v10, v0, s[36:39], s6 offen sc1
  buffer_load_dword v11, v0, s[36:39], s6 offen offset:256 sc1
  s_add_u32 s86, s57, 32768
  buffer_load_dwordx4 v[160:163], v1, s[36:39], s86 offen sc1
  v_mfma_f32_32x32x16_bf16 v[96:111], a[76:79], v[168:171], v[96:111]
  v_mfma_f32_32x32x16_bf16 v[112:127], a[76:79], v[172:175], v[112:127]
  buffer_load_dwordx4 v[164:167], v1, s[36:39], s86 offen offset:1024 sc1
  v_mfma_f32_32x32x16_bf16 v[64:79], a[80:83], v[176:179], v[64:79]
  s_waitcnt vmcnt(29)
  v_bitop3_b32 v36, v192, v193, v194 bitop3:0x96
  v_bitop3_b32 v37, v209, v210, v211 bitop3:0x96
  v_mfma_f32_32x32x16_bf16 v[80:95], a[80:83], v[180:183], v[80:95]
  buffer_load_dwordx4 v[168:171], v1, s[36:39], s86 offen offset:2048 sc1
  v_bitop3_b32 v36, v195, v196, v36 bitop3:0x96
  v_bitop3_b32 v37, v212, v213, v37 bitop3:0x96
  v_bitop3_b32 v36, v197, v198, v36 bitop3:0x96
  v_mfma_f32_32x32x16_bf16 v[96:111], a[84:87], v[176:179], v[96:111]
  v_bitop3_b32 v37, v214, v215, v37 bitop3:0x96
  v_bitop3_b32 v36, v199, v200, v36 bitop3:0x96
  v_mfma_f32_32x32x16_bf16 v[112:127], a[84:87], v[180:183], v[112:127]
  buffer_load_dwordx4 v[172:175], v1, s[36:39], s86 offen offset:3072 sc1
  v_bitop3_b32 v37, v216, v217, v37 bitop3:0x96
  v_bitop3_b32 v36, v201, v202, v36 bitop3:0x96
  v_mfma_f32_32x32x16_bf16 v[64:79], a[88:91], v[184:187], v[64:79]
  v_bitop3_b32 v37, v218, v219, v37 bitop3:0x96
  v_bitop3_b32 v36, v203, v204, v36 bitop3:0x96
  v_mfma_f32_32x32x16_bf16 v[80:95], a[88:91], v[188:191], v[80:95]
  s_add_u32 s86, s57, 36864
  buffer_load_dwordx4 v[176:179], v1, s[36:39], s86 offen sc1
  v_bitop3_b32 v37, v220, v221, v37 bitop3:0x96
  v_bitop3_b32 v36, v205, v206, v36 bitop3:0x96
  v_mfma_f32_32x32x16_bf16 v[96:111], a[92:95], v[184:187], v[96:111]
  v_bitop3_b32 v37, v222, v223, v37 bitop3:0x96
  v_bitop3_b32 v36, v207, v208, v36 bitop3:0x96
  v_mfma_f32_32x32x16_bf16 v[112:127], a[92:95], v[188:191], v[112:127]
  buffer_load_dwordx4 v[180:183], v1, s[36:39], s86 offen offset:1024 sc1
  v_bitop3_b32 v37, v6, v7, v37 bitop3:0x96
  v_bitop3_b32 v36, v36, v37, s76 bitop3:0x96
  v_cmp_ne_u32 vcc, 0, v36
  s_nop 3
  s_cbranch_vccnz L_Q_bad_13
L_Q_back_14:
  v_mfma_f32_32x32x16_bf16 v[64:79], a[96:99], v[192:195], v[64:79]
  v_mfma_f32_32x32x16_bf16 v[80:95], a[96:99], v[196:199], v[80:95]
  buffer_load_dwordx4 v[184:187], v1, s[36:39], s86 offen offset:2048 sc1
  v_mfma_f32_32x32x16_bf16 v[96:111], a[100:103], v[192:195], v[96:111]
  v_mfma_f32_32x32x16_bf16 v[112:127], a[100:103], v[196:199], v[112:127]
  buffer_load_dwordx4 v[188:191], v1, s[36:39], s86 offen offset:3072 sc1
  v_mfma_f32_32x32x16_bf16 v[64:79], a[104:107], v[200:203], v[64:79]
  v_mfma_f32_32x32x16_bf16 v[80:95], a[104:107], v[204:207], v[80:95]
  s_add_u32 s6, s74, 8192
  buffer_load_dword v12, v0, s[36:39], s6 offen sc1
  buffer_load_dword v13, v0, s[36:39], s6 offen offset:256 sc1
  s_add_u32 s86, s57, 24576
  buffer_load_dwordx4 v[192:195], v1, s[36:39], s86 offen sc1
  v_mfma_f32_32x32x16_bf16 v[96:111], a[108:111], v[200:203], v[96:111]
  v_mfma_f32_32x32x16_bf16 v[112:127], a[108:111], v[204:207], v[112:127]
  buffer_load_dwordx4 v[196:199], v1, s[36:39], s86 offen offset:1024 sc1
  v_mfma_f32_32x32x16_bf16 v[64:79], a[112:115], v[208:211], v[64:79]
  s_waitcnt vmcnt(29)
  v_bitop3_b32 v38, v224, v225, v226 bitop3:0x96
  v_bitop3_b32 v39, v241, v242, v243 bitop3:0x96
  v_mfma_f32_32x32x16_bf16 v[80:95], a[112:115], v[212:215], v[80:95]
  buffer_load_dwordx4 v[200:203], v1, s[36:39], s86 offen offset:2048 sc1
  v_bitop3_b32 v38, v227, v228, v38 bitop3:0x96
  v_bitop3_b32 v39, v244, v245, v39 bitop3:0x96
  v_bitop3_b32 v38, v229, v230, v38 bitop3:0x96
  v_mfma_f32_32x32x16_bf16 v[96:111], a[116:119], v[208:211], v[96:111]
  v_bitop3_b32 v39, v246, v247, v39 bitop3:0x96
  v_bitop3_b32 v38, v231, v232, v38 bitop3:0x96
  v_mfma_f32_32x32x16_bf16 v[112:127], a[116:119], v[212:215], v[112:127]
  buffer_load_dwordx4 v[204:207], v1, s[36:39], s86 offen offset:3072 sc1
  v_bitop3_b32 v39, v248, v249, v39 bitop3:0x96
  v_bitop3_b32 v38, v233, v234, v38 bitop3:0x96
  v_mfma_f32_32x32x16_bf16 v[64:79], a[120:123], v[216:219], v[64:79]
  v_bitop3_b32 v39, v250, v251, v39 bitop3:0x96
  v_bitop3_b32 v38, v235, v236, v38 bitop3:0x96
  v_mfma_f32_32x32x16_bf16 v[80:95], a[120:123], v[220:223], v[80:95]
  s_add_u32 s6, s74, 6144
  buffer_load_dword v2, v0, s[36:39], s6 offen sc1
  buffer_load_dword v3, v0, s[36:39], s6 offen offset:256 sc1
  s_add_u32 s86, s57, 28672
  buffer_load_dwordx4 v[208:211], v1, s[36:39], s86 offen sc1
  v_bitop3_b32 v39, v252, v253, v39 bitop3:0x96
  v_bitop3_b32 v38, v237, v238, v38 bitop3:0x96
  v_mfma_f32_32x32x16_bf16 v[96:111], a[124:127], v[216:219], v[96:111]
  v_bitop3_b32 v39, v254, v255, v39 bitop3:0x96
  v_bitop3_b32 v38, v239, v240, v38 bitop3:0x96
  v_mfma_f32_32x32x16_bf16 v[112:127], a[124:127], v[220:223], v[112:127]
  buffer_load_dwordx4 v[212:215], v1, s[36:39], s86 offen offset:1024 sc1
  v_bitop3_b32 v39, v8, v9, v39 bitop3:0x96
  v_bitop3_b32 v38, v38, v39, s79 bitop3:0x96
  v_cmp_ne_u32 vcc, 0, v38
  s_nop 3
  s_cbranch_vccnz L_Q_bad_16
L_Q_back_17:
  v_mfma_f32_32x32x16_bf16 v[64:79], a[128:131], v[224:227], v[64:79]
  v_mfma_f32_32x32x16_bf16 v[80:95], a[128:131], v[228:231], v[80:95]
  buffer_load_dwordx4 v[216:219], v1, s[36:39], s86 offen offset:2048 sc1
  v_mfma_f32_32x32x16_bf16 v[96:111], a[132:135], v[224:227], v[96:111]
  v_mfma_f32_32x32x16_bf16 v[112:127], a[132:135], v[228:231], v[112:127]
  buffer_load_dwordx4 v[220:223], v1, s[36:39], s86 offen offset:3072 sc1
  v_mfma_f32_32x32x16_bf16 v[64:79], a[136:139], v[232:235], v[64:79]
  v_mfma_f32_32x32x16_bf16 v[80:95], a[136:139], v[236:239], v[80:95]
  s_add_u32 s6, s74, 7168
  buffer_load_dword v4, v0, s[36:39], s6 offen sc1
  buffer_load_dword v5, v0, s[36:39], s6 offen offset:256 sc1
  s_add_u32 s86, s58, 0
  buffer_load_dwordx4 v[224:227], v1, s[36:39], s86 offen sc1
  v_mfma_f32_32x32x16_bf16 v[96:111], a[140:143], v[232:235], v[96:111]
  v_mfma_f32_32x32x16_bf16 v[112:127], a[140:143], v[236:239], v[112:127]
  buffer_load_dwordx4 v[228:231], v1, s[36:39], s86 offen offset:1024 sc1
  v_mfma_f32_32x32x16_bf16 v[64:79], a[144:147], v[240:243], v[64:79]
  s_waitcnt vmcnt(24)
  v_bitop3_b32 v36, v128, v129, v130 bitop3:0x96
  v_bitop3_b32 v37, v145, v146, v147 bitop3:0x96
  v_mfma_f32_32x32x16_bf16 v[80:95], a[144:147], v[244:247], v[80:95]
  buffer_load_dwordx4 v[232:235], v1, s[36:39], s86 offen offset:2048 sc1
  v_bitop3_b32 v36, v131, v132, v36 bitop3:0x96
  v_bitop3_b32 v37, v148, v149, v37 bitop3:0x96
  v_bitop3_b32 v36, v133, v134, v36 bitop3:0x96
  v_mfma_f32_32x32x16_bf16 v[96:111], a[148:151], v[240:243], v[96:111]
  v_bitop3_b32 v37, v150, v151, v37 bitop3:0x96
  v_bitop3_b32 v36, v135, v136, v36 bitop3:0x96
  v_mfma_f32_32x32x16_bf16 v[112:127], a[148:151], v[244:247], v[112:127]
  buffer_load_dwordx4 v[236:239], v1, s[36:39], s86 offen offset:3072 sc1
  v_bitop3_b32 v37, v152, v153, v37 bitop3:0x96
  v_bitop3_b32 v36, v137, v138, v36 bitop3:0x96
  v_mfma_f32_32x32x16_bf16 v[64:79], a[152:155], v[248:251], v[64:79]
  v_bitop3_b32 v37, v154, v155, v37 bitop3:0x96
  v_bitop3_b32 v36, v139, v140, v36 bitop3:0x96
  v_mfma_f32_32x32x16_bf16 v[80:95], a[152:155], v[252:255], v[80:95]
  s_add_u32 s86, s58, 4096
  buffer_load_dwordx4 v[240:243], v1, s[36:39], s86 offen sc1
  v_bitop3_b32 v37, v156, v157, v37 bitop3:0x96
  v_bitop3_b32 v36, v141, v142, v36 bitop3:0x96
  v_mfma_f32_32x32x16_bf16 v[96:111], a[156:159], v[248:251], v[96:111]
  v_bitop3_b32 v37, v158, v159, v37 bitop3:0x96
  v_bitop3_b32 v36, v143, v144, v36 bitop3:0x96
  v_mfma_f32_32x32x16_bf16 v[112:127], a[156:159], v[252:255], v[112:127]
  buffer_load_dwordx4 v[244:247], v1, s[36:39], s86 offen offset:1024 sc1
  v_bitop3_b32 v37, v10, v11, v37 bitop3:0x96
  v_bitop3_b32 v36, v36, v37, s77 bitop3:0x96
  v_cmp_ne_u32 vcc, 0, v36
  s_nop 3
  s_cbranch_vccnz L_Q_bad_19
L_Q_back_20:
  v_mfma_f32_32x32x16_bf16 v[64:79], a[160:163], v[128:131], v[64:79]
  v_mfma_f32_32x32x16_bf16 v[80:95], a[160:163], v[132:135], v[80:95]
  buffer_load_dwordx4 v[248:251], v1, s[36:39], s86 offen offset:2048 sc1
  v_mfma_f32_32x32x16_bf16 v[96:111], a[164:167], v[128:131], v[96:111]
  v_mfma_f32_32x32x16_bf16 v[112:127], a[164:167], v[132:135], v[112:127]
  buffer_load_dwordx4 v[252:255], v1, s[36:39], s86 offen offset:3072 sc1
  v_mfma_f32_32x32x16_bf16 v[64:79], a[168:171], v[136:139], v[64:79]
  v_mfma_f32_32x32x16_bf16 v[80:95], a[168:171], v[140:143], v[80:95]
  s_mul_i32 s7, s45, 10240
  s_sub_u32 s7, s74, s7
  s_add_u32 s6, s7, 57344
  buffer_load_dword v6, v0, s[36:39], s6 offen sc1
  buffer_load_dword v7, v0, s[36:39], s6 offen offset:256 sc1
  s_add_u32 s86, s58, 8192
  buffer_load_dwordx4 v[128:131], v1, s[36:39], s86 offen sc1
  v_mfma_f32_32x32x16_bf16 v[96:111], a[172:175], v[136:139], v[96:111]
  v_mfma_f32_32x32x16_bf16 v[112:127], a[172:175], v[140:143], v[112:127]
  buffer_load_dwordx4 v[132:135], v1, s[36:39], s86 offen offset:1024 sc1
  v_mfma_f32_32x32x16_bf16 v[64:79], a[176:179], v[144:147], v[64:79]
  s_waitcnt vmcnt(24)
  v_bitop3_b32 v38, v160, v161, v162 bitop3:0x96
  v_bitop3_b32 v39, v177, v178, v179 bitop3:0x96
  v_mfma_f32_32x32x16_bf16 v[80:95], a[176:179], v[148:151], v[80:95]
  buffer_load_dwordx4 v[136:139], v1, s[36:39], s86 offen offset:2048 sc1
  v_bitop3_b32 v38, v163, v164, v38 bitop3:0x96
  v_bitop3_b32 v39, v180, v181, v39 bitop3:0x96
  v_bitop3_b32 v38, v165, v166, v38 bitop3:0x96
  v_mfma_f32_32x32x16_bf16 v[96:111], a[180:183], v[144:147], v[96:111]
  v_bitop3_b32 v39, v182, v183, v39 bitop3:0x96
  v_bitop3_b32 v38, v167, v168, v38 bitop3:0x96
  v_mfma_f32_32x32x16_bf16 v[112:127], a[180:183], v[148:151], v[112:127]
  buffer_load_dwordx4 v[140:143], v1, s[36:39], s86 offen offset:3072 sc1
  v_bitop3_b32 v39, v184, v185, v39 bitop3:0x96
  v_bitop3_b32 v38, v169, v170, v38 bitop3:0x96
  v_mfma_f32_32x32x16_bf16 v[64:79], a[184:187], v[152:155], v[64:79]
  v_bitop3_b32 v39, v186, v187, v39 bitop3:0x96
  v_bitop3_b32 v38, v171, v172, v38 bitop3:0x96
  v_mfma_f32_32x32x16_bf16 v[80:95], a[184:187], v[156:159], v[80:95]
  s_add_u32 s86, s58, 12288
  buffer_load_dwordx4 v[144:147], v1, s[36:39], s86 offen sc1
  v_bitop3_b32 v39, v188, v189, v39 bitop3:0x96
  v_bitop3_b32 v38, v173, v174, v38 bitop3:0x96
  v_mfma_f32_32x32x16_bf16 v[96:111], a[188:191], v[152:155], v[96:111]
  v_bitop3_b32 v39, v190, v191, v39 bitop3:0x96
  v_bitop3_b32 v38, v175, v176, v38 bitop3:0x96
  v_mfma_f32_32x32x16_bf16 v[112:127], a[188:191], v[156:159], v[112:127]
  buffer_load_dwordx4 v[148:151], v1, s[36:39], s86 offen offset:1024 sc1
  v_bitop3_b32 v39, v12, v13, v39 bitop3:0x96
  v_bitop3_b32 v38, v38, v39, s78 bitop3:0x96
  v_cmp_ne_u32 vcc, 0, v38
  s_nop 3
  s_cbranch_vccnz L_Q_bad_22
L_Q_back_23:
  v_mfma_f32_32x32x16_bf16 v[64:79], a[192:195], v[160:163], v[64:79]
  v_mfma_f32_32x32x16_bf16 v[80:95], a[192:195], v[164:167], v[80:95]
  buffer_load_dwordx4 v[152:155], v1, s[36:39], s86 offen offset:2048 sc1
  v_mfma_f32_32x32x16_bf16 v[96:111], a[196:199], v[160:163], v[96:111]
  v_mfma_f32_32x32x16_bf16 v[112:127], a[196:199], v[164:167], v[112:127]
  buffer_load_dwordx4 v[156:159], v1, s[36:39], s86 offen offset:3072 sc1
  v_mfma_f32_32x32x16_bf16 v[64:79], a[200:203], v[168:171], v[64:79]
  v_mfma_f32_32x32x16_bf16 v[80:95], a[200:203], v[172:175], v[80:95]
  s_mul_i32 s7, s45, 10240
  s_sub_u32 s7, s74, s7
  s_add_u32 s6, s7, 59392
  buffer_load_dword v8, v0, s[36:39], s6 offen sc1
  buffer_load_dword v9, v0, s[36:39], s6 offen offset:256 sc1
  v_mfma_f32_32x32x16_bf16 v[96:111], a[204:207], v[168:171], v[96:111]
  v_mfma_f32_32x32x16_bf16 v[112:127], a[204:207], v[172:175], v[112:127]
  v_mfma_f32_32x32x16_bf16 v[64:79], a[208:211], v[176:179], v[64:79]
  s_waitcnt vmcnt(26)
  v_bitop3_b32 v36, v192, v193, v194 bitop3:0x96
  v_mfma_f32_32x32x16_bf16 v[80:95], a[208:211], v[180:183], v[80:95]
  v_bitop3_b32 v37, v201, v202, v203 bitop3:0x96
  v_bitop3_b32 v36, v195, v196, v36 bitop3:0x96
  v_mfma_f32_32x32x16_bf16 v[96:111], a[212:215], v[176:179], v[96:111]
  v_bitop3_b32 v37, v204, v205, v37 bitop3:0x96
  v_mfma_f32_32x32x16_bf16 v[112:127], a[212:215], v[180:183], v[112:127]
  v_bitop3_b32 v36, v197, v198, v36 bitop3:0x96
  v_mfma_f32_32x32x16_bf16 v[64:79], a[216:219], v[184:187], v[64:79]
  v_bitop3_b32 v37, v206, v207, v37 bitop3:0x96
  v_mfma_f32_32x32x16_bf16 v[80:95], a[216:219], v[188:191], v[80:95]
  v_bitop3_b32 v36, v199, v200, v36 bitop3:0x96
  v_mfma_f32_32x32x16_bf16 v[96:111], a[220:223], v[184:187], v[96:111]
  v_bitop3_b32 v37, v2, v3, v37 bitop3:0x96
  v_mfma_f32_32x32x16_bf16 v[112:127], a[220:223], v[188:191], v[112:127]
  v_bitop3_b32 v36, v36, v37, s77 bitop3:0x96
  v_cmp_ne_u32 vcc, 0, v36
  s_nop 3
  s_cbranch_vccnz L_Q_bad_25
L_Q_back_26:
  v_mfma_f32_32x32x16_bf16 v[64:79], a[224:227], v[192:195], v[64:79]
  s_waitcnt vmcnt(20)
  v_bitop3_b32 v38, v208, v209, v210 bitop3:0x96
  v_mfma_f32_32x32x16_bf16 v[80:95], a[224:227], v[196:199], v[80:95]
  v_bitop3_b32 v39, v217, v218, v219 bitop3:0x96
  v_bitop3_b32 v38, v211, v212, v38 bitop3:0x96
  v_mfma_f32_32x32x16_bf16 v[96:111], a[228:231], v[192:195], v[96:111]
  v_bitop3_b32 v39, v220, v221, v39 bitop3:0x96
  v_mfma_f32_32x32x16_bf16 v[112:127], a[228:231], v[196:199], v[112:127]
  v_bitop3_b32 v38, v213, v214, v38 bitop3:0x96
  v_mfma_f32_32x32x16_bf16 v[64:79], a[232:235], v[200:203], v[64:79]
  v_bitop3_b32 v39, v222, v223, v39 bitop3:0x96
  v_mfma_f32_32x32x16_bf16 v[80:95], a[232:235], v[204:207], v[80:95]
  v_bitop3_b32 v38, v215, v216, v38 bitop3:0x96
  v_mfma_f32_32x32x16_bf16 v[96:111], a[236:239], v[200:203], v[96:111]
  v_bitop3_b32 v39, v4, v5, v39 bitop3:0x96
  v_mfma_f32_32x32x16_bf16 v[112:127], a[236:239], v[204:207], v[112:127]
  v_bitop3_b32 v38, v38, v39, s78 bitop3:0x96
  v_cmp_ne_u32 vcc, 0, v38
  s_nop 3
  s_cbranch_vccnz L_Q_bad_28
L_Q_back_29:
  v_add_u32 v21, 131072, v16
  v_xor_b32 v22, 64, v21
  ds_read_b64_tr_b16 a[0:1], v21 offset:0
  ds_read_b64_tr_b16 a[2:3], v21 offset:1024
  ds_read_b64_tr_b16 a[4:5], v22 offset:0
  ds_read_b64_tr_b16 a[6:7], v22 offset:1024
  v_mfma_f32_32x32x16_bf16 v[64:79], a[240:243], v[208:211], v[64:79]
  s_waitcnt vmcnt(10)
  v_bitop3_b32 v36, v224, v225, v226 bitop3:0x96
  v_bitop3_b32 v37, v241, v242, v243 bitop3:0x96
  v_mfma_f32_32x32x16_bf16 v[80:95], a[240:243], v[212:215], v[80:95]
  v_bitop3_b32 v36, v227, v228, v36 bitop3:0x96
  v_bitop3_b32 v37, v244, v245, v37 bitop3:0x96
  v_bitop3_b32 v36, v229, v230, v36 bitop3:0x96
  v_mfma_f32_32x32x16_bf16 v[96:111], a[244:247], v[208:211], v[96:111]
  v_bitop3_b32 v37, v246, v247, v37 bitop3:0x96
  v_bitop3_b32 v36, v231, v232, v36 bitop3:0x96
  v_mfma_f32_32x32x16_bf16 v[112:127], a[244:247], v[212:215], v[112:127]
  v_bitop3_b32 v37, v248, v249, v37 bitop3:0x96
  v_bitop3_b32 v36, v233, v234, v36 bitop3:0x96
  ds_read_b64_tr_b16 a[8:9], v21 offset:2048
  ds_read_b64_tr_b16 a[10:11], v21 offset:3072
  ds_read_b64_tr_b16 a[12:13], v22 offset:2048
  ds_read_b64_tr_b16 a[14:15], v22 offset:3072
  v_mfma_f32_32x32x16_bf16 v[64:79], a[248:251], v[216:219], v[64:79]
  v_bitop3_b32 v37, v250, v251, v37 bitop3:0x96
  v_bitop3_b32 v36, v235, v236, v36 bitop3:0x96
  v_mfma_f32_32x32x16_bf16 v[80:95], a[248:251], v[220:223], v[80:95]
  v_bitop3_b32 v37, v252, v253, v37 bitop3:0x96
  v_bitop3_b32 v36, v237, v238, v36 bitop3:0x96
  v_mfma_f32_32x32x16_bf16 v[96:111], a[252:255], v[216:219], v[96:111]
  v_bitop3_b32 v37, v254, v255, v37 bitop3:0x96
  v_bitop3_b32 v36, v239, v240, v36 bitop3:0x96
  v_mfma_f32_32x32x16_bf16 v[112:127], a[252:255], v[220:223], v[112:127]
  v_bitop3_b32 v37, v6, v7, v37 bitop3:0x96
  v_bitop3_b32 v36, v36, v37, s76 bitop3:0x96
  v_cmp_ne_u32 vcc, 0, v36
  s_nop 3
  s_cbranch_vccnz L_Q_bad_31
L_Q_back_32:
  v_add_u32 v21, 147456, v16
  v_xor_b32 v22, 64, v21
  ds_read_b64_tr_b16 a[16:17], v21 offset:0
  ds_read_b64_tr_b16 a[18:19], v21 offset:1024
  ds_read_b64_tr_b16 a[20:21], v22 offset:0
  ds_read_b64_tr_b16 a[22:23], v22 offset:1024
  s_waitcnt lgkmcnt(10)
  v_mfma_f32_32x32x16_bf16 v[64:79], a[0:3], v[224:227], v[64:79]
  v_mfma_f32_32x32x16_bf16 v[80:95], a[0:3], v[228:231], v[80:95]
  s_waitcnt lgkmcnt(8)
  v_mfma_f32_32x32x16_bf16 v[96:111], a[4:7], v[224:227], v[96:111]
  v_mfma_f32_32x32x16_bf16 v[112:127], a[4:7], v[228:231], v[112:127]
  ds_read_b64_tr_b16 a[24:25], v21 offset:2048
  ds_read_b64_tr_b16 a[26:27], v21 offset:3072
  ds_read_b64_tr_b16 a[28:29], v22 offset:2048
  ds_read_b64_tr_b16 a[30:31], v22 offset:3072
  s_waitcnt lgkmcnt(10)
  v_mfma_f32_32x32x16_bf16 v[64:79], a[8:11], v[232:235], v[64:79]
  v_mfma_f32_32x32x16_bf16 v[80:95], a[8:11], v[236:239], v[80:95]
  s_waitcnt lgkmcnt(8)
  v_mfma_f32_32x32x16_bf16 v[96:111], a[12:15], v[232:235], v[96:111]
  v_mfma_f32_32x32x16_bf16 v[112:127], a[12:15], v[236:239], v[112:127]
  v_add_u32 v21, 65536, v16
  v_xor_b32 v22, 64, v21
  ds_read_b64_tr_b16 a[0:1], v21 offset:0
  ds_read_b64_tr_b16 a[2:3], v21 offset:1024
  ds_read_b64_tr_b16 a[4:5], v22 offset:0
  ds_read_b64_tr_b16 a[6:7], v22 offset:1024
  s_waitcnt lgkmcnt(10)
  v_mfma_f32_32x32x16_bf16 v[64:79], a[16:19], v[240:243], v[64:79]
  s_waitcnt vmcnt(0)
  v_bitop3_b32 v38, v128, v129, v130 bitop3:0x96
  v_bitop3_b32 v39, v145, v146, v147 bitop3:0x96
  v_mfma_f32_32x32x16_bf16 v[80:95], a[16:19], v[244:247], v[80:95]
  v_bitop3_b32 v38, v131, v132, v38 bitop3:0x96
  v_bitop3_b32 v39, v148, v149, v39 bitop3:0x96
  v_bitop3_b32 v38, v133, v134, v38 bitop3:0x96
  s_waitcnt lgkmcnt(8)
  v_mfma_f32_32x32x16_bf16 v[96:111], a[20:23], v[240:243], v[96:111]
  v_bitop3_b32 v39, v150, v151, v39 bitop3:0x96
  v_bitop3_b32 v38, v135, v136, v38 bitop3:0x96
  v_mfma_f32_32x32x16_bf16 v[112:127], a[20:23], v[244:247], v[112:127]
  v_bitop3_b32 v39, v152, v153, v39 bitop3:0x96
  v_bitop3_b32 v38, v137, v138, v38 bitop3:0x96
  ds_read_b64_tr_b16 a[8:9], v21 offset:2048
  ds_read_b64_tr_b16 a[10:11], v21 offset:3072
  ds_read_b64_tr_b16 a[12:13], v22 offset:2048
  ds_read_b64_tr_b16 a[14:15], v22 offset:3072
  s_waitcnt lgkmcnt(10)
  v_mfma_f32_32x32x16_bf16 v[64:79], a[24:27], v[248:251], v[64:79]
  v_bitop3_b32 v39, v154, v155, v39 bitop3:0x96
  v_bitop3_b32 v38, v139, v140, v38 bitop3:0x96
  v_mfma_f32_32x32x16_bf16 v[80:95], a[24:27], v[252:255], v[80:95]
  v_bitop3_b32 v39, v156, v157, v39 bitop3:0x96
  v_bitop3_b32 v38, v141, v142, v38 bitop3:0x96
  s_waitcnt lgkmcnt(8)
  v_mfma_f32_32x32x16_bf16 v[96:111], a[28:31], v[248:251], v[96:111]
  v_bitop3_b32 v39, v158, v159, v39 bitop3:0x96
  v_bitop3_b32 v38, v143, v144, v38 bitop3:0x96
  v_mfma_f32_32x32x16_bf16 v[112:127], a[28:31], v[252:255], v[112:127]
  v_bitop3_b32 v39, v8, v9, v39 bitop3:0x96
  v_bitop3_b32 v38, v38, v39, s79 bitop3:0x96
  v_cmp_ne_u32 vcc, 0, v38
  s_nop 3
  s_cbranch_vccnz L_Q_bad_34
L_Q_back_35:
  v_add_u32 v21, 81920, v16
  v_xor_b32 v22, 64, v21
  ds_read_b64_tr_b16 a[16:17], v21 offset:0
  ds_read_b64_tr_b16 a[18:19], v21 offset:1024
  ds_read_b64_tr_b16 a[20:21], v22 offset:0
  ds_read_b64_tr_b16 a[22:23], v22 offset:1024
  s_waitcnt lgkmcnt(10)
  v_mfma_f32_32x32x16_bf16 v[64:79], a[0:3], v[128:131], v[64:79]
  v_mfma_f32_32x32x16_bf16 v[80:95], a[0:3], v[132:135], v[80:95]
  s_waitcnt lgkmcnt(8)
  v_mfma_f32_32x32x16_bf16 v[96:111], a[4:7], v[128:131], v[96:111]
  v_mfma_f32_32x32x16_bf16 v[112:127], a[4:7], v[132:135], v[112:127]
  ds_read_b64_tr_b16 a[24:25], v21 offset:2048
  ds_read_b64_tr_b16 a[26:27], v21 offset:3072
  ds_read_b64_tr_b16 a[28:29], v22 offset:2048
  ds_read_b64_tr_b16 a[30:31], v22 offset:3072
  s_waitcnt lgkmcnt(10)
  v_mfma_f32_32x32x16_bf16 v[64:79], a[8:11], v[136:139], v[64:79]
  v_mfma_f32_32x32x16_bf16 v[80:95], a[8:11], v[140:143], v[80:95]
  s_waitcnt lgkmcnt(8)
  v_mfma_f32_32x32x16_bf16 v[96:111], a[12:15], v[136:139], v[96:111]
  v_mfma_f32_32x32x16_bf16 v[112:127], a[12:15], v[140:143], v[112:127]
  s_waitcnt lgkmcnt(6)
  v_mfma_f32_32x32x16_bf16 v[64:79], a[16:19], v[144:147], v[64:79]
  v_mfma_f32_32x32x16_bf16 v[80:95], a[16:19], v[148:151], v[80:95]
  s_waitcnt lgkmcnt(4)
  v_mfma_f32_32x32x16_bf16 v[96:111], a[20:23], v[144:147], v[96:111]
  v_mfma_f32_32x32x16_bf16 v[112:127], a[20:23], v[148:151], v[112:127]
  s_waitcnt lgkmcnt(2)
  v_mfma_f32_32x32x16_bf16 v[64:79], a[24:27], v[152:155], v[64:79]
  v_mfma_f32_32x32x16_bf16 v[80:95], a[24:27], v[156:159], v[80:95]
  s_waitcnt lgkmcnt(0)
  v_mfma_f32_32x32x16_bf16 v[96:111], a[28:31], v[152:155], v[96:111]
  v_mfma_f32_32x32x16_bf16 v[112:127], a[28:31], v[156:159], v[112:127]
  s_lshl_b32 s6, s45, 13
  v_add_u32 v33, s6, v1
  v_xor_b32 v40, 0, v33
  v_xor_b32 v41, 32, v33
  v_xor_b32 v42, 64, v33
  v_xor_b32 v43, 96, v33
  v_xor_b32 v44, 128, v33
  v_xor_b32 v45, 160, v33
  v_xor_b32 v46, 192, v33
  v_xor_b32 v47, 224, v33
  ds_write_b128 v40, v[64:67] offset:0
  ds_write_b128 v41, v[68:71] offset:1024
  ds_write_b128 v42, v[72:75] offset:2048
  ds_write_b128 v43, v[76:79] offset:3072
  ds_write_b128 v44, v[96:99] offset:4096
  ds_write_b128 v45, v[100:103] offset:5120
  ds_write_b128 v46, v[104:107] offset:6144
  ds_write_b128 v47, v[108:111] offset:7168
  ds_write_b128 v40, v[80:83] offset:32768
  ds_write_b128 v41, v[84:87] offset:33792
  ds_write_b128 v42, v[88:91] offset:34816
  ds_write_b128 v43, v[92:95] offset:35840
  ds_write_b128 v44, v[112:115] offset:36864
  ds_write_b128 v45, v[116:119] offset:37888
  ds_write_b128 v46, v[120:123] offset:38912
  ds_write_b128 v47, v[124:127] offset:39936
  v_lshrrev_b32 v34, 3, v30
  s_and_b32 s6, s45, 1
  s_lshl_b32 s6, s6, 4
  v_add_u32 v34, s6, v34
  v_and_b32 v35, 7, v30
  v_lshlrev_b32 v36, 1, v35
  v_xor_b32 v37, v34, v36
  v_lshlrev_b32 v37, 4, v37
  v_lshl_add_u32 v37, v35, 10, v37
  s_lshr_b32 s6, s45, 1
  s_lshl_b32 s6, s6, 15
  v_add_u32 v37, s6, v37
  v_xor_b32 v38, 128, v37
  s_waitcnt lgkmcnt(0)
  s_barrier
  ds_read_b128 v[128:131], v37 offset:0
  ds_read_b128 v[132:135], v37 offset:512
  ds_read_b128 v[136:139], v37 offset:8192
  ds_read_b128 v[140:143], v37 offset:8704
  ds_read_b128 v[144:147], v37 offset:16384
  ds_read_b128 v[148:151], v37 offset:16896
  ds_read_b128 v[152:155], v37 offset:24576
  ds_read_b128 v[156:159], v37 offset:25088
  ds_read_b128 v[160:163], v38 offset:0
  ds_read_b128 v[164:167], v38 offset:512
  ds_read_b128 v[168:171], v38 offset:8192
  ds_read_b128 v[172:175], v38 offset:8704
  ds_read_b128 v[176:179], v38 offset:16384
  ds_read_b128 v[180:183], v38 offset:16896
  ds_read_b128 v[184:187], v38 offset:24576
  ds_read_b128 v[188:191], v38 offset:25088
  v_lshlrev_b32 v64, 16, v48
  v_and_b32 v65, 0xffff0000, v48
  v_lshlrev_b32 v66, 16, v49
  v_and_b32 v67, 0xffff0000, v49
  v_lshlrev_b32 v68, 16, v50
  v_and_b32 v69, 0xffff0000, v50
  v_lshlrev_b32 v70, 16, v51
  v_and_b32 v71, 0xffff0000, v51
  v_lshlrev_b32 v72, 16, v52
  v_and_b32 v73, 0xffff0000, v52
  v_lshlrev_b32 v74, 16, v53
  v_and_b32 v75, 0xffff0000, v53
  v_lshlrev_b32 v76, 16, v54
  v_and_b32 v77, 0xffff0000, v54
  v_lshlrev_b32 v78, 16, v55
  v_and_b32 v79, 0xffff0000, v55
  s_waitcnt lgkmcnt(14)
  v_pk_add_f32 v[64:65], v[64:65], v[128:129]
  v_pk_add_f32 v[66:67], v[66:67], v[130:131]
  v_pk_add_f32 v[68:69], v[68:69], v[132:133]
  v_pk_add_f32 v[70:71], v[70:71], v[134:135]
  s_waitcnt lgkmcnt(12)
  v_pk_add_f32 v[64:65], v[64:65], v[136:137]
  v_pk_add_f32 v[66:67], v[66:67], v[138:139]
  v_pk_add_f32 v[68:69], v[68:69], v[140:141]
  v_pk_add_f32 v[70:71], v[70:71], v[142:143]
  s_waitcnt lgkmcnt(10)
  v_pk_add_f32 v[64:65], v[64:65], v[144:145]
  v_pk_add_f32 v[66:67], v[66:67], v[146:147]
  v_pk_add_f32 v[68:69], v[68:69], v[148:149]
  v_pk_add_f32 v[70:71], v[70:71], v[150:151]
  s_waitcnt lgkmcnt(8)
  v_pk_add_f32 v[64:65], v[64:65], v[152:153]
  v_pk_add_f32 v[66:67], v[66:67], v[154:155]
  v_pk_add_f32 v[68:69], v[68:69], v[156:157]
  v_pk_add_f32 v[70:71], v[70:71], v[158:159]
  v_cvt_pk_bf16_f32 v56, v64, v65
  v_cvt_pk_bf16_f32 v57, v66, v67
  v_cvt_pk_bf16_f32 v58, v68, v69
  v_cvt_pk_bf16_f32 v59, v70, v71
  buffer_store_dwordx4 v[56:59], v32, s[32:35], s75 offen
  s_waitcnt lgkmcnt(6)
  v_pk_add_f32 v[72:73], v[72:73], v[160:161]
  v_pk_add_f32 v[74:75], v[74:75], v[162:163]
  v_pk_add_f32 v[76:77], v[76:77], v[164:165]
  v_pk_add_f32 v[78:79], v[78:79], v[166:167]
  s_waitcnt lgkmcnt(4)
  v_pk_add_f32 v[72:73], v[72:73], v[168:169]
  v_pk_add_f32 v[74:75], v[74:75], v[170:171]
  v_pk_add_f32 v[76:77], v[76:77], v[172:173]
  v_pk_add_f32 v[78:79], v[78:79], v[174:175]
  s_waitcnt lgkmcnt(2)
  v_pk_add_f32 v[72:73], v[72:73], v[176:177]
  v_pk_add_f32 v[74:75], v[74:75], v[178:179]
  v_pk_add_f32 v[76:77], v[76:77], v[180:181]
  v_pk_add_f32 v[78:79], v[78:79], v[182:183]
  s_waitcnt lgkmcnt(0)
  v_pk_add_f32 v[72:73], v[72:73], v[184:185]
  v_pk_add_f32 v[74:75], v[74:75], v[186:187]
  v_pk_add_f32 v[76:77], v[76:77], v[188:189]
  v_pk_add_f32 v[78:79], v[78:79], v[190:191]
  v_cvt_pk_bf16_f32 v60, v72, v73
  v_cvt_pk_bf16_f32 v61, v74, v75
  v_cvt_pk_bf16_f32 v62, v76, v77
  v_cvt_pk_bf16_f32 v63, v78, v79
  s_add_u32 s7, s75, 8192
  buffer_store_dwordx4 v[60:63], v32, s[32:35], s7 offen
  s_endpgm
L_Q_slow_1:
  s_mov_b32 s70, 0
L_Q_spin_3:
  s_add_u32 s70, s70, 1
  s_cmp_ge_u32 s70, 100000
  s_cbranch_scc1 L_Q_pback_2
  s_sleep 1
  v_lshlrev_b32 v60, 6, v30
  v_add_u32 v60, v60, v25
  s_mov_b64 exec, 0xf
  buffer_load_dword v31, v60, s[40:43], 0 offen sc1
  s_waitcnt vmcnt(0)
  v_cmp_le_u32 vcc, s44, v31
  s_mov_b64 exec, -1
  s_nop 2
  s_cmp_eq_u64 vcc, 0xf
  s_cbranch_scc0 L_Q_spin_3
  s_branch L_Q_pback_2
L_Q_slow_4:
  s_mov_b32 s70, 0
L_Q_spin_6:
  s_add_u32 s70, s70, 1
  s_cmp_ge_u32 s70, 100000
  s_cbranch_scc1 L_Q_pback_5
  v_add_u32 v60, v0, v25
  s_lshl_b32 s7, s60, 7
  s_add_u32 s7, s7, 10551296
  s_mov_b64 exec, 0xffff
  buffer_load_dword v31, v60, s[36:39], s7 offen sc1
  s_waitcnt vmcnt(0)
  v_cmp_le_u32 vcc, s44, v31
  s_mov_b64 exec, -1
  s_nop 2
  s_cmp_eq_u64 vcc, 0xffff
  s_cbranch_scc0 L_Q_spin_6
  s_branch L_Q_pback_5
L_Q_bad_7:
  s_mov_b32 s70, 0
L_Q_retry_9:
  s_add_u32 s70, s70, 1
  s_cmp_ge_u32 s70, 100000
  s_cbranch_scc1 L_Q_back_8
  s_add_u32 s6, s57, 0
  buffer_load_dwordx4 v[128:131], v1, s[36:39], s6 offen sc1
  buffer_load_dwordx4 v[132:135], v1, s[36:39], s6 offen offset:1024 sc1
  buffer_load_dwordx4 v[136:139], v1, s[36:39], s6 offen offset:2048 sc1
  buffer_load_dwordx4 v[140:143], v1, s[36:39], s6 offen offset:3072 sc1
  s_add_u32 s6, s57, 4096
  buffer_load_dwordx4 v[144:147], v1, s[36:39], s6 offen sc1
  buffer_load_dwordx4 v[148:151], v1, s[36:39], s6 offen offset:1024 sc1
  buffer_load_dwordx4 v[152:155], v1, s[36:39], s6 offen offset:2048 sc1
  buffer_load_dwordx4 v[156:159], v1, s[36:39], s6 offen offset:3072 sc1
  s_add_u32 s6, s74, 0
  buffer_load_dword v2, v0, s[36:39], s6 offen sc1
  buffer_load_dword v3, v0, s[36:39], s6 offen offset:256 sc1
  s_waitcnt vmcnt(0)
  v_bitop3_b32 v36, v128, v129, v130 bitop3:0x96
  v_bitop3_b32 v37, v145, v146, v147 bitop3:0x96
  v_bitop3_b32 v36, v131, v132, v36 bitop3:0x96
  v_bitop3_b32 v37, v148, v149, v37 bitop3:0x96
  v_bitop3_b32 v36, v133, v134, v36 bitop3:0x96
  v_bitop3_b32 v37, v150, v151, v37 bitop3:0x96
  v_bitop3_b32 v36, v135, v136, v36 bitop3:0x96
  v_bitop3_b32 v37, v152, v153, v37 bitop3:0x96
  v_bitop3_b32 v36, v137, v138, v36 bitop3:0x96
  v_bitop3_b32 v37, v154, v155, v37 bitop3:0x96
  v_bitop3_b32 v36, v139, v140, v36 bitop3:0x96
  v_bitop3_b32 v37, v156, v157, v37 bitop3:0x96
  v_bitop3_b32 v36, v141, v142, v36 bitop3:0x96
  v_bitop3_b32 v37, v158, v159, v37 bitop3:0x96
  v_bitop3_b32 v36, v143, v144, v36 bitop3:0x96
  v_bitop3_b32 v37, v2, v3, v37 bitop3:0x96
  v_bitop3_b32 v36, v36, v37, s76 bitop3:0x96
  v_cmp_ne_u32 vcc, 0, v36
  s_nop 3
  s_cbranch_vccnz L_Q_retry_9
  s_branch L_Q_back_8
L_Q_bad_10:
  s_mov_b32 s70, 0
L_Q_retry_12:
  s_add_u32 s70, s70, 1
  s_cmp_ge_u32 s70, 100000
  s_cbranch_scc1 L_Q_back_11
  s_add_u32 s6, s57, 40960
  buffer_load_dwordx4 v[160:163], v1, s[36:39], s6 offen sc1
  buffer_load_dwordx4 v[164:167], v1, s[36:39], s6 offen offset:1024 sc1
  buffer_load_dwordx4 v[168:171], v1, s[36:39], s6 offen offset:2048 sc1
  buffer_load_dwordx4 v[172:175], v1, s[36:39], s6 offen offset:3072 sc1
  s_add_u32 s6, s57, 45056
  buffer_load_dwordx4 v[176:179], v1, s[36:39], s6 offen sc1
  buffer_load_dwordx4 v[180:183], v1, s[36:39], s6 offen offset:1024 sc1
  buffer_load_dwordx4 v[184:187], v1, s[36:39], s6 offen offset:2048 sc1
  buffer_load_dwordx4 v[188:191], v1, s[36:39], s6 offen offset:3072 sc1
  s_add_u32 s6, s74, 10240
  buffer_load_dword v4, v0, s[36:39], s6 offen sc1
  buffer_load_dword v5, v0, s[36:39], s6 offen offset:256 sc1
  s_waitcnt vmcnt(0)
  v_bitop3_b32 v38, v160, v161, v162 bitop3:0x96
  v_bitop3_b32 v39, v177, v178, v179 bitop3:0x96
  v_bitop3_b32 v38, v163, v164, v38 bitop3:0x96
  v_bitop3_b32 v39, v180, v181, v39 bitop3:0x96
  v_bitop3_b32 v38, v165, v166, v38 bitop3:0x96
  v_bitop3_b32 v39, v182, v183, v39 bitop3:0x96
  v_bitop3_b32 v38, v167, v168, v38 bitop3:0x96
  v_bitop3_b32 v39, v184, v185, v39 bitop3:0x96
  v_bitop3_b32 v38, v169, v170, v38 bitop3:0x96
  v_bitop3_b32 v39, v186, v187, v39 bitop3:0x96
  v_bitop3_b32 v38, v171, v172, v38 bitop3:0x96
  v_bitop3_b32 v39, v188, v189, v39 bitop3:0x96
  v_bitop3_b32 v38, v173, v174, v38 bitop3:0x96
  v_bitop3_b32 v39, v190, v191, v39 bitop3:0x96
  v_bitop3_b32 v38, v175, v176, v38 bitop3:0x96
  v_bitop3_b32 v39, v4, v5, v39 bitop3:0x96
  v_bitop3_b32 v38, v38, v39, s79 bitop3:0x96
  v_cmp_ne_u32 vcc, 0, v38
  s_nop 3
  s_cbranch_vccnz L_Q_retry_12
  s_branch L_Q_back_11
L_Q_bad_13:
  s_mov_b32 s70, 0
L_Q_retry_15:
  s_add_u32 s70, s70, 1
  s_cmp_ge_u32 s70, 100000
  s_cbranch_scc1 L_Q_back_14
  s_add_u32 s6, s57, 8192
  buffer_load_dwordx4 v[192:195], v1, s[36:39], s6 offen sc1
  buffer_load_dwordx4 v[196:199], v1, s[36:39], s6 offen offset:1024 sc1
  buffer_load_dwordx4 v[200:203], v1, s[36:39], s6 offen offset:2048 sc1
  buffer_load_dwordx4 v[204:207], v1, s[36:39], s6 offen offset:3072 sc1
  s_add_u32 s6, s57, 12288
  buffer_load_dwordx4 v[208:211], v1, s[36:39], s6 offen sc1
  buffer_load_dwordx4 v[212:215], v1, s[36:39], s6 offen offset:1024 sc1
  buffer_load_dwordx4 v[216:219], v1, s[36:39], s6 offen offset:2048 sc1
  buffer_load_dwordx4 v[220:223], v1, s[36:39], s6 offen offset:3072 sc1
  s_add_u32 s6, s74, 2048
  buffer_load_dword v6, v0, s[36:39], s6 offen sc1
  buffer_load_dword v7, v0, s[36:39], s6 offen offset:256 sc1
  s_waitcnt vmcnt(0)
  v_bitop3_b32 v36, v192, v193, v194 bitop3:0x96
  v_bitop3_b32 v37, v209, v210, v211 bitop3:0x96
  v_bitop3_b32 v36, v195, v196, v36 bitop3:0x96
  v_bitop3_b32 v37, v212, v213, v37 bitop3:0x96
  v_bitop3_b32 v36, v197, v198, v36 bitop3:0x96
  v_bitop3_b32 v37, v214, v215, v37 bitop3:0x96
  v_bitop3_b32 v36, v199, v200, v36 bitop3:0x96
  v_bitop3_b32 v37, v216, v217, v37 bitop3:0x96
  v_bitop3_b32 v36, v201, v202, v36 bitop3:0x96
  v_bitop3_b32 v37, v218, v219, v37 bitop3:0x96
  v_bitop3_b32 v36, v203, v204, v36 bitop3:0x96
  v_bitop3_b32 v37, v220, v221, v37 bitop3:0x96
  v_bitop3_b32 v36, v205, v206, v36 bitop3:0x96
  v_bitop3_b32 v37, v222, v223, v37 bitop3:0x96
  v_bitop3_b32 v36, v207, v208, v36 bitop3:0x96
  v_bitop3_b32 v37, v6, v7, v37 bitop3:0x96
  v_bitop3_b32 v36, v36, v37, s76 bitop3:0x96
  v_cmp_ne_u32 vcc, 0, v36
  s_nop 3
  s_cbranch_vccnz L_Q_retry_15
  s_branch L_Q_back_14
L_Q_bad_16:
  s_mov_b32 s70, 0
L_Q_retry_18:
  s_add_u32 s70, s70, 1
  s_cmp_ge_u32 s70, 100000
  s_cbranch_scc1 L_Q_back_17
  s_add_u32 s6, s57, 49152
  buffer_load_dwordx4 v[224:227], v1, s[36:39], s6 offen sc1
  buffer_load_dwordx4 v[228:231], v1, s[36:39], s6 offen offset:1024 sc1
  buffer_load_dwordx4 v[232:235], v1, s[36:39], s6 offen offset:2048 sc1
  buffer_load_dwordx4 v[236:239], v1, s[36:39], s6 offen offset:3072 sc1
  s_add_u32 s6, s57, 53248
  buffer_load_dwordx4 v[240:243], v1, s[36:39], s6 offen sc1
  buffer_load_dwordx4 v[244:247], v1, s[36:39], s6 offen offset:1024 sc1
  buffer_load_dwordx4 v[248:251], v1, s[36:39], s6 offen offset:2048 sc1
  buffer_load_dwordx4 v[252:255], v1, s[36:39], s6 offen offset:3072 sc1
  s_add_u32 s6, s74, 12288
  buffer_load_dword v8, v0, s[36:39], s6 offen sc1
  buffer_load_dword v9, v0, s[36:39], s6 offen offset:256 sc1
  s_waitcnt vmcnt(0)
  v_bitop3_b32 v38, v224, v225, v226 bitop3:0x96
  v_bitop3_b32 v39, v241, v242, v243 bitop3:0x96
  v_bitop3_b32 v38, v227, v228, v38 bitop3:0x96
  v_bitop3_b32 v39, v244, v245, v39 bitop3:0x96
  v_bitop3_b32 v38, v229, v230, v38 bitop3:0x96
  v_bitop3_b32 v39, v246, v247, v39 bitop3:0x96
  v_bitop3_b32 v38, v231, v232, v38 bitop3:0x96
  v_bitop3_b32 v39, v248, v249, v39 bitop3:0x96
  v_bitop3_b32 v38, v233, v234, v38 bitop3:0x96
  v_bitop3_b32 v39, v250, v251, v39 bitop3:0x96
  v_bitop3_b32 v38, v235, v236, v38 bitop3:0x96
  v_bitop3_b32 v39, v252, v253, v39 bitop3:0x96
  v_bitop3_b32 v38, v237, v238, v38 bitop3:0x96
  v_bitop3_b32 v39, v254, v255, v39 bitop3:0x96
  v_bitop3_b32 v38, v239, v240, v38 bitop3:0x96
  v_bitop3_b32 v39, v8, v9, v39 bitop3:0x96
  v_bitop3_b32 v38, v38, v39, s79 bitop3:0x96
  v_cmp_ne_u32 vcc, 0, v38
  s_nop 3
  s_cbranch_vccnz L_Q_retry_18
  s_branch L_Q_back_17
L_Q_bad_19:
  s_mov_b32 s70, 0
L_Q_retry_21:
  s_add_u32 s70, s70, 1
  s_cmp_ge_u32 s70, 100000
  s_cbranch_scc1 L_Q_back_20
  s_add_u32 s6, s57, 16384
  buffer_load_dwordx4 v[128:131], v1, s[36:39], s6 offen sc1
  buffer_load_dwordx4 v[132:135], v1, s[36:39], s6 offen offset:1024 sc1
  buffer_load_dwordx4 v[136:139], v1, s[36:39], s6 offen offset:2048 sc1
  buffer_load_dwordx4 v[140:143], v1, s[36:39], s6 offen offset:3072 sc1
  s_add_u32 s6, s57, 20480
  buffer_load_dwordx4 v[144:147], v1, s[36:39], s6 offen sc1
  buffer_load_dwordx4 v[148:151], v1, s[36:39], s6 offen offset:1024 sc1
  buffer_load_dwordx4 v[152:155], v1, s[36:39], s6 offen offset:2048 sc1
  buffer_load_dwordx4 v[156:159], v1, s[36:39], s6 offen offset:3072 sc1
  s_add_u32 s6, s74, 4096
  buffer_load_dword v10, v0, s[36:39], s6 offen sc1
  buffer_load_dword v11, v0, s[36:39], s6 offen offset:256 sc1
  s_waitcnt vmcnt(0)
  v_bitop3_b32 v36, v128, v129, v130 bitop3:0x96
  v_bitop3_b32 v37, v145, v146, v147 bitop3:0x96
  v_bitop3_b32 v36, v131, v132, v36 bitop3:0x96
  v_bitop3_b32 v37, v148, v149, v37 bitop3:0x96
  v_bitop3_b32 v36, v133, v134, v36 bitop3:0x96
  v_bitop3_b32 v37, v150, v151, v37 bitop3:0x96
  v_bitop3_b32 v36, v135, v136, v36 bitop3:0x96
  v_bitop3_b32 v37, v152, v153, v37 bitop3:0x96
  v_bitop3_b32 v36, v137, v138, v36 bitop3:0x96
  v_bitop3_b32 v37, v154, v155, v37 bitop3:0x96
  v_bitop3_b32 v36, v139, v140, v36 bitop3:0x96
  v_bitop3_b32 v37, v156, v157, v37 bitop3:0x96
  v_bitop3_b32 v36, v141, v142, v36 bitop3:0x96
  v_bitop3_b32 v37, v158, v159, v37 bitop3:0x96
  v_bitop3_b32 v36, v143, v144, v36 bitop3:0x96
  v_bitop3_b32 v37, v10, v11, v37 bitop3:0x96
  v_bitop3_b32 v36, v36, v37, s77 bitop3:0x96
  v_cmp_ne_u32 vcc, 0, v36
  s_nop 3
  s_cbranch_vccnz L_Q_retry_21
  s_branch L_Q_back_20
L_Q_bad_22:
  s_mov_b32 s70, 0
L_Q_retry_24:
  s_add_u32 s70, s70, 1
  s_cmp_ge_u32 s70, 100000
  s_cbranch_scc1 L_Q_back_23
  s_add_u32 s6, s57, 32768
  buffer_load_dwordx4 v[160:163], v1, s[36:39], s6 offen sc1
  buffer_load_dwordx4 v[164:167], v1, s[36:39], s6 offen offset:1024 sc1
  buffer_load_dwordx4 v[168:171], v1, s[36:39], s6 offen offset:2048 sc1
  buffer_load_dwordx4 v[172:175], v1, s[36:39], s6 offen offset:3072 sc1
  s_add_u32 s6, s57, 36864
  buffer_load_dwordx4 v[176:179], v1, s[36:39], s6 offen sc1
  buffer_load_dwordx4 v[180:183], v1, s[36:39], s6 offen offset:1024 sc1
  buffer_load_dwordx4 v[184:187], v1, s[36:39], s6 offen offset:2048 sc1
  buffer_load_dwordx4 v[188:191], v1, s[36:39], s6 offen offset:3072 sc1
  s_add_u32 s6, s74, 8192
  buffer_load_dword v12, v0, s[36:39], s6 offen sc1
  buffer_load_dword v13, v0, s[36:39], s6 offen offset:256 sc1
  s_waitcnt vmcnt(0)
  v_bitop3_b32 v38, v160, v161, v162 bitop3:0x96
  v_bitop3_b32 v39, v177, v178, v179 bitop3:0x96
  v_bitop3_b32 v38, v163, v164, v38 bitop3:0x96
  v_bitop3_b32 v39, v180, v181, v39 bitop3:0x96
  v_bitop3_b32 v38, v165, v166, v38 bitop3:0x96
  v_bitop3_b32 v39, v182, v183, v39 bitop3:0x96
  v_bitop3_b32 v38, v167, v168, v38 bitop3:0x96
  v_bitop3_b32 v39, v184, v185, v39 bitop3:0x96
  v_bitop3_b32 v38, v169, v170, v38 bitop3:0x96
  v_bitop3_b32 v39, v186, v187, v39 bitop3:0x96
  v_bitop3_b32 v38, v171, v172, v38 bitop3:0x96
  v_bitop3_b32 v39, v188, v189, v39 bitop3:0x96
  v_bitop3_b32 v38, v173, v174, v38 bitop3:0x96
  v_bitop3_b32 v39, v190, v191, v39 bitop3:0x96
  v_bitop3_b32 v38, v175, v176, v38 bitop3:0x96
  v_bitop3_b32 v39, v12, v13, v39 bitop3:0x96
  v_bitop3_b32 v38, v38, v39, s78 bitop3:0x96
  v_cmp_ne_u32 vcc, 0, v38
  s_nop 3
  s_cbranch_vccnz L_Q_retry_24
  s_branch L_Q_back_23
L_Q_bad_25:
  s_mov_b32 s70, 0
L_Q_retry_27:
  s_add_u32 s70, s70, 1
  s_cmp_ge_u32 s70, 100000
  s_cbranch_scc1 L_Q_back_26
  s_add_u32 s6, s57, 24576
  buffer_load_dwordx4 v[192:195], v1, s[36:39], s6 offen sc1
  buffer_load_dwordx4 v[196:199], v1, s[36:39], s6 offen offset:1024 sc1
  buffer_load_dwordx4 v[200:203], v1, s[36:39], s6 offen offset:2048 sc1
  buffer_load_dwordx4 v[204:207], v1, s[36:39], s6 offen offset:3072 sc1
  s_add_u32 s6, s74, 6144
  buffer_load_dword v2, v0, s[36:39], s6 offen sc1
  buffer_load_dword v3, v0, s[36:39], s6 offen offset:256 sc1
  s_waitcnt vmcnt(0)
  v_bitop3_b32 v36, v192, v193, v194 bitop3:0x96
  v_bitop3_b32 v37, v201, v202, v203 bitop3:0x96
  v_bitop3_b32 v36, v195, v196, v36 bitop3:0x96
  v_bitop3_b32 v37, v204, v205, v37 bitop3:0x96
  v_bitop3_b32 v36, v197, v198, v36 bitop3:0x96
  v_bitop3_b32 v37, v206, v207, v37 bitop3:0x96
  v_bitop3_b32 v36, v199, v200, v36 bitop3:0x96
  v_bitop3_b32 v37, v2, v3, v37 bitop3:0x96
  v_bitop3_b32 v36, v36, v37, s77 bitop3:0x96
  v_cmp_ne_u32 vcc, 0, v36
  s_nop 3
  s_cbranch_vccnz L_Q_retry_27
  s_branch L_Q_back_26
L_Q_bad_28:
  s_mov_b32 s70, 0
L_Q_retry_30:
  s_add_u32 s70, s70, 1
  s_cmp_ge_u32 s70, 100000
  s_cbranch_scc1 L_Q_back_29
  s_add_u32 s6, s57, 28672
  buffer_load_dwordx4 v[208:211], v1, s[36:39], s6 offen sc1
  buffer_load_dwordx4 v[212:215], v1, s[36:39], s6 offen offset:1024 sc1
  buffer_load_dwordx4 v[216:219], v1, s[36:39], s6 offen offset:2048 sc1
  buffer_load_dwordx4 v[220:223], v1, s[36:39], s6 offen offset:3072 sc1
  s_add_u32 s6, s74, 7168
  buffer_load_dword v4, v0, s[36:39], s6 offen sc1
  buffer_load_dword v5, v0, s[36:39], s6 offen offset:256 sc1
  s_waitcnt vmcnt(0)
  v_bitop3_b32 v38, v208, v209, v210 bitop3:0x96
  v_bitop3_b32 v39, v217, v218, v219 bitop3:0x96
  v_bitop3_b32 v38, v211, v212, v38 bitop3:0x96
  v_bitop3_b32 v39, v220, v221, v39 bitop3:0x96
  v_bitop3_b32 v38, v213, v214, v38 bitop3:0x96
  v_bitop3_b32 v39, v222, v223, v39 bitop3:0x96
  v_bitop3_b32 v38, v215, v216, v38 bitop3:0x96
  v_bitop3_b32 v39, v4, v5, v39 bitop3:0x96
  v_bitop3_b32 v38, v38, v39, s78 bitop3:0x96
  v_cmp_ne_u32 vcc, 0, v38
  s_nop 3
  s_cbranch_vccnz L_Q_retry_30
  s_branch L_Q_back_29
L_Q_bad_31:
  s_mov_b32 s70, 0
L_Q_retry_33:
  s_add_u32 s70, s70, 1
  s_cmp_ge_u32 s70, 100000
  s_cbranch_scc1 L_Q_back_32
  s_add_u32 s6, s58, 0
  buffer_load_dwordx4 v[224:227], v1, s[36:39], s6 offen sc1
  buffer_load_dwordx4 v[228:231], v1, s[36:39], s6 offen offset:1024 sc1
  buffer_load_dwordx4 v[232:235], v1, s[36:39], s6 offen offset:2048 sc1
  buffer_load_dwordx4 v[236:239], v1, s[36:39], s6 offen offset:3072 sc1
  s_add_u32 s6, s58, 4096
  buffer_load_dwordx4 v[240:243], v1, s[36:39], s6 offen sc1
  buffer_load_dwordx4 v[244:247], v1, s[36:39], s6 offen offset:1024 sc1
  buffer_load_dwordx4 v[248:251], v1, s[36:39], s6 offen offset:2048 sc1
  buffer_load_dwordx4 v[252:255], v1, s[36:39], s6 offen offset:3072 sc1
  s_mul_i32 s7, s45, 10240
  s_sub_u32 s7, s74, s7
  s_add_u32 s6, s7, 57344
  buffer_load_dword v6, v0, s[36:39], s6 offen sc1
  buffer_load_dword v7, v0, s[36:39], s6 offen offset:256 sc1
  s_waitcnt vmcnt(0)
  v_bitop3_b32 v36, v224, v225, v226 bitop3:0x96
  v_bitop3_b32 v37, v241, v242, v243 bitop3:0x96
  v_bitop3_b32 v36, v227, v228, v36 bitop3:0x96
  v_bitop3_b32 v37, v244, v245, v37 bitop3:0x96
  v_bitop3_b32 v36, v229, v230, v36 bitop3:0x96
  v_bitop3_b32 v37, v246, v247, v37 bitop3:0x96
  v_bitop3_b32 v36, v231, v232, v36 bitop3:0x96
  v_bitop3_b32 v37, v248, v249, v37 bitop3:0x96
  v_bitop3_b32 v36, v233, v234, v36 bitop3:0x96
  v_bitop3_b32 v37, v250, v251, v37 bitop3:0x96
  v_bitop3_b32 v36, v235, v236, v36 bitop3:0x96
  v_bitop3_b32 v37, v252, v253, v37 bitop3:0x96
  v_bitop3_b32 v36, v237, v238, v36 bitop3:0x96
  v_bitop3_b32 v37, v254, v255, v37 bitop3:0x96
  v_bitop3_b32 v36, v239, v240, v36 bitop3:0x96
  v_bitop3_b32 v37, v6, v7, v37 bitop3:0x96
  v_bitop3_b32 v36, v36, v37, s76 bitop3:0x96
  v_cmp_ne_u32 vcc, 0, v36
  s_nop 3
  s_cbranch_vccnz L_Q_retry_33
  s_branch L_Q_back_32
L_Q_bad_34:
  s_mov_b32 s70, 0
L_Q_retry_36:
  s_add_u32 s70, s70, 1
  s_cmp_ge_u32 s70, 100000
  s_cbranch_scc1 L_Q_back_35
  s_add_u32 s6, s58, 8192
  buffer_load_dwordx4 v[128:131], v1, s[36:39], s6 offen sc1
  buffer_load_dwordx4 v[132:135], v1, s[36:39], s6 offen offset:1024 sc1
  buffer_load_dwordx4 v[136:139], v1, s[36:39], s6 offen offset:2048 sc1
  buffer_load_dwordx4 v[140:143], v1, s[36:39], s6 offen offset:3072 sc1
  s_add_u32 s6, s58, 12288
  buffer_load_dwordx4 v[144:147], v1, s[36:39], s6 offen sc1
  buffer_load_dwordx4 v[148:151], v1, s[36:39], s6 offen offset:1024 sc1
  buffer_load_dwordx4 v[152:155], v1, s[36:39], s6 offen offset:2048 sc1
  buffer_load_dwordx4 v[156:159], v1, s[36:39], s6 offen offset:3072 sc1
  s_mul_i32 s7, s45, 10240
  s_sub_u32 s7, s74, s7
  s_add_u32 s6, s7, 59392
  buffer_load_dword v8, v0, s[36:39], s6 offen sc1
  buffer_load_dword v9, v0, s[36:39], s6 offen offset:256 sc1
  s_waitcnt vmcnt(0)
  v_bitop3_b32 v38, v128, v129, v130 bitop3:0x96
  v_bitop3_b32 v39, v145, v146, v147 bitop3:0x96
  v_bitop3_b32 v38, v131, v132, v38 bitop3:0x96
  v_bitop3_b32 v39, v148, v149, v39 bitop3:0x96
  v_bitop3_b32 v38, v133, v134, v38 bitop3:0x96
  v_bitop3_b32 v39, v150, v151, v39 bitop3:0x96
  v_bitop3_b32 v38, v135, v136, v38 bitop3:0x96
  v_bitop3_b32 v39, v152, v153, v39 bitop3:0x96
  v_bitop3_b32 v38, v137, v138, v38 bitop3:0x96
  v_bitop3_b32 v39, v154, v155, v39 bitop3:0x96
  v_bitop3_b32 v38, v139, v140, v38 bitop3:0x96
  v_bitop3_b32 v39, v156, v157, v39 bitop3:0x96
  v_bitop3_b32 v38, v141, v142, v38 bitop3:0x96
  v_bitop3_b32 v39, v158, v159, v39 bitop3:0x96
  v_bitop3_b32 v38, v143, v144, v38 bitop3:0x96
  v_bitop3_b32 v39, v8, v9, v39 bitop3:0x96
  v_bitop3_b32 v38, v38, v39, s79 bitop3:0x96
  v_cmp_ne_u32 vcc, 0, v38
  s_nop 3
  s_cbranch_vccnz L_Q_retry_36
  s_branch L_Q_back_35
L_KV:
  s_mul_i32 s7, s64, 448
  s_cmp_eq_u32 s61, 1
  s_movk_i32 s6, 256
  s_cselect_b32 s6, 128, s6
  s_movk_i32 s44, 224
  s_cselect_b32 s44, 192, s44
  s_add_u32 s6, s6, s7
  s_add_u32 s44, s44, s7
  s_mul_i32 s48, s45, 49152
  s_lshl_b32 s7, s60, 7
  s_add_u32 s48, s48, s7
  s_add_u32 s48, s48, 1024
  s_mul_i32 s49, s45, 57344
  s_lshl_b32 s7, s6, 1
  s_add_u32 s49, s49, s7
  s_mul_i32 s50, s45, 114688
  s_lshl_b32 s7, s44, 1
  s_add_u32 s50, s50, s7
  s_lshl_b32 s7, s6, 7
  s_add_u32 s55, s53, s7
  s_lshl_b32 s7, s44, 7
  s_add_u32 s56, s53, s7
  s_lshl_b32 s5, s2, 2
  s_add_u32 s5, s5, s45
  v_lshlrev_b32 v60, 7, v30
  s_mul_i32 s6, s5, 1792
  s_add_u32 s6, s6, 4096
  s_mov_b64 exec, 0x3fff
  buffer_load_dword v55, v60, s[28:31], s6 offen
  s_mul_i32 s6, s5, 512
  s_add_u32 s6, s6, 4096
  s_mov_b64 exec, 0xf
  buffer_load_dword v54, v60, s[16:19], s6 offen
  s_mov_b64 exec, -1
  v_mov_b32 v26, 0
  v_mov_b32 v40, 0
  v_mov_b32 v27, 0
  v_mov_b32 v41, 0
  v_mov_b32 v28, 0
  v_mov_b32 v42, 0
  v_mov_b32 v29, 0
  v_mov_b32 v43, 0
  s_waitcnt vmcnt(10)
  v_add_u32 v17, 32768, v63
  v_xor_b32 v18, 32, v17
  v_xor_b32 v19, 64, v17
  v_xor_b32 v20, 96, v17
  ds_read_b128 v[128:131], v17
  ds_read_b128 v[132:135], v18
  ds_read_b128 v[136:139], v19
  ds_read_b128 v[140:143], v20
  s_add_u32 s3, s65, 3
  s_and_b32 s3, s3, 7
  s_mul_i32 s3, s3, 128
  s_add_u32 s3, s3, s47
  s_add_u32 m0, s46, 81920
  s_nop 0
  buffer_load_dwordx4 v2, s[8:11], s3 offen lds
  buffer_load_dwordx4 v3, s[8:11], s3 offen offset:1024 lds
  buffer_load_dwordx4 v4, s[8:11], s3 offen offset:2048 lds
  buffer_load_dwordx4 v5, s[8:11], s3 offen offset:3072 lds
  s_waitcnt vmcnt(10)
  v_add_u32 v17, 49152, v63
  v_xor_b32 v18, 32, v17
  v_xor_b32 v19, 64, v17
  v_xor_b32 v20, 96, v17
  ds_read_b128 v[144:147], v17
  ds_read_b128 v[148:151], v18
  ds_read_b128 v[152:155], v19
  ds_read_b128 v[156:159], v20
  s_add_u32 s3, s65, 4
  s_and_b32 s3, s3, 7
  s_mul_i32 s3, s3, 128
  s_add_u32 s3, s3, s47
  s_add_u32 m0, s46, 98304
  s_nop 0
  buffer_load_dwordx4 v2, s[8:11], s3 offen lds
  buffer_load_dwordx4 v3, s[8:11], s3 offen offset:1024 lds
  buffer_load_dwordx4 v4, s[8:11], s3 offen offset:2048 lds
  buffer_load_dwordx4 v5, s[8:11], s3 offen offset:3072 lds
  s_waitcnt lgkmcnt(4)
  v_dot2c_f32_bf16 v26, s67, v128
  v_dot2c_f32_bf16 v40, v128, v128
  v_dot2c_f32_bf16 v27, s67, v129
  v_dot2c_f32_bf16 v41, v129, v129
  v_dot2c_f32_bf16 v28, s67, v130
  v_dot2c_f32_bf16 v42, v130, v130
  v_dot2c_f32_bf16 v29, s67, v131
  v_dot2c_f32_bf16 v43, v131, v131
  v_dot2c_f32_bf16 v26, s67, v132
  v_dot2c_f32_bf16 v40, v132, v132
  v_dot2c_f32_bf16 v27, s67, v133
  v_dot2c_f32_bf16 v41, v133, v133
  v_dot2c_f32_bf16 v28, s67, v134
  v_dot2c_f32_bf16 v42, v134, v134
  v_dot2c_f32_bf16 v29, s67, v135
  v_dot2c_f32_bf16 v43, v135, v135
  v_dot2c_f32_bf16 v26, s67, v136
  v_dot2c_f32_bf16 v40, v136, v136
  v_dot2c_f32_bf16 v27, s67, v137
  v_dot2c_f32_bf16 v41, v137, v137
  v_dot2c_f32_bf16 v28, s67, v138
  v_dot2c_f32_bf16 v42, v138, v138
  v_dot2c_f32_bf16 v29, s67, v139
  v_dot2c_f32_bf16 v43, v139, v139
  v_dot2c_f32_bf16 v26, s67, v140
  v_dot2c_f32_bf16 v40, v140, v140
  v_dot2c_f32_bf16 v27, s67, v141
  v_dot2c_f32_bf16 v41, v141, v141
  v_dot2c_f32_bf16 v28, s67, v142
  v_dot2c_f32_bf16 v42, v142, v142
  v_dot2c_f32_bf16 v29, s67, v143
  v_dot2c_f32_bf16 v43, v143, v143
  s_waitcnt vmcnt(10)
  v_add_u32 v17, 65536, v63
  v_xor_b32 v18, 32, v17
  v_xor_b32 v19, 64, v17
  v_xor_b32 v20, 96, v17
  ds_read_b128 v[160:163], v17
  ds_read_b128 v[164:167], v18
  ds_read_b128 v[168:171], v19
  ds_read_b128 v[172:175], v20
  s_add_u32 s3, s65, 5
  s_and_b32 s3, s3, 7
  s_mul_i32 s3, s3, 128
  s_add_u32 s3, s3, s47
  s_add_u32 m0, s46, 114688
  s_nop 0
  buffer_load_dwordx4 v2, s[8:11], s3 offen lds
  buffer_load_dwordx4 v3, s[8:11], s3 offen offset:1024 lds
  buffer_load_dwordx4 v4, s[8:11], s3 offen offset:2048 lds
  buffer_load_dwordx4 v5, s[8:11], s3 offen offset:3072 lds
  s_waitcnt lgkmcnt(4)
  v_dot2c_f32_bf16 v26, s67, v144
  v_dot2c_f32_bf16 v40, v144, v144
  v_dot2c_f32_bf16 v27, s67, v145
  v_dot2c_f32_bf16 v41, v145, v145
  v_dot2c_f32_bf16 v28, s67, v146
  v_dot2c_f32_bf16 v42, v146, v146
  v_dot2c_f32_bf16 v29, s67, v147
  v_dot2c_f32_bf16 v43, v147, v147
  v_dot2c_f32_bf16 v26, s67, v148
  v_dot2c_f32_bf16 v40, v148, v148
  v_dot2c_f32_bf16 v27, s67, v149
  v_dot2c_f32_bf16 v41, v149, v149
  v_dot2c_f32_bf16 v28, s67, v150
  v_dot2c_f32_bf16 v42, v150, v150
  v_dot2c_f32_bf16 v29, s67, v151
  v_dot2c_f32_bf16 v43, v151, v151
  v_dot2c_f32_bf16 v26, s67, v152
  v_dot2c_f32_bf16 v40, v152, v152
  v_dot2c_f32_bf16 v27, s67, v153
  v_dot2c_f32_bf16 v41, v153, v153
  v_dot2c_f32_bf16 v28, s67, v154
  v_dot2c_f32_bf16 v42, v154, v154
  v_dot2c_f32_bf16 v29, s67, v155
  v_dot2c_f32_bf16 v43, v155, v155
  v_dot2c_f32_bf16 v26, s67, v156
  v_dot2c_f32_bf16 v40, v156, v156
  v_dot2c_f32_bf16 v27, s67, v157
  v_dot2c_f32_bf16 v41, v157, v157
  v_dot2c_f32_bf16 v28, s67, v158
  v_dot2c_f32_bf16 v42, v158, v158
  v_dot2c_f32_bf16 v29, s67, v159
  v_dot2c_f32_bf16 v43, v159, v159
  s_waitcnt vmcnt(8)
  v_add_u32 v17, 81920, v63
  v_xor_b32 v18, 32, v17
  v_xor_b32 v19, 64, v17
  v_xor_b32 v20, 96, v17
  ds_read_b128 v[176:179], v17
  ds_read_b128 v[180:183], v18
  ds_read_b128 v[184:187], v19
  ds_read_b128 v[188:191], v20
  s_add_u32 s3, s65, 6
  s_and_b32 s3, s3, 7
  s_mul_i32 s3, s3, 128
  s_add_u32 s3, s3, s47
  s_add_u32 m0, s46, 131072
  s_nop 0
  buffer_load_dwordx4 v2, s[8:11], s3 offen lds
  buffer_load_dwordx4 v3, s[8:11], s3 offen offset:1024 lds
  buffer_load_dwordx4 v4, s[8:11], s3 offen offset:2048 lds
  buffer_load_dwordx4 v5, s[8:11], s3 offen offset:3072 lds
  s_waitcnt lgkmcnt(4)
  v_dot2c_f32_bf16 v26, s67, v160
  v_dot2c_f32_bf16 v40, v160, v160
  v_dot2c_f32_bf16 v27, s67, v161
  v_dot2c_f32_bf16 v41, v161, v161
  v_dot2c_f32_bf16 v28, s67, v162
  v_dot2c_f32_bf16 v42, v162, v162
  v_dot2c_f32_bf16 v29, s67, v163
  v_dot2c_f32_bf16 v43, v163, v163
  v_dot2c_f32_bf16 v26, s67, v164
  v_dot2c_f32_bf16 v40, v164, v164
  v_dot2c_f32_bf16 v27, s67, v165
  v_dot2c_f32_bf16 v41, v165, v165
  v_dot2c_f32_bf16 v28, s67, v166
  v_dot2c_f32_bf16 v42, v166, v166
  v_dot2c_f32_bf16 v29, s67, v167
  v_dot2c_f32_bf16 v43, v167, v167
  v_dot2c_f32_bf16 v26, s67, v168
  v_dot2c_f32_bf16 v40, v168, v168
  v_dot2c_f32_bf16 v27, s67, v169
  v_dot2c_f32_bf16 v41, v169, v169
  v_dot2c_f32_bf16 v28, s67, v170
  v_dot2c_f32_bf16 v42, v170, v170
  v_dot2c_f32_bf16 v29, s67, v171
  v_dot2c_f32_bf16 v43, v171, v171
  v_dot2c_f32_bf16 v26, s67, v172
  v_dot2c_f32_bf16 v40, v172, v172
  v_dot2c_f32_bf16 v27, s67, v173
  v_dot2c_f32_bf16 v41, v173, v173
  v_dot2c_f32_bf16 v28, s67, v174
  v_dot2c_f32_bf16 v42, v174, v174
  v_dot2c_f32_bf16 v29, s67, v175
  v_dot2c_f32_bf16 v43, v175, v175
  s_waitcnt vmcnt(8)
  v_add_u32 v17, 98304, v63
  v_xor_b32 v18, 32, v17
  v_xor_b32 v19, 64, v17
  v_xor_b32 v20, 96, v17
  ds_read_b128 v[192:195], v17
  ds_read_b128 v[196:199], v18
  ds_read_b128 v[200:203], v19
  ds_read_b128 v[204:207], v20
  s_add_u32 s3, s65, 7
  s_and_b32 s3, s3, 7
  s_mul_i32 s3, s3, 128
  s_add_u32 s3, s3, s47
  s_add_u32 m0, s46, 147456
  s_nop 0
  buffer_load_dwordx4 v2, s[8:11], s3 offen lds
  buffer_load_dwordx4 v3, s[8:11], s3 offen offset:1024 lds
  buffer_load_dwordx4 v4, s[8:11], s3 offen offset:2048 lds
  buffer_load_dwordx4 v5, s[8:11], s3 offen offset:3072 lds
  s_waitcnt lgkmcnt(4)
  v_dot2c_f32_bf16 v26, s67, v176
  v_dot2c_f32_bf16 v40, v176, v176
  v_dot2c_f32_bf16 v27, s67, v177
  v_dot2c_f32_bf16 v41, v177, v177
  v_dot2c_f32_bf16 v28, s67, v178
  v_dot2c_f32_bf16 v42, v178, v178
  v_dot2c_f32_bf16 v29, s67, v179
  v_dot2c_f32_bf16 v43, v179, v179
  v_dot2c_f32_bf16 v26, s67, v180
  v_dot2c_f32_bf16 v40, v180, v180
  v_dot2c_f32_bf16 v27, s67, v181
  v_dot2c_f32_bf16 v41, v181, v181
  v_dot2c_f32_bf16 v28, s67, v182
  v_dot2c_f32_bf16 v42, v182, v182
  v_dot2c_f32_bf16 v29, s67, v183
  v_dot2c_f32_bf16 v43, v183, v183
  v_dot2c_f32_bf16 v26, s67, v184
  v_dot2c_f32_bf16 v40, v184, v184
  v_dot2c_f32_bf16 v27, s67, v185
  v_dot2c_f32_bf16 v41, v185, v185
  v_dot2c_f32_bf16 v28, s67, v186
  v_dot2c_f32_bf16 v42, v186, v186
  v_dot2c_f32_bf16 v29, s67, v187
  v_dot2c_f32_bf16 v43, v187, v187
  v_dot2c_f32_bf16 v26, s67, v188
  v_dot2c_f32_bf16 v40, v188, v188
  v_dot2c_f32_bf16 v27, s67, v189
  v_dot2c_f32_bf16 v41, v189, v189
  v_dot2c_f32_bf16 v28, s67, v190
  v_dot2c_f32_bf16 v42, v190, v190
  v_dot2c_f32_bf16 v29, s67, v191
  v_dot2c_f32_bf16 v43, v191, v191
  s_waitcnt vmcnt(8)
  v_add_u32 v17, 114688, v63
  v_xor_b32 v18, 32, v17
  v_xor_b32 v19, 64, v17
  v_xor_b32 v20, 96, v17
  ds_read_b128 v[208:211], v17
  ds_read_b128 v[212:215], v18
  ds_read_b128 v[216:219], v19
  ds_read_b128 v[220:223], v20
  v_add_u32 v2, 4096, v11
  v_add_u32 v3, 27648, v11
  v_add_u32 v4, 3072, v11
  v_add_u32 v5, 26624, v11
  s_add_u32 s3, s65, 0
  s_and_b32 s3, s3, 7
  s_mul_i32 s3, s3, 196608
  s_add_u32 s3, s3, s48
  s_add_u32 m0, s46, 0
  s_nop 0
  buffer_load_dwordx4 v2, s[12:15], s3 offen lds
  buffer_load_dwordx4 v3, s[12:15], s3 offen offset:1024 lds
  buffer_load_dwordx4 v4, s[12:15], s3 offen offset:2048 lds
  buffer_load_dwordx4 v5, s[12:15], s3 offen offset:3072 lds
  s_waitcnt lgkmcnt(4)
  v_dot2c_f32_bf16 v26, s67, v192
  v_dot2c_f32_bf16 v40, v192, v192
  v_dot2c_f32_bf16 v27, s67, v193
  v_dot2c_f32_bf16 v41, v193, v193
  v_dot2c_f32_bf16 v28, s67, v194
  v_dot2c_f32_bf16 v42, v194, v194
  v_dot2c_f32_bf16 v29, s67, v195
  v_dot2c_f32_bf16 v43, v195, v195
  v_dot2c_f32_bf16 v26, s67, v196
  v_dot2c_f32_bf16 v40, v196, v196
  v_dot2c_f32_bf16 v27, s67, v197
  v_dot2c_f32_bf16 v41, v197, v197
  v_dot2c_f32_bf16 v28, s67, v198
  v_dot2c_f32_bf16 v42, v198, v198
  v_dot2c_f32_bf16 v29, s67, v199
  v_dot2c_f32_bf16 v43, v199, v199
  v_dot2c_f32_bf16 v26, s67, v200
  v_dot2c_f32_bf16 v40, v200, v200
  v_dot2c_f32_bf16 v27, s67, v201
  v_dot2c_f32_bf16 v41, v201, v201
  v_dot2c_f32_bf16 v28, s67, v202
  v_dot2c_f32_bf16 v42, v202, v202
  v_dot2c_f32_bf16 v29, s67, v203
  v_dot2c_f32_bf16 v43, v203, v203
  v_dot2c_f32_bf16 v26, s67, v204
  v_dot2c_f32_bf16 v40, v204, v204
  v_dot2c_f32_bf16 v27, s67, v205
  v_dot2c_f32_bf16 v41, v205, v205
  v_dot2c_f32_bf16 v28, s67, v206
  v_dot2c_f32_bf16 v42, v206, v206
  v_dot2c_f32_bf16 v29, s67, v207
  v_dot2c_f32_bf16 v43, v207, v207
  s_waitcnt vmcnt(8)
  v_add_u32 v17, 131072, v63
  v_xor_b32 v18, 32, v17
  v_xor_b32 v19, 64, v17
  v_xor_b32 v20, 96, v17
  ds_read_b128 v[224:227], v17
  ds_read_b128 v[228:231], v18
  ds_read_b128 v[232:235], v19
  ds_read_b128 v[236:239], v20
  s_add_u32 s3, s65, 1
  s_and_b32 s3, s3, 7
  s_mul_i32 s3, s3, 196608
  s_add_u32 s3, s3, s48
  s_add_u32 m0, s46, 16384
  s_nop 0
  buffer_load_dwordx4 v2, s[12:15], s3 offen lds
  buffer_load_dwordx4 v3, s[12:15], s3 offen offset:1024 lds
  buffer_load_dwordx4 v4, s[12:15], s3 offen offset:2048 lds
  buffer_load_dwordx4 v5, s[12:15], s3 offen offset:3072 lds
  s_waitcnt lgkmcnt(4)
  v_dot2c_f32_bf16 v26, s67, v208
  v_dot2c_f32_bf16 v40, v208, v208
  v_dot2c_f32_bf16 v27, s67, v209
  v_dot2c_f32_bf16 v41, v209, v209
  v_dot2c_f32_bf16 v28, s67, v210
  v_dot2c_f32_bf16 v42, v210, v210
  v_dot2c_f32_bf16 v29, s67, v211
  v_dot2c_f32_bf16 v43, v211, v211
  v_dot2c_f32_bf16 v26, s67, v212
  v_dot2c_f32_bf16 v40, v212, v212
  v_dot2c_f32_bf16 v27, s67, v213
  v_dot2c_f32_bf16 v41, v213, v213
  v_dot2c_f32_bf16 v28, s67, v214
  v_dot2c_f32_bf16 v42, v214, v214
  v_dot2c_f32_bf16 v29, s67, v215
  v_dot2c_f32_bf16 v43, v215, v215
  v_dot2c_f32_bf16 v26, s67, v216
  v_dot2c_f32_bf16 v40, v216, v216
  v_dot2c_f32_bf16 v27, s67, v217
  v_dot2c_f32_bf16 v41, v217, v217
  v_dot2c_f32_bf16 v28, s67, v218
  v_dot2c_f32_bf16 v42, v218, v218
  v_dot2c_f32_bf16 v29, s67, v219
  v_dot2c_f32_bf16 v43, v219, v219
  v_dot2c_f32_bf16 v26, s67, v220
  v_dot2c_f32_bf16 v40, v220, v220
  v_dot2c_f32_bf16 v27, s67, v221
  v_dot2c_f32_bf16 v41, v221, v221
  v_dot2c_f32_bf16 v28, s67, v222
  v_dot2c_f32_bf16 v42, v222, v222
  v_dot2c_f32_bf16 v29, s67, v223
  v_dot2c_f32_bf16 v43, v223, v223
  s_waitcnt vmcnt(8)
  v_add_u32 v17, 147456, v63
  v_xor_b32 v18, 32, v17
  v_xor_b32 v19, 64, v17
  v_xor_b32 v20, 96, v17
  ds_read_b128 v[240:243], v17
  ds_read_b128 v[244:247], v18
  ds_read_b128 v[248:251], v19
  ds_read_b128 v[252:255], v20
  s_mov_b64 exec, 1
  v_mov_b32 v62, 0
  v_mov_b32 v61, s72
  buffer_store_dword v61, v62, s[36:39], s75 offen sc1
  s_mov_b64 exec, -1
  s_mov_b64 exec, 1
  v_mov_b32 v61, 0
  buffer_store_dword v61, v25, s[36:39], s69 offen sc1
  s_mov_b64 exec, -1
  s_cmp_eq_u32 s59, 0
  s_cselect_b32 s44, 0, 0x7ffffff0
  v_add_u32 v60, s44, v1
  v_mov_b32 v56, 0
  v_mov_b32 v57, 0
  v_mov_b32 v58, 0
  v_mov_b32 v59, 0
  s_lshl_b32 s7, s45, 10
  s_add_u32 s6, s68, s7
  buffer_store_dwordx4 v[56:59], v60, s[36:39], s6 offen sc1
  s_add_u32 s6, s68, 4096
  s_mov_b64 exec, 0xffff
  buffer_store_dwordx4 v[56:59], v60, s[36:39], s6 offen sc1
  s_mov_b64 exec, -1
  s_waitcnt lgkmcnt(4)
  v_dot2c_f32_bf16 v26, s67, v224
  v_dot2c_f32_bf16 v40, v224, v224
  v_dot2c_f32_bf16 v27, s67, v225
  v_dot2c_f32_bf16 v41, v225, v225
  v_dot2c_f32_bf16 v28, s67, v226
  v_dot2c_f32_bf16 v42, v226, v226
  v_dot2c_f32_bf16 v29, s67, v227
  v_dot2c_f32_bf16 v43, v227, v227
  v_dot2c_f32_bf16 v26, s67, v228
  v_dot2c_f32_bf16 v40, v228, v228
  v_dot2c_f32_bf16 v27, s67, v229
  v_dot2c_f32_bf16 v41, v229, v229
  v_dot2c_f32_bf16 v28, s67, v230
  v_dot2c_f32_bf16 v42, v230, v230
  v_dot2c_f32_bf16 v29, s67, v231
  v_dot2c_f32_bf16 v43, v231, v231
  v_dot2c_f32_bf16 v26, s67, v232
  v_dot2c_f32_bf16 v40, v232, v232
  v_dot2c_f32_bf16 v27, s67, v233
  v_dot2c_f32_bf16 v41, v233, v233
  v_dot2c_f32_bf16 v28, s67, v234
  v_dot2c_f32_bf16 v42, v234, v234
  v_dot2c_f32_bf16 v29, s67, v235
  v_dot2c_f32_bf16 v43, v235, v235
  v_dot2c_f32_bf16 v26, s67, v236
  v_dot2c_f32_bf16 v40, v236, v236
  v_dot2c_f32_bf16 v27, s67, v237
  v_dot2c_f32_bf16 v41, v237, v237
  v_dot2c_f32_bf16 v28, s67, v238
  v_dot2c_f32_bf16 v42, v238, v238
  v_dot2c_f32_bf16 v29, s67, v239
  v_dot2c_f32_bf16 v43, v239, v239
  s_waitcnt lgkmcnt(0)
  v_dot2c_f32_bf16 v26, s67, v240
  v_dot2c_f32_bf16 v40, v240, v240
  v_dot2c_f32_bf16 v27, s67, v241
  v_dot2c_f32_bf16 v41, v241, v241
  v_dot2c_f32_bf16 v28, s67, v242
  v_dot2c_f32_bf16 v42, v242, v242
  v_dot2c_f32_bf16 v29, s67, v243
  v_dot2c_f32_bf16 v43, v243, v243
  v_dot2c_f32_bf16 v26, s67, v244
  v_dot2c_f32_bf16 v40, v244, v244
  v_dot2c_f32_bf16 v27, s67, v245
  v_dot2c_f32_bf16 v41, v245, v245
  v_dot2c_f32_bf16 v28, s67, v246
  v_dot2c_f32_bf16 v42, v246, v246
  v_dot2c_f32_bf16 v29, s67, v247
  v_dot2c_f32_bf16 v43, v247, v247
  v_dot2c_f32_bf16 v26, s67, v248
  v_dot2c_f32_bf16 v40, v248, v248
  v_dot2c_f32_bf16 v27, s67, v249
  v_dot2c_f32_bf16 v41, v249, v249
  v_dot2c_f32_bf16 v28, s67, v250
  v_dot2c_f32_bf16 v42, v250, v250
  v_dot2c_f32_bf16 v29, s67, v251
  v_dot2c_f32_bf16 v43, v251, v251
  v_dot2c_f32_bf16 v26, s67, v252
  v_dot2c_f32_bf16 v40, v252, v252
  v_dot2c_f32_bf16 v27, s67, v253
  v_dot2c_f32_bf16 v41, v253, v253
  v_dot2c_f32_bf16 v28, s67, v254
  v_dot2c_f32_bf16 v42, v254, v254
  v_dot2c_f32_bf16 v29, s67, v255
  v_dot2c_f32_bf16 v43, v255, v255
  v_add_f32 v26, v26, v27
  s_nop 0
  v_add_f32 v28, v28, v29
  v_add_f32 v40, v40, v41
  v_add_f32 v42, v42, v43
  v_add_f32 v26, v26, v28
  v_add_f32 v40, v40, v42
  v_mov_b32 v27, v26
  v_mov_b32 v41, v40
  s_nop 0
  v_permlane32_swap_b32 v26, v27
  v_permlane32_swap_b32 v40, v41
  v_add_f32 v26, v26, v27
  v_add_f32 v40, v40, v41
  v_mul_f32 v23, 0xbb000000, v26
  v_mul_f32 v40, 0x3b000000, v40
  v_fma_f32 v40, -v23, v23, v40
  v_max_f32 v40, 0, v40
  v_add_f32 v40, 0x3727c5ac, v40
  v_rsq_f32 v24, v40
  s_nop 0
  v_mul_f32 v48, v23, v24
  s_mov_b32 s44, 0xffff0000
  v_lshlrev_b32 v32, 16, v128
  v_and_b32 v33, s44, v128
  v_lshlrev_b32 v34, 16, v129
  v_and_b32 v35, s44, v129
  v_lshlrev_b32 v36, 16, v130
  v_and_b32 v37, s44, v130
  v_pk_fma_f32 v[32:33], v[32:33], v[24:25], v[48:49] op_sel_hi:[1,0,0]
  v_lshlrev_b32 v38, 16, v131
  v_and_b32 v39, s44, v131
  v_pk_fma_f32 v[34:35], v[34:35], v[24:25], v[48:49] op_sel_hi:[1,0,0]
  s_add_u32 s3, s65, 2
  s_and_b32 s3, s3, 7
  s_mul_i32 s3, s3, 196608
  s_add_u32 s3, s3, s48
  s_add_u32 m0, s46, 32768
  s_nop 0
  buffer_load_dwordx4 v2, s[12:15], s3 offen lds
  buffer_load_dwordx4 v3, s[12:15], s3 offen offset:1024 lds
  buffer_load_dwordx4 v4, s[12:15], s3 offen offset:2048 lds
  buffer_load_dwordx4 v5, s[12:15], s3 offen offset:3072 lds
  v_lshlrev_b32 v40, 16, v132
  v_and_b32 v41, s44, v132
  v_pk_fma_f32 v[36:37], v[36:37], v[24:25], v[48:49] op_sel_hi:[1,0,0]
  v_cvt_pk_bf16_f32 v128, v32, v33
  v_lshlrev_b32 v42, 16, v133
  v_and_b32 v43, s44, v133
  v_pk_fma_f32 v[38:39], v[38:39], v[24:25], v[48:49] op_sel_hi:[1,0,0]
  v_cvt_pk_bf16_f32 v129, v34, v35
  v_lshlrev_b32 v44, 16, v134
  v_and_b32 v45, s44, v134
  v_pk_fma_f32 v[40:41], v[40:41], v[24:25], v[48:49] op_sel_hi:[1,0,0]
  v_cvt_pk_bf16_f32 v130, v36, v37
  v_lshlrev_b32 v46, 16, v135
  v_and_b32 v47, s44, v135
  v_pk_fma_f32 v[42:43], v[42:43], v[24:25], v[48:49] op_sel_hi:[1,0,0]
  v_cvt_pk_bf16_f32 v131, v38, v39
  v_lshlrev_b32 v32, 16, v136
  v_and_b32 v33, s44, v136
  v_pk_fma_f32 v[44:45], v[44:45], v[24:25], v[48:49] op_sel_hi:[1,0,0]
  v_cvt_pk_bf16_f32 v132, v40, v41
  v_lshlrev_b32 v34, 16, v137
  v_and_b32 v35, s44, v137
  v_pk_fma_f32 v[46:47], v[46:47], v[24:25], v[48:49] op_sel_hi:[1,0,0]
  v_cvt_pk_bf16_f32 v133, v42, v43
  v_lshlrev_b32 v36, 16, v138
  v_and_b32 v37, s44, v138
  v_pk_fma_f32 v[32:33], v[32:33], v[24:25], v[48:49] op_sel_hi:[1,0,0]
  v_cvt_pk_bf16_f32 v134, v44, v45
  v_lshlrev_b32 v38, 16, v139
  v_and_b32 v39, s44, v139
  v_pk_fma_f32 v[34:35], v[34:35], v[24:25], v[48:49] op_sel_hi:[1,0,0]
  v_cvt_pk_bf16_f32 v135, v46, v47
  v_lshlrev_b32 v40, 16, v140
  v_and_b32 v41, s44, v140
  v_pk_fma_f32 v[36:37], v[36:37], v[24:25], v[48:49] op_sel_hi:[1,0,0]
  v_cvt_pk_bf16_f32 v136, v32, v33
  v_lshlrev_b32 v42, 16, v141
  v_and_b32 v43, s44, v141
  v_pk_fma_f32 v[38:39], v[38:39], v[24:25], v[48:49] op_sel_hi:[1,0,0]
  v_cvt_pk_bf16_f32 v137, v34, v35
  v_lshlrev_b32 v44, 16, v142
  v_and_b32 v45, s44, v142
  v_pk_fma_f32 v[40:41], v[40:41], v[24:25], v[48:49] op_sel_hi:[1,0,0]
  v_cvt_pk_bf16_f32 v138, v36, v37
  v_lshlrev_b32 v46, 16, v143
  v_and_b32 v47, s44, v143
  v_pk_fma_f32 v[42:43], v[42:43], v[24:25], v[48:49] op_sel_hi:[1,0,0]
  v_cvt_pk_bf16_f32 v139, v38, v39
  v_lshlrev_b32 v32, 16, v144
  v_and_b32 v33, s44, v144
  v_pk_fma_f32 v[44:45], v[44:45], v[24:25], v[48:49] op_sel_hi:[1,0,0]
  v_cvt_pk_bf16_f32 v140, v40, v41
  v_lshlrev_b32 v34, 16, v145
  v_and_b32 v35, s44, v145
  v_pk_fma_f32 v[46:47], v[46:47], v[24:25], v[48:49] op_sel_hi:[1,0,0]
  v_cvt_pk_bf16_f32 v141, v42, v43
  v_lshlrev_b32 v36, 16, v146
  v_and_b32 v37, s44, v146
  v_pk_fma_f32 v[32:33], v[32:33], v[24:25], v[48:49] op_sel_hi:[1,0,0]
  v_cvt_pk_bf16_f32 v142, v44, v45
  v_lshlrev_b32 v38, 16, v147
  v_and_b32 v39, s44, v147
  v_pk_fma_f32 v[34:35], v[34:35], v[24:25], v[48:49] op_sel_hi:[1,0,0]
  v_cvt_pk_bf16_f32 v143, v46, v47
  v_lshlrev_b32 v40, 16, v148
  v_and_b32 v41, s44, v148
  v_pk_fma_f32 v[36:37], v[36:37], v[24:25], v[48:49] op_sel_hi:[1,0,0]
  v_cvt_pk_bf16_f32 v144, v32, v33
  v_lshlrev_b32 v42, 16, v149
  v_and_b32 v43, s44, v149
  v_pk_fma_f32 v[38:39], v[38:39], v[24:25], v[48:49] op_sel_hi:[1,0,0]
  v_cvt_pk_bf16_f32 v145, v34, v35
  s_add_u32 s3, s65, 3
  s_and_b32 s3, s3, 7
  s_mul_i32 s3, s3, 196608
  s_add_u32 s3, s3, s48
  s_add_u32 m0, s46, 49152
  s_nop 0
  buffer_load_dwordx4 v2, s[12:15], s3 offen lds
  buffer_load_dwordx4 v3, s[12:15], s3 offen offset:1024 lds
  buffer_load_dwordx4 v4, s[12:15], s3 offen offset:2048 lds
  buffer_load_dwordx4 v5, s[12:15], s3 offen offset:3072 lds
  v_lshlrev_b32 v44, 16, v150
  v_and_b32 v45, s44, v150
  v_pk_fma_f32 v[40:41], v[40:41], v[24:25], v[48:49] op_sel_hi:[1,0,0]
  v_cvt_pk_bf16_f32 v146, v36, v37
  v_lshlrev_b32 v46, 16, v151
  v_and_b32 v47, s44, v151
  v_pk_fma_f32 v[42:43], v[42:43], v[24:25], v[48:49] op_sel_hi:[1,0,0]
  v_cvt_pk_bf16_f32 v147, v38, v39
  v_lshlrev_b32 v32, 16, v152
  v_and_b32 v33, s44, v152
  v_pk_fma_f32 v[44:45], v[44:45], v[24:25], v[48:49] op_sel_hi:[1,0,0]
  v_cvt_pk_bf16_f32 v148, v40, v41
  v_lshlrev_b32 v34, 16, v153
  v_and_b32 v35, s44, v153
  v_pk_fma_f32 v[46:47], v[46:47], v[24:25], v[48:49] op_sel_hi:[1,0,0]
  v_cvt_pk_bf16_f32 v149, v42, v43
  v_lshlrev_b32 v36, 16, v154
  v_and_b32 v37, s44, v154
  v_pk_fma_f32 v[32:33], v[32:33], v[24:25], v[48:49] op_sel_hi:[1,0,0]
  v_cvt_pk_bf16_f32 v150, v44, v45
  v_lshlrev_b32 v38, 16, v155
  v_and_b32 v39, s44, v155
  v_pk_fma_f32 v[34:35], v[34:35], v[24:25], v[48:49] op_sel_hi:[1,0,0]
  v_cvt_pk_bf16_f32 v151, v46, v47
  v_lshlrev_b32 v40, 16, v156
  v_and_b32 v41, s44, v156
  v_pk_fma_f32 v[36:37], v[36:37], v[24:25], v[48:49] op_sel_hi:[1,0,0]
  v_cvt_pk_bf16_f32 v152, v32, v33
  v_lshlrev_b32 v42, 16, v157
  v_and_b32 v43, s44, v157
  v_pk_fma_f32 v[38:39], v[38:39], v[24:25], v[48:49] op_sel_hi:[1,0,0]
  v_cvt_pk_bf16_f32 v153, v34, v35
  v_lshlrev_b32 v44, 16, v158
  v_and_b32 v45, s44, v158
  v_pk_fma_f32 v[40:41], v[40:41], v[24:25], v[48:49] op_sel_hi:[1,0,0]
  v_cvt_pk_bf16_f32 v154, v36, v37
  v_lshlrev_b32 v46, 16, v159
  v_and_b32 v47, s44, v159
  v_pk_fma_f32 v[42:43], v[42:43], v[24:25], v[48:49] op_sel_hi:[1,0,0]
  v_cvt_pk_bf16_f32 v155, v38, v39
  v_lshlrev_b32 v32, 16, v160
  v_and_b32 v33, s44, v160
  v_pk_fma_f32 v[44:45], v[44:45], v[24:25], v[48:49] op_sel_hi:[1,0,0]
  v_cvt_pk_bf16_f32 v156, v40, v41
  v_lshlrev_b32 v34, 16, v161
  v_and_b32 v35, s44, v161
  v_pk_fma_f32 v[46:47], v[46:47], v[24:25], v[48:49] op_sel_hi:[1,0,0]
  v_cvt_pk_bf16_f32 v157, v42, v43
  v_lshlrev_b32 v36, 16, v162
  v_and_b32 v37, s44, v162
  v_pk_fma_f32 v[32:33], v[32:33], v[24:25], v[48:49] op_sel_hi:[1,0,0]
  v_cvt_pk_bf16_f32 v158, v44, v45
  v_lshlrev_b32 v38, 16, v163
  v_and_b32 v39, s44, v163
  v_pk_fma_f32 v[34:35], v[34:35], v[24:25], v[48:49] op_sel_hi:[1,0,0]
  v_cvt_pk_bf16_f32 v159, v46, v47
  v_lshlrev_b32 v40, 16, v164
  v_and_b32 v41, s44, v164
  v_pk_fma_f32 v[36:37], v[36:37], v[24:25], v[48:49] op_sel_hi:[1,0,0]
  v_cvt_pk_bf16_f32 v160, v32, v33
  v_lshlrev_b32 v42, 16, v165
  v_and_b32 v43, s44, v165
  v_pk_fma_f32 v[38:39], v[38:39], v[24:25], v[48:49] op_sel_hi:[1,0,0]
  v_cvt_pk_bf16_f32 v161, v34, v35
  v_lshlrev_b32 v44, 16, v166
  v_and_b32 v45, s44, v166
  v_pk_fma_f32 v[40:41], v[40:41], v[24:25], v[48:49] op_sel_hi:[1,0,0]
  v_cvt_pk_bf16_f32 v162, v36, v37
  v_lshlrev_b32 v46, 16, v167
  v_and_b32 v47, s44, v167
  v_pk_fma_f32 v[42:43], v[42:43], v[24:25], v[48:49] op_sel_hi:[1,0,0]
  v_cvt_pk_bf16_f32 v163, v38, v39
  s_add_u32 s3, s65, 4
  s_and_b32 s3, s3, 7
  s_mul_i32 s3, s3, 196608
  s_add_u32 s3, s3, s48
  s_add_u32 m0, s46, 65536
  s_nop 0
  buffer_load_dwordx4 v2, s[12:15], s3 offen lds
  buffer_load_dwordx4 v3, s[12:15], s3 offen offset:1024 lds
  buffer_load_dwordx4 v4, s[12:15], s3 offen offset:2048 lds
  buffer_load_dwordx4 v5, s[12:15], s3 offen offset:3072 lds
  v_lshlrev_b32 v32, 16, v168
  v_and_b32 v33, s44, v168
  v_pk_fma_f32 v[44:45], v[44:45], v[24:25], v[48:49] op_sel_hi:[1,0,0]
  v_cvt_pk_bf16_f32 v164, v40, v41
  v_lshlrev_b32 v34, 16, v169
  v_and_b32 v35, s44, v169
  v_pk_fma_f32 v[46:47], v[46:47], v[24:25], v[48:49] op_sel_hi:[1,0,0]
  v_cvt_pk_bf16_f32 v165, v42, v43
  v_lshlrev_b32 v36, 16, v170
  v_and_b32 v37, s44, v170
  v_pk_fma_f32 v[32:33], v[32:33], v[24:25], v[48:49] op_sel_hi:[1,0,0]
  v_cvt_pk_bf16_f32 v166, v44, v45
  v_lshlrev_b32 v38, 16, v171
  v_and_b32 v39, s44, v171
  v_pk_fma_f32 v[34:35], v[34:35], v[24:25], v[48:49] op_sel_hi:[1,0,0]
  v_cvt_pk_bf16_f32 v167, v46, v47
  v_lshlrev_b32 v40, 16, v172
  v_and_b32 v41, s44, v172
  v_pk_fma_f32 v[36:37], v[36:37], v[24:25], v[48:49] op_sel_hi:[1,0,0]
  v_cvt_pk_bf16_f32 v168, v32, v33
  v_lshlrev_b32 v42, 16, v173
  v_and_b32 v43, s44, v173
  v_pk_fma_f32 v[38:39], v[38:39], v[24:25], v[48:49] op_sel_hi:[1,0,0]
  v_cvt_pk_bf16_f32 v169, v34, v35
  v_lshlrev_b32 v44, 16, v174
  v_and_b32 v45, s44, v174
  v_pk_fma_f32 v[40:41], v[40:41], v[24:25], v[48:49] op_sel_hi:[1,0,0]
  v_cvt_pk_bf16_f32 v170, v36, v37
  v_lshlrev_b32 v46, 16, v175
  v_and_b32 v47, s44, v175
  v_pk_fma_f32 v[42:43], v[42:43], v[24:25], v[48:49] op_sel_hi:[1,0,0]
  v_cvt_pk_bf16_f32 v171, v38, v39
  v_lshlrev_b32 v32, 16, v176
  v_and_b32 v33, s44, v176
  v_pk_fma_f32 v[44:45], v[44:45], v[24:25], v[48:49] op_sel_hi:[1,0,0]
  v_cvt_pk_bf16_f32 v172, v40, v41
  v_lshlrev_b32 v34, 16, v177
  v_and_b32 v35, s44, v177
  v_pk_fma_f32 v[46:47], v[46:47], v[24:25], v[48:49] op_sel_hi:[1,0,0]
  v_cvt_pk_bf16_f32 v173, v42, v43
  v_lshlrev_b32 v36, 16, v178
  v_and_b32 v37, s44, v178
  v_pk_fma_f32 v[32:33], v[32:33], v[24:25], v[48:49] op_sel_hi:[1,0,0]
  v_cvt_pk_bf16_f32 v174, v44, v45
  v_lshlrev_b32 v38, 16, v179
  v_and_b32 v39, s44, v179
  v_pk_fma_f32 v[34:35], v[34:35], v[24:25], v[48:49] op_sel_hi:[1,0,0]
  v_cvt_pk_bf16_f32 v175, v46, v47
  v_lshlrev_b32 v40, 16, v180
  v_and_b32 v41, s44, v180
  v_pk_fma_f32 v[36:37], v[36:37], v[24:25], v[48:49] op_sel_hi:[1,0,0]
  v_cvt_pk_bf16_f32 v176, v32, v33
  v_lshlrev_b32 v42, 16, v181
  v_and_b32 v43, s44, v181
  v_pk_fma_f32 v[38:39], v[38:39], v[24:25], v[48:49] op_sel_hi:[1,0,0]
  v_cvt_pk_bf16_f32 v177, v34, v35
  v_lshlrev_b32 v44, 16, v182
  v_and_b32 v45, s44, v182
  v_pk_fma_f32 v[40:41], v[40:41], v[24:25], v[48:49] op_sel_hi:[1,0,0]
  v_cvt_pk_bf16_f32 v178, v36, v37
  v_lshlrev_b32 v46, 16, v183
  v_and_b32 v47, s44, v183
  v_pk_fma_f32 v[42:43], v[42:43], v[24:25], v[48:49] op_sel_hi:[1,0,0]
  v_cvt_pk_bf16_f32 v179, v38, v39
  v_lshlrev_b32 v32, 16, v184
  v_and_b32 v33, s44, v184
  v_pk_fma_f32 v[44:45], v[44:45], v[24:25], v[48:49] op_sel_hi:[1,0,0]
  v_cvt_pk_bf16_f32 v180, v40, v41
  v_lshlrev_b32 v34, 16, v185
  v_and_b32 v35, s44, v185
  v_pk_fma_f32 v[46:47], v[46:47], v[24:25], v[48:49] op_sel_hi:[1,0,0]
  v_cvt_pk_bf16_f32 v181, v42, v43
  s_add_u32 s3, s65, 5
  s_and_b32 s3, s3, 7
  s_mul_i32 s3, s3, 196608
  s_add_u32 s3, s3, s48
  s_add_u32 m0, s46, 81920
  s_nop 0
  buffer_load_dwordx4 v2, s[12:15], s3 offen lds
  buffer_load_dwordx4 v3, s[12:15], s3 offen offset:1024 lds
  buffer_load_dwordx4 v4, s[12:15], s3 offen offset:2048 lds
  buffer_load_dwordx4 v5, s[12:15], s3 offen offset:3072 lds
  v_lshlrev_b32 v36, 16, v186
  v_and_b32 v37, s44, v186
  v_pk_fma_f32 v[32:33], v[32:33], v[24:25], v[48:49] op_sel_hi:[1,0,0]
  v_cvt_pk_bf16_f32 v182, v44, v45
  v_lshlrev_b32 v38, 16, v187
  v_and_b32 v39, s44, v187
  v_pk_fma_f32 v[34:35], v[34:35], v[24:25], v[48:49] op_sel_hi:[1,0,0]
  v_cvt_pk_bf16_f32 v183, v46, v47
  v_lshlrev_b32 v40, 16, v188
  v_and_b32 v41, s44, v188
  v_pk_fma_f32 v[36:37], v[36:37], v[24:25], v[48:49] op_sel_hi:[1,0,0]
  v_cvt_pk_bf16_f32 v184, v32, v33
  v_lshlrev_b32 v42, 16, v189
  v_and_b32 v43, s44, v189
  v_pk_fma_f32 v[38:39], v[38:39], v[24:25], v[48:49] op_sel_hi:[1,0,0]
  v_cvt_pk_bf16_f32 v185, v34, v35
  v_lshlrev_b32 v44, 16, v190
  v_and_b32 v45, s44, v190
  v_pk_fma_f32 v[40:41], v[40:41], v[24:25], v[48:49] op_sel_hi:[1,0,0]
  v_cvt_pk_bf16_f32 v186, v36, v37
  v_lshlrev_b32 v46, 16, v191
  v_and_b32 v47, s44, v191
  v_pk_fma_f32 v[42:43], v[42:43], v[24:25], v[48:49] op_sel_hi:[1,0,0]
  v_cvt_pk_bf16_f32 v187, v38, v39
  v_lshlrev_b32 v32, 16, v192
  v_and_b32 v33, s44, v192
  v_pk_fma_f32 v[44:45], v[44:45], v[24:25], v[48:49] op_sel_hi:[1,0,0]
  v_cvt_pk_bf16_f32 v188, v40, v41
  v_lshlrev_b32 v34, 16, v193
  v_and_b32 v35, s44, v193
  v_pk_fma_f32 v[46:47], v[46:47], v[24:25], v[48:49] op_sel_hi:[1,0,0]
  v_cvt_pk_bf16_f32 v189, v42, v43
  v_lshlrev_b32 v36, 16, v194
  v_and_b32 v37, s44, v194
  v_pk_fma_f32 v[32:33], v[32:33], v[24:25], v[48:49] op_sel_hi:[1,0,0]
  v_cvt_pk_bf16_f32 v190, v44, v45
  v_lshlrev_b32 v38, 16, v195
  v_and_b32 v39, s44, v195
  v_pk_fma_f32 v[34:35], v[34:35], v[24:25], v[48:49] op_sel_hi:[1,0,0]
  v_cvt_pk_bf16_f32 v191, v46, v47
  v_lshlrev_b32 v40, 16, v196
  v_and_b32 v41, s44, v196
  v_pk_fma_f32 v[36:37], v[36:37], v[24:25], v[48:49] op_sel_hi:[1,0,0]
  v_cvt_pk_bf16_f32 v192, v32, v33
  v_lshlrev_b32 v42, 16, v197
  v_and_b32 v43, s44, v197
  v_pk_fma_f32 v[38:39], v[38:39], v[24:25], v[48:49] op_sel_hi:[1,0,0]
  v_cvt_pk_bf16_f32 v193, v34, v35
  v_lshlrev_b32 v44, 16, v198
  v_and_b32 v45, s44, v198
  v_pk_fma_f32 v[40:41], v[40:41], v[24:25], v[48:49] op_sel_hi:[1,0,0]
  v_cvt_pk_bf16_f32 v194, v36, v37
  v_lshlrev_b32 v46, 16, v199
  v_and_b32 v47, s44, v199
  v_pk_fma_f32 v[42:43], v[42:43], v[24:25], v[48:49] op_sel_hi:[1,0,0]
  v_cvt_pk_bf16_f32 v195, v38, v39
  v_lshlrev_b32 v32, 16, v200
  v_and_b32 v33, s44, v200
  v_pk_fma_f32 v[44:45], v[44:45], v[24:25], v[48:49] op_sel_hi:[1,0,0]
  v_cvt_pk_bf16_f32 v196, v40, v41
  v_lshlrev_b32 v34, 16, v201
  v_and_b32 v35, s44, v201
  v_pk_fma_f32 v[46:47], v[46:47], v[24:25], v[48:49] op_sel_hi:[1,0,0]
  v_cvt_pk_bf16_f32 v197, v42, v43
  v_lshlrev_b32 v36, 16, v202
  v_and_b32 v37, s44, v202
  v_pk_fma_f32 v[32:33], v[32:33], v[24:25], v[48:49] op_sel_hi:[1,0,0]
  v_cvt_pk_bf16_f32 v198, v44, v45
  v_lshlrev_b32 v38, 16, v203
  v_and_b32 v39, s44, v203
  v_pk_fma_f32 v[34:35], v[34:35], v[24:25], v[48:49] op_sel_hi:[1,0,0]
  v_cvt_pk_bf16_f32 v199, v46, v47
  s_add_u32 s3, s65, 6
  s_and_b32 s3, s3, 7
  s_mul_i32 s3, s3, 196608
  s_add_u32 s3, s3, s48
  s_add_u32 m0, s46, 98304
  s_nop 0
  buffer_load_dwordx4 v2, s[12:15], s3 offen lds
  buffer_load_dwordx4 v3, s[12:15], s3 offen offset:1024 lds
  buffer_load_dwordx4 v4, s[12:15], s3 offen offset:2048 lds
  buffer_load_dwordx4 v5, s[12:15], s3 offen offset:3072 lds
  v_lshlrev_b32 v40, 16, v204
  v_and_b32 v41, s44, v204
  v_pk_fma_f32 v[36:37], v[36:37], v[24:25], v[48:49] op_sel_hi:[1,0,0]
  v_cvt_pk_bf16_f32 v200, v32, v33
  v_lshlrev_b32 v42, 16, v205
  v_and_b32 v43, s44, v205
  v_pk_fma_f32 v[38:39], v[38:39], v[24:25], v[48:49] op_sel_hi:[1,0,0]
  v_cvt_pk_bf16_f32 v201, v34, v35
  v_lshlrev_b32 v44, 16, v206
  v_and_b32 v45, s44, v206
  v_pk_fma_f32 v[40:41], v[40:41], v[24:25], v[48:49] op_sel_hi:[1,0,0]
  v_cvt_pk_bf16_f32 v202, v36, v37
  v_lshlrev_b32 v46, 16, v207
  v_and_b32 v47, s44, v207
  v_pk_fma_f32 v[42:43], v[42:43], v[24:25], v[48:49] op_sel_hi:[1,0,0]
  v_cvt_pk_bf16_f32 v203, v38, v39
  v_lshlrev_b32 v32, 16, v208
  v_and_b32 v33, s44, v208
  v_pk_fma_f32 v[44:45], v[44:45], v[24:25], v[48:49] op_sel_hi:[1,0,0]
  v_cvt_pk_bf16_f32 v204, v40, v41
  v_lshlrev_b32 v34, 16, v209
  v_and_b32 v35, s44, v209
  v_pk_fma_f32 v[46:47], v[46:47], v[24:25], v[48:49] op_sel_hi:[1,0,0]
  v_cvt_pk_bf16_f32 v205, v42, v43
  v_lshlrev_b32 v36, 16, v210
  v_and_b32 v37, s44, v210
  v_pk_fma_f32 v[32:33], v[32:33], v[24:25], v[48:49] op_sel_hi:[1,0,0]
  v_cvt_pk_bf16_f32 v206, v44, v45
  v_lshlrev_b32 v38, 16, v211
  v_and_b32 v39, s44, v211
  v_pk_fma_f32 v[34:35], v[34:35], v[24:25], v[48:49] op_sel_hi:[1,0,0]
  v_cvt_pk_bf16_f32 v207, v46, v47
  v_lshlrev_b32 v40, 16, v212
  v_and_b32 v41, s44, v212
  v_pk_fma_f32 v[36:37], v[36:37], v[24:25], v[48:49] op_sel_hi:[1,0,0]
  v_cvt_pk_bf16_f32 v208, v32, v33
  v_lshlrev_b32 v42, 16, v213
  v_and_b32 v43, s44, v213
  v_pk_fma_f32 v[38:39], v[38:39], v[24:25], v[48:49] op_sel_hi:[1,0,0]
  v_cvt_pk_bf16_f32 v209, v34, v35
  v_lshlrev_b32 v44, 16, v214
  v_and_b32 v45, s44, v214
  v_pk_fma_f32 v[40:41], v[40:41], v[24:25], v[48:49] op_sel_hi:[1,0,0]
  v_cvt_pk_bf16_f32 v210, v36, v37
  v_lshlrev_b32 v46, 16, v215
  v_and_b32 v47, s44, v215
  v_pk_fma_f32 v[42:43], v[42:43], v[24:25], v[48:49] op_sel_hi:[1,0,0]
  v_cvt_pk_bf16_f32 v211, v38, v39
  v_lshlrev_b32 v32, 16, v216
  v_and_b32 v33, s44, v216
  v_pk_fma_f32 v[44:45], v[44:45], v[24:25], v[48:49] op_sel_hi:[1,0,0]
  v_cvt_pk_bf16_f32 v212, v40, v41
  v_lshlrev_b32 v34, 16, v217
  v_and_b32 v35, s44, v217
  v_pk_fma_f32 v[46:47], v[46:47], v[24:25], v[48:49] op_sel_hi:[1,0,0]
  v_cvt_pk_bf16_f32 v213, v42, v43
  v_lshlrev_b32 v36, 16, v218
  v_and_b32 v37, s44, v218
  v_pk_fma_f32 v[32:33], v[32:33], v[24:25], v[48:49] op_sel_hi:[1,0,0]
  v_cvt_pk_bf16_f32 v214, v44, v45
  v_lshlrev_b32 v38, 16, v219
  v_and_b32 v39, s44, v219
  v_pk_fma_f32 v[34:35], v[34:35], v[24:25], v[48:49] op_sel_hi:[1,0,0]
  v_cvt_pk_bf16_f32 v215, v46, v47
  v_lshlrev_b32 v40, 16, v220
  v_and_b32 v41, s44, v220
  v_pk_fma_f32 v[36:37], v[36:37], v[24:25], v[48:49] op_sel_hi:[1,0,0]
  v_cvt_pk_bf16_f32 v216, v32, v33
  v_lshlrev_b32 v42, 16, v221
  v_and_b32 v43, s44, v221
  v_pk_fma_f32 v[38:39], v[38:39], v[24:25], v[48:49] op_sel_hi:[1,0,0]
  v_cvt_pk_bf16_f32 v217, v34, v35
  s_add_u32 s3, s65, 7
  s_and_b32 s3, s3, 7
  s_mul_i32 s3, s3, 196608
  s_add_u32 s3, s3, s48
  s_add_u32 m0, s46, 114688
  s_nop 0
  buffer_load_dwordx4 v2, s[12:15], s3 offen lds
  buffer_load_dwordx4 v3, s[12:15], s3 offen offset:1024 lds
  buffer_load_dwordx4 v4, s[12:15], s3 offen offset:2048 lds
  buffer_load_dwordx4 v5, s[12:15], s3 offen offset:3072 lds
  v_lshlrev_b32 v44, 16, v222
  v_and_b32 v45, s44, v222
  v_pk_fma_f32 v[40:41], v[40:41], v[24:25], v[48:49] op_sel_hi:[1,0,0]
  v_cvt_pk_bf16_f32 v218, v36, v37
  v_lshlrev_b32 v46, 16, v223
  v_and_b32 v47, s44, v223
  v_pk_fma_f32 v[42:43], v[42:43], v[24:25], v[48:49] op_sel_hi:[1,0,0]
  v_cvt_pk_bf16_f32 v219, v38, v39
  v_lshlrev_b32 v32, 16, v224
  v_and_b32 v33, s44, v224
  v_pk_fma_f32 v[44:45], v[44:45], v[24:25], v[48:49] op_sel_hi:[1,0,0]
  v_cvt_pk_bf16_f32 v220, v40, v41
  v_lshlrev_b32 v34, 16, v225
  v_and_b32 v35, s44, v225
  v_pk_fma_f32 v[46:47], v[46:47], v[24:25], v[48:49] op_sel_hi:[1,0,0]
  v_cvt_pk_bf16_f32 v221, v42, v43
  v_lshlrev_b32 v36, 16, v226
  v_and_b32 v37, s44, v226
  v_pk_fma_f32 v[32:33], v[32:33], v[24:25], v[48:49] op_sel_hi:[1,0,0]
  v_cvt_pk_bf16_f32 v222, v44, v45
  v_lshlrev_b32 v38, 16, v227
  v_and_b32 v39, s44, v227
  v_pk_fma_f32 v[34:35], v[34:35], v[24:25], v[48:49] op_sel_hi:[1,0,0]
  v_cvt_pk_bf16_f32 v223, v46, v47
  v_lshlrev_b32 v40, 16, v228
  v_and_b32 v41, s44, v228
  v_pk_fma_f32 v[36:37], v[36:37], v[24:25], v[48:49] op_sel_hi:[1,0,0]
  v_cvt_pk_bf16_f32 v224, v32, v33
  v_lshlrev_b32 v42, 16, v229
  v_and_b32 v43, s44, v229
  v_pk_fma_f32 v[38:39], v[38:39], v[24:25], v[48:49] op_sel_hi:[1,0,0]
  v_cvt_pk_bf16_f32 v225, v34, v35
  v_lshlrev_b32 v44, 16, v230
  v_and_b32 v45, s44, v230
  v_pk_fma_f32 v[40:41], v[40:41], v[24:25], v[48:49] op_sel_hi:[1,0,0]
  v_cvt_pk_bf16_f32 v226, v36, v37
  v_lshlrev_b32 v46, 16, v231
  v_and_b32 v47, s44, v231
  v_pk_fma_f32 v[42:43], v[42:43], v[24:25], v[48:49] op_sel_hi:[1,0,0]
  v_cvt_pk_bf16_f32 v227, v38, v39
  v_lshlrev_b32 v32, 16, v232
  v_and_b32 v33, s44, v232
  v_pk_fma_f32 v[44:45], v[44:45], v[24:25], v[48:49] op_sel_hi:[1,0,0]
  v_cvt_pk_bf16_f32 v228, v40, v41
  v_lshlrev_b32 v34, 16, v233
  v_and_b32 v35, s44, v233
  v_pk_fma_f32 v[46:47], v[46:47], v[24:25], v[48:49] op_sel_hi:[1,0,0]
  v_cvt_pk_bf16_f32 v229, v42, v43
  v_lshlrev_b32 v36, 16, v234
  v_and_b32 v37, s44, v234
  v_pk_fma_f32 v[32:33], v[32:33], v[24:25], v[48:49] op_sel_hi:[1,0,0]
  v_cvt_pk_bf16_f32 v230, v44, v45
  v_lshlrev_b32 v38, 16, v235
  v_and_b32 v39, s44, v235
  v_pk_fma_f32 v[34:35], v[34:35], v[24:25], v[48:49] op_sel_hi:[1,0,0]
  v_cvt_pk_bf16_f32 v231, v46, v47
  v_lshlrev_b32 v40, 16, v236
  v_and_b32 v41, s44, v236
  v_pk_fma_f32 v[36:37], v[36:37], v[24:25], v[48:49] op_sel_hi:[1,0,0]
  v_cvt_pk_bf16_f32 v232, v32, v33
  v_lshlrev_b32 v42, 16, v237
  v_and_b32 v43, s44, v237
  v_pk_fma_f32 v[38:39], v[38:39], v[24:25], v[48:49] op_sel_hi:[1,0,0]
  v_cvt_pk_bf16_f32 v233, v34, v35
  v_lshlrev_b32 v44, 16, v238
  v_and_b32 v45, s44, v238
  v_pk_fma_f32 v[40:41], v[40:41], v[24:25], v[48:49] op_sel_hi:[1,0,0]
  v_cvt_pk_bf16_f32 v234, v36, v37
  v_lshlrev_b32 v46, 16, v239
  v_and_b32 v47, s44, v239
  v_pk_fma_f32 v[42:43], v[42:43], v[24:25], v[48:49] op_sel_hi:[1,0,0]
  v_cvt_pk_bf16_f32 v235, v38, v39
  v_lshlrev_b32 v32, 16, v240
  v_and_b32 v33, s44, v240
  v_pk_fma_f32 v[44:45], v[44:45], v[24:25], v[48:49] op_sel_hi:[1,0,0]
  v_cvt_pk_bf16_f32 v236, v40, v41
  v_lshlrev_b32 v34, 16, v241
  v_and_b32 v35, s44, v241
  v_pk_fma_f32 v[46:47], v[46:47], v[24:25], v[48:49] op_sel_hi:[1,0,0]
  v_cvt_pk_bf16_f32 v237, v42, v43
  v_lshlrev_b32 v36, 16, v242
  v_and_b32 v37, s44, v242
  v_pk_fma_f32 v[32:33], v[32:33], v[24:25], v[48:49] op_sel_hi:[1,0,0]
  v_cvt_pk_bf16_f32 v238, v44, v45
  v_lshlrev_b32 v38, 16, v243
  v_and_b32 v39, s44, v243
  v_pk_fma_f32 v[34:35], v[34:35], v[24:25], v[48:49] op_sel_hi:[1,0,0]
  v_cvt_pk_bf16_f32 v239, v46, v47
  v_lshlrev_b32 v40, 16, v244
  v_and_b32 v41, s44, v244
  v_pk_fma_f32 v[36:37], v[36:37], v[24:25], v[48:49] op_sel_hi:[1,0,0]
  v_cvt_pk_bf16_f32 v240, v32, v33
  v_lshlrev_b32 v42, 16, v245
  v_and_b32 v43, s44, v245
  v_pk_fma_f32 v[38:39], v[38:39], v[24:25], v[48:49] op_sel_hi:[1,0,0]
  v_cvt_pk_bf16_f32 v241, v34, v35
  v_lshlrev_b32 v44, 16, v246
  v_and_b32 v45, s44, v246
  v_pk_fma_f32 v[40:41], v[40:41], v[24:25], v[48:49] op_sel_hi:[1,0,0]
  v_cvt_pk_bf16_f32 v242, v36, v37
  v_lshlrev_b32 v46, 16, v247
  v_and_b32 v47, s44, v247
  v_pk_fma_f32 v[42:43], v[42:43], v[24:25], v[48:49] op_sel_hi:[1,0,0]
  v_cvt_pk_bf16_f32 v243, v38, v39
  v_lshlrev_b32 v32, 16, v248
  v_and_b32 v33, s44, v248
  v_pk_fma_f32 v[44:45], v[44:45], v[24:25], v[48:49] op_sel_hi:[1,0,0]
  v_cvt_pk_bf16_f32 v244, v40, v41
  v_lshlrev_b32 v34, 16, v249
  v_and_b32 v35, s44, v249
  v_pk_fma_f32 v[46:47], v[46:47], v[24:25], v[48:49] op_sel_hi:[1,0,0]
  v_cvt_pk_bf16_f32 v245, v42, v43
  s_waitcnt vmcnt(32)
  s_waitcnt vmcnt(24)
  s_barrier
  v_add_u32 v17, 0, v14
  v_xor_b32 v18, 64, v17
  ds_read_b64_tr_b16 a[0:1], v17 offset:0
  ds_read_b64_tr_b16 a[2:3], v17 offset:512
  ds_read_b64_tr_b16 a[4:5], v18 offset:0
  ds_read_b64_tr_b16 a[6:7], v18 offset:512
  ds_read_b64_tr_b16 a[8:9], v17 offset:2048
  ds_read_b64_tr_b16 a[10:11], v17 offset:2560
  ds_read_b64_tr_b16 a[12:13], v18 offset:2048
  ds_read_b64_tr_b16 a[14:15], v18 offset:2560
  ds_read_b64_tr_b16 a[16:17], v17 offset:4096
  ds_read_b64_tr_b16 a[18:19], v17 offset:4608
  ds_read_b64_tr_b16 a[20:21], v18 offset:4096
  ds_read_b64_tr_b16 a[22:23], v18 offset:4608
  v_lshlrev_b32 v36, 16, v250
  v_and_b32 v37, s44, v250
  v_pk_fma_f32 v[32:33], v[32:33], v[24:25], v[48:49] op_sel_hi:[1,0,0]
  v_cvt_pk_bf16_f32 v246, v44, v45
  v_lshlrev_b32 v38, 16, v251
  v_and_b32 v39, s44, v251
  v_pk_fma_f32 v[34:35], v[34:35], v[24:25], v[48:49] op_sel_hi:[1,0,0]
  v_cvt_pk_bf16_f32 v247, v46, v47
  v_lshlrev_b32 v40, 16, v252
  v_and_b32 v41, s44, v252
  v_pk_fma_f32 v[36:37], v[36:37], v[24:25], v[48:49] op_sel_hi:[1,0,0]
  v_cvt_pk_bf16_f32 v248, v32, v33
  v_lshlrev_b32 v42, 16, v253
  v_and_b32 v43, s44, v253
  v_pk_fma_f32 v[38:39], v[38:39], v[24:25], v[48:49] op_sel_hi:[1,0,0]
  v_cvt_pk_bf16_f32 v249, v34, v35
  v_lshlrev_b32 v44, 16, v254
  v_and_b32 v45, s44, v254
  v_pk_fma_f32 v[40:41], v[40:41], v[24:25], v[48:49] op_sel_hi:[1,0,0]
  v_cvt_pk_bf16_f32 v250, v36, v37
  v_lshlrev_b32 v46, 16, v255
  v_and_b32 v47, s44, v255
  v_pk_fma_f32 v[42:43], v[42:43], v[24:25], v[48:49] op_sel_hi:[1,0,0]
  v_cvt_pk_bf16_f32 v251, v38, v39
  v_pk_fma_f32 v[44:45], v[44:45], v[24:25], v[48:49] op_sel_hi:[1,0,0]
  v_cvt_pk_bf16_f32 v252, v40, v41
  v_pk_fma_f32 v[46:47], v[46:47], v[24:25], v[48:49] op_sel_hi:[1,0,0]
  v_cvt_pk_bf16_f32 v253, v42, v43
  v_cvt_pk_bf16_f32 v254, v44, v45
  v_cvt_pk_bf16_f32 v255, v46, v47
  s_waitcnt lgkmcnt(8)
  v_mfma_f32_32x32x16_bf16 v[64:79], v[128:131], a[0:3], 0
  ds_read_b64_tr_b16 a[24:25], v17 offset:6144
  ds_read_b64_tr_b16 a[26:27], v17 offset:6656
  s_add_u32 s4, s51, 0
  v_mfma_f32_32x32x16_bf16 v[80:95], v[128:131], a[4:7], 0
  ds_read_b64_tr_b16 a[28:29], v18 offset:6144
  ds_read_b64_tr_b16 a[30:31], v18 offset:6656
  s_add_u32 m0, s46, 131072
  s_nop 0
  buffer_load_dwordx4 v6, s[28:31], s4 offen lds
  s_waitcnt lgkmcnt(8)
  v_mfma_f32_32x32x16_bf16 v[96:111], v[128:131], a[8:11], 0
  ds_read_b64_tr_b16 a[0:1], v17 offset:8192
  ds_read_b64_tr_b16 a[2:3], v17 offset:8704
  buffer_load_dwordx4 v7, s[28:31], s4 offen offset:1024 lds
  v_mfma_f32_32x32x16_bf16 v[112:127], v[128:131], a[12:15], 0
  ds_read_b64_tr_b16 a[4:5], v18 offset:8192
  ds_read_b64_tr_b16 a[6:7], v18 offset:8704
  buffer_load_dwordx4 v8, s[28:31], s4 offen offset:2048 lds
  s_waitcnt lgkmcnt(8)
  v_mfma_f32_32x32x16_bf16 v[64:79], v[132:135], a[16:19], v[64:79]
  ds_read_b64_tr_b16 a[8:9], v17 offset:10240
  ds_read_b64_tr_b16 a[10:11], v17 offset:10752
  buffer_load_dwordx4 v9, s[28:31], s4 offen offset:3072 lds
  v_mfma_f32_32x32x16_bf16 v[80:95], v[132:135], a[20:23], v[80:95]
  ds_read_b64_tr_b16 a[12:13], v18 offset:10240
  ds_read_b64_tr_b16 a[14:15], v18 offset:10752
  s_add_u32 s4, s51, 32768
  s_waitcnt lgkmcnt(8)
  v_mfma_f32_32x32x16_bf16 v[96:111], v[132:135], a[24:27], v[96:111]
  ds_read_b64_tr_b16 a[16:17], v17 offset:12288
  ds_read_b64_tr_b16 a[18:19], v17 offset:12800
  s_add_u32 m0, s46, 147456
  s_nop 0
  buffer_load_dwordx4 v6, s[28:31], s4 offen lds
  v_mfma_f32_32x32x16_bf16 v[112:127], v[132:135], a[28:31], v[112:127]
  ds_read_b64_tr_b16 a[20:21], v18 offset:12288
  ds_read_b64_tr_b16 a[22:23], v18 offset:12800
  buffer_load_dwordx4 v7, s[28:31], s4 offen offset:1024 lds
  s_waitcnt lgkmcnt(8)
  v_mfma_f32_32x32x16_bf16 v[64:79], v[136:139], a[0:3], v[64:79]
  ds_read_b64_tr_b16 a[24:25], v17 offset:14336
  ds_read_b64_tr_b16 a[26:27], v17 offset:14848
  buffer_load_dwordx4 v8, s[28:31], s4 offen offset:2048 lds
  v_mfma_f32_32x32x16_bf16 v[80:95], v[136:139], a[4:7], v[80:95]
  ds_read_b64_tr_b16 a[28:29], v18 offset:14336
  ds_read_b64_tr_b16 a[30:31], v18 offset:14848
  buffer_load_dwordx4 v9, s[28:31], s4 offen offset:3072 lds
  s_waitcnt lgkmcnt(8)
  v_mfma_f32_32x32x16_bf16 v[96:111], v[136:139], a[8:11], v[96:111]
  s_barrier
  v_add_u32 v17, 16384, v14
  v_xor_b32 v18, 64, v17
  ds_read_b64_tr_b16 a[0:1], v17 offset:0
  ds_read_b64_tr_b16 a[2:3], v17 offset:512
  s_and_b32 s6, s2, 3
  s_lshl_b32 s6, s6, 6
  s_mov_b64 exec, 1
  v_mov_b32 v61, 1
  buffer_atomic_add v61, v25, s[40:43], s6 offen
  s_mov_b64 exec, -1
  s_nop 3
  v_mfma_f32_32x32x16_bf16 v[112:127], v[136:139], a[12:15], v[112:127]
  ds_read_b64_tr_b16 a[4:5], v18 offset:0
  ds_read_b64_tr_b16 a[6:7], v18 offset:512
  s_waitcnt lgkmcnt(8)
  v_mfma_f32_32x32x16_bf16 v[64:79], v[140:143], a[16:19], v[64:79]
  ds_read_b64_tr_b16 a[8:9], v17 offset:2048
  ds_read_b64_tr_b16 a[10:11], v17 offset:2560
  v_mfma_f32_32x32x16_bf16 v[80:95], v[140:143], a[20:23], v[80:95]
  ds_read_b64_tr_b16 a[12:13], v18 offset:2048
  ds_read_b64_tr_b16 a[14:15], v18 offset:2560
  s_waitcnt lgkmcnt(8)
  v_mfma_f32_32x32x16_bf16 v[96:111], v[140:143], a[24:27], v[96:111]
  ds_read_b64_tr_b16 a[16:17], v17 offset:4096
  ds_read_b64_tr_b16 a[18:19], v17 offset:4608
  v_mfma_f32_32x32x16_bf16 v[112:127], v[140:143], a[28:31], v[112:127]
  ds_read_b64_tr_b16 a[20:21], v18 offset:4096
  ds_read_b64_tr_b16 a[22:23], v18 offset:4608
  s_waitcnt lgkmcnt(8)
  v_mfma_f32_32x32x16_bf16 v[64:79], v[144:147], a[0:3], v[64:79]
  ds_read_b64_tr_b16 a[24:25], v17 offset:6144
  ds_read_b64_tr_b16 a[26:27], v17 offset:6656
  v_mfma_f32_32x32x16_bf16 v[80:95], v[144:147], a[4:7], v[80:95]
  ds_read_b64_tr_b16 a[28:29], v18 offset:6144
  ds_read_b64_tr_b16 a[30:31], v18 offset:6656
  s_waitcnt lgkmcnt(8)
  v_mfma_f32_32x32x16_bf16 v[96:111], v[144:147], a[8:11], v[96:111]
  ds_read_b64_tr_b16 a[0:1], v17 offset:8192
  ds_read_b64_tr_b16 a[2:3], v17 offset:8704
  v_mfma_f32_32x32x16_bf16 v[112:127], v[144:147], a[12:15], v[112:127]
  ds_read_b64_tr_b16 a[4:5], v18 offset:8192
  ds_read_b64_tr_b16 a[6:7], v18 offset:8704
  s_waitcnt lgkmcnt(8)
  v_mfma_f32_32x32x16_bf16 v[64:79], v[148:151], a[16:19], v[64:79]
  ds_read_b64_tr_b16 a[8:9], v17 offset:10240
  ds_read_b64_tr_b16 a[10:11], v17 offset:10752
  v_mfma_f32_32x32x16_bf16 v[80:95], v[148:151], a[20:23], v[80:95]
  ds_read_b64_tr_b16 a[12:13], v18 offset:10240
  ds_read_b64_tr_b16 a[14:15], v18 offset:10752
  s_waitcnt lgkmcnt(8)
  v_mfma_f32_32x32x16_bf16 v[96:111], v[148:151], a[24:27], v[96:111]
  ds_read_b64_tr_b16 a[16:17], v17 offset:12288
  ds_read_b64_tr_b16 a[18:19], v17 offset:12800
  v_mfma_f32_32x32x16_bf16 v[112:127], v[148:151], a[28:31], v[112:127]
  ds_read_b64_tr_b16 a[20:21], v18 offset:12288
  ds_read_b64_tr_b16 a[22:23], v18 offset:12800
  s_waitcnt lgkmcnt(8)
  v_mfma_f32_32x32x16_bf16 v[64:79], v[152:155], a[0:3], v[64:79]
  ds_read_b64_tr_b16 a[24:25], v17 offset:14336
  ds_read_b64_tr_b16 a[26:27], v17 offset:14848
  v_mfma_f32_32x32x16_bf16 v[80:95], v[152:155], a[4:7], v[80:95]
  ds_read_b64_tr_b16 a[28:29], v18 offset:14336
  ds_read_b64_tr_b16 a[30:31], v18 offset:14848
  s_waitcnt lgkmcnt(8)
  v_mfma_f32_32x32x16_bf16 v[96:111], v[152:155], a[8:11], v[96:111]
  s_waitcnt vmcnt(29)
  s_barrier
  v_add_u32 v17, 32768, v14
  v_xor_b32 v18, 64, v17
  ds_read_b64_tr_b16 a[0:1], v17 offset:0
  ds_read_b64_tr_b16 a[2:3], v17 offset:512
  v_add_u32 v2, 4096, v10
  v_add_u32 v3, 31744, v10
  v_xor_b32 v5, 64, v10
  v_add_u32 v4, 2048, v5
  v_add_u32 v5, 29696, v5
  s_add_u32 s3, s65, 0
  s_and_b32 s3, s3, 7
  s_mul_i32 s3, s3, 229376
  s_add_u32 s3, s3, s49
  v_mfma_f32_32x32x16_bf16 v[112:127], v[152:155], a[12:15], v[112:127]
  ds_read_b64_tr_b16 a[4:5], v18 offset:0
  ds_read_b64_tr_b16 a[6:7], v18 offset:512
  s_add_u32 m0, s46, 0
  s_nop 0
  buffer_load_dwordx4 v2, s[20:23], s3 offen lds
  s_waitcnt lgkmcnt(8)
  v_mfma_f32_32x32x16_bf16 v[64:79], v[156:159], a[16:19], v[64:79]
  ds_read_b64_tr_b16 a[8:9], v17 offset:2048
  ds_read_b64_tr_b16 a[10:11], v17 offset:2560
  buffer_load_dwordx4 v3, s[20:23], s3 offen offset:1024 lds
  v_mfma_f32_32x32x16_bf16 v[80:95], v[156:159], a[20:23], v[80:95]
  ds_read_b64_tr_b16 a[12:13], v18 offset:2048
  ds_read_b64_tr_b16 a[14:15], v18 offset:2560
  buffer_load_dwordx4 v4, s[24:27], s3 offen offset:2048 lds
  s_waitcnt lgkmcnt(8)
  v_mfma_f32_32x32x16_bf16 v[96:111], v[156:159], a[24:27], v[96:111]
  ds_read_b64_tr_b16 a[16:17], v17 offset:4096
  ds_read_b64_tr_b16 a[18:19], v17 offset:4608
  buffer_load_dwordx4 v5, s[24:27], s3 offen offset:3072 lds
  s_lshl_b32 s5, s2, 2
  s_add_u32 s5, s5, s45
  v_lshlrev_b32 v60, 7, v30
  s_mov_b32 s7, 0x7ffffff0
  s_mov_b32 s92, s12
  s_mov_b32 s93, s13
  s_mov_b32 s94, s14
  s_mov_b32 s95, s15
  s_sub_u32 s6, s5, 0
  s_lshl_b32 s44, s6, 13
  s_add_u32 s44, s44, 4096
  s_cmp_lt_u32 s6, 192
  s_cselect_b32 s7, s44, s7
  s_cselect_b32 s92, s12, s92
  s_cselect_b32 s93, s13, s93
  s_cselect_b32 s94, s14, s94
  s_sub_u32 s6, s5, 192
  s_lshl_b32 s44, s6, 13
  s_add_u32 s44, s44, 4096
  s_cmp_lt_u32 s6, 224
  s_cselect_b32 s7, s44, s7
  s_cselect_b32 s92, s20, s92
  s_cselect_b32 s93, s21, s93
  s_cselect_b32 s94, s22, s94
  s_sub_u32 s6, s5, 416
  s_lshl_b32 s44, s6, 13
  s_add_u32 s44, s44, 4096
  s_cmp_lt_u32 s6, 224
  s_cselect_b32 s7, s44, s7
  s_cselect_b32 s92, s24, s92
  s_cselect_b32 s93, s25, s93
  s_cselect_b32 s94, s26, s94
  s_sub_u32 s6, s5, 640
  s_lshl_b32 s44, s6, 13
  s_add_u32 s44, s44, 4096
  s_cmp_lt_u32 s6, 224
  s_cselect_b32 s7, s44, s7
  s_cselect_b32 s92, s28, s92
  s_cselect_b32 s93, s29, s93
  s_cselect_b32 s94, s30, s94
  s_sub_u32 s6, s5, 864
  s_lshl_b32 s44, s6, 13
  s_add_u32 s44, s44, 4096
  s_cmp_lt_u32 s6, 64
  s_cselect_b32 s7, s44, s7
  s_cselect_b32 s92, s16, s92
  s_cselect_b32 s93, s17, s93
  s_cselect_b32 s94, s18, s94
  s_mov_b32 s95, 0x20000
  v_add_u32 v60, s7, v60
  buffer_load_dword v55, v60, s[92:95], 0 offen
  v_mfma_f32_32x32x16_bf16 v[112:127], v[156:159], a[28:31], v[112:127]
  ds_read_b64_tr_b16 a[20:21], v18 offset:4096
  ds_read_b64_tr_b16 a[22:23], v18 offset:4608
  s_waitcnt lgkmcnt(8)
  v_mfma_f32_32x32x16_bf16 v[64:79], v[160:163], a[0:3], v[64:79]
  ds_read_b64_tr_b16 a[24:25], v17 offset:6144
  ds_read_b64_tr_b16 a[26:27], v17 offset:6656
  v_mfma_f32_32x32x16_bf16 v[80:95], v[160:163], a[4:7], v[80:95]
  ds_read_b64_tr_b16 a[28:29], v18 offset:6144
  ds_read_b64_tr_b16 a[30:31], v18 offset:6656
  s_waitcnt lgkmcnt(8)
  v_mfma_f32_32x32x16_bf16 v[96:111], v[160:163], a[8:11], v[96:111]
  ds_read_b64_tr_b16 a[0:1], v17 offset:8192
  ds_read_b64_tr_b16 a[2:3], v17 offset:8704
  v_mfma_f32_32x32x16_bf16 v[112:127], v[160:163], a[12:15], v[112:127]
  ds_read_b64_tr_b16 a[4:5], v18 offset:8192
  ds_read_b64_tr_b16 a[6:7], v18 offset:8704
  s_waitcnt lgkmcnt(8)
  v_mfma_f32_32x32x16_bf16 v[64:79], v[164:167], a[16:19], v[64:79]
  ds_read_b64_tr_b16 a[8:9], v17 offset:10240
  ds_read_b64_tr_b16 a[10:11], v17 offset:10752
  v_mfma_f32_32x32x16_bf16 v[80:95], v[164:167], a[20:23], v[80:95]
  ds_read_b64_tr_b16 a[12:13], v18 offset:10240
  ds_read_b64_tr_b16 a[14:15], v18 offset:10752
  s_waitcnt lgkmcnt(8)
  v_mfma_f32_32x32x16_bf16 v[96:111], v[164:167], a[24:27], v[96:111]
  ds_read_b64_tr_b16 a[16:17], v17 offset:12288
  ds_read_b64_tr_b16 a[18:19], v17 offset:12800
  v_mfma_f32_32x32x16_bf16 v[112:127], v[164:167], a[28:31], v[112:127]
  ds_read_b64_tr_b16 a[20:21], v18 offset:12288
  ds_read_b64_tr_b16 a[22:23], v18 offset:12800
  s_waitcnt lgkmcnt(8)
  v_mfma_f32_32x32x16_bf16 v[64:79], v[168:171], a[0:3], v[64:79]
  ds_read_b64_tr_b16 a[24:25], v17 offset:14336
  ds_read_b64_tr_b16 a[26:27], v17 offset:14848
  v_mfma_f32_32x32x16_bf16 v[80:95], v[168:171], a[4:7], v[80:95]
  ds_read_b64_tr_b16 a[28:29], v18 offset:14336
  ds_read_b64_tr_b16 a[30:31], v18 offset:14848
  s_waitcnt lgkmcnt(8)
  v_mfma_f32_32x32x16_bf16 v[96:111], v[168:171], a[8:11], v[96:111]
  s_waitcnt vmcnt(30)
  s_barrier
  v_add_u32 v17, 49152, v14
  v_xor_b32 v18, 64, v17
  ds_read_b64_tr_b16 a[0:1], v17 offset:0
  ds_read_b64_tr_b16 a[2:3], v17 offset:512
  s_add_u32 s3, s65, 1
  s_and_b32 s3, s3, 7
  s_mul_i32 s3, s3, 229376
  s_add_u32 s3, s3, s49
  v_mfma_f32_32x32x16_bf16 v[112:127], v[168:171], a[12:15], v[112:127]
  ds_read_b64_tr_b16 a[4:5], v18 offset:0
  ds_read_b64_tr_b16 a[6:7], v18 offset:512
  s_add_u32 m0, s46, 16384
  s_nop 0
  buffer_load_dwordx4 v2, s[20:23], s3 offen lds
  s_waitcnt lgkmcnt(8)
  v_mfma_f32_32x32x16_bf16 v[64:79], v[172:175], a[16:19], v[64:79]
  ds_read_b64_tr_b16 a[8:9], v17 offset:2048
  ds_read_b64_tr_b16 a[10:11], v17 offset:2560
  buffer_load_dwordx4 v3, s[20:23], s3 offen offset:1024 lds
  v_mfma_f32_32x32x16_bf16 v[80:95], v[172:175], a[20:23], v[80:95]
  ds_read_b64_tr_b16 a[12:13], v18 offset:2048
  ds_read_b64_tr_b16 a[14:15], v18 offset:2560
  buffer_load_dwordx4 v4, s[24:27], s3 offen offset:2048 lds
  s_waitcnt lgkmcnt(8)
  v_mfma_f32_32x32x16_bf16 v[96:111], v[172:175], a[24:27], v[96:111]
  ds_read_b64_tr_b16 a[16:17], v17 offset:4096
  ds_read_b64_tr_b16 a[18:19], v17 offset:4608
  buffer_load_dwordx4 v5, s[24:27], s3 offen offset:3072 lds
  v_mfma_f32_32x32x16_bf16 v[112:127], v[172:175], a[28:31], v[112:127]
  ds_read_b64_tr_b16 a[20:21], v18 offset:4096
  ds_read_b64_tr_b16 a[22:23], v18 offset:4608
  s_waitcnt lgkmcnt(8)
  v_mfma_f32_32x32x16_bf16 v[64:79], v[176:179], a[0:3], v[64:79]
  ds_read_b64_tr_b16 a[24:25], v17 offset:6144
  ds_read_b64_tr_b16 a[26:27], v17 offset:6656
  s_waitcnt vmcnt(14)
  v_add_u32 v21, 131072, v16
  v_xor_b32 v22, 64, v21
  ds_read_b64_tr_b16 a[32:33], v21 offset:0
  ds_read_b64_tr_b16 a[34:35], v21 offset:1024
  v_mfma_f32_32x32x16_bf16 v[80:95], v[176:179], a[4:7], v[80:95]
  ds_read_b64_tr_b16 a[28:29], v18 offset:6144
  ds_read_b64_tr_b16 a[30:31], v18 offset:6656
  ds_read_b64_tr_b16 a[36:37], v22 offset:0
  ds_read_b64_tr_b16 a[38:39], v22 offset:1024
  s_waitcnt lgkmcnt(12)
  v_mfma_f32_32x32x16_bf16 v[96:111], v[176:179], a[8:11], v[96:111]
  ds_read_b64_tr_b16 a[0:1], v17 offset:8192
  ds_read_b64_tr_b16 a[2:3], v17 offset:8704
  ds_read_b64_tr_b16 a[40:41], v21 offset:2048
  ds_read_b64_tr_b16 a[42:43], v21 offset:3072
  v_mfma_f32_32x32x16_bf16 v[112:127], v[176:179], a[12:15], v[112:127]
  ds_read_b64_tr_b16 a[4:5], v18 offset:8192
  ds_read_b64_tr_b16 a[6:7], v18 offset:8704
  ds_read_b64_tr_b16 a[44:45], v22 offset:2048
  ds_read_b64_tr_b16 a[46:47], v22 offset:3072
  s_waitcnt lgkmcnt(15)
  v_mfma_f32_32x32x16_bf16 v[64:79], v[180:183], a[16:19], v[64:79]
  ds_read_b64_tr_b16 a[8:9], v17 offset:10240
  ds_read_b64_tr_b16 a[10:11], v17 offset:10752
  v_mfma_f32_32x32x16_bf16 v[80:95], v[180:183], a[20:23], v[80:95]
  ds_read_b64_tr_b16 a[12:13], v18 offset:10240
  ds_read_b64_tr_b16 a[14:15], v18 offset:10752
  s_waitcnt lgkmcnt(4)
  s_add_u32 s4, s51, 327680
  v_mfma_f32_32x32x16_bf16 v[96:111], v[180:183], a[24:27], v[96:111]
  ds_read_b64_tr_b16 a[16:17], v17 offset:12288
  ds_read_b64_tr_b16 a[18:19], v17 offset:12800
  s_add_u32 m0, s46, 131072
  s_nop 0
  buffer_load_dwordx4 v6, s[28:31], s4 offen lds
  v_mfma_f32_32x32x16_bf16 v[112:127], v[180:183], a[28:31], v[112:127]
  ds_read_b64_tr_b16 a[20:21], v18 offset:12288
  ds_read_b64_tr_b16 a[22:23], v18 offset:12800
  buffer_load_dwordx4 v7, s[28:31], s4 offen offset:1024 lds
  v_mfma_f32_32x32x16_bf16 v[64:79], v[184:187], a[0:3], v[64:79]
  ds_read_b64_tr_b16 a[24:25], v17 offset:14336
  ds_read_b64_tr_b16 a[26:27], v17 offset:14848
  buffer_load_dwordx4 v8, s[28:31], s4 offen offset:2048 lds
  v_mfma_f32_32x32x16_bf16 v[80:95], v[184:187], a[4:7], v[80:95]
  ds_read_b64_tr_b16 a[28:29], v18 offset:14336
  ds_read_b64_tr_b16 a[30:31], v18 offset:14848
  buffer_load_dwordx4 v9, s[28:31], s4 offen offset:3072 lds
  v_lshlrev_b32 v60, 6, v30
  v_add_u32 v60, v60, v25
  s_mov_b64 exec, 0xf
  buffer_load_dword v31, v60, s[40:43], 0 offen sc1
  s_mov_b64 exec, -1
  s_waitcnt lgkmcnt(8)
  s_nop 2
  v_mfma_f32_32x32x16_bf16 v[96:111], v[184:187], a[8:11], v[96:111]
  s_barrier
  v_add_u32 v17, 65536, v14
  v_xor_b32 v18, 64, v17
  ds_read_b64_tr_b16 a[0:1], v17 offset:0
  ds_read_b64_tr_b16 a[2:3], v17 offset:512
  s_add_u32 s3, s65, 2
  s_and_b32 s3, s3, 7
  s_mul_i32 s3, s3, 229376
  s_add_u32 s3, s3, s49
  v_mfma_f32_32x32x16_bf16 v[112:127], v[184:187], a[12:15], v[112:127]
  ds_read_b64_tr_b16 a[4:5], v18 offset:0
  ds_read_b64_tr_b16 a[6:7], v18 offset:512
  s_add_u32 m0, s46, 32768
  s_nop 0
  buffer_load_dwordx4 v2, s[20:23], s3 offen lds
  s_waitcnt lgkmcnt(8)
  v_mfma_f32_32x32x16_bf16 v[64:79], v[188:191], a[16:19], v[64:79]
  ds_read_b64_tr_b16 a[8:9], v17 offset:2048
  ds_read_b64_tr_b16 a[10:11], v17 offset:2560
  buffer_load_dwordx4 v3, s[20:23], s3 offen offset:1024 lds
  v_mfma_f32_32x32x16_bf16 v[80:95], v[188:191], a[20:23], v[80:95]
  ds_read_b64_tr_b16 a[12:13], v18 offset:2048
  ds_read_b64_tr_b16 a[14:15], v18 offset:2560
  buffer_load_dwordx4 v4, s[24:27], s3 offen offset:2048 lds
  s_waitcnt lgkmcnt(8)
  v_mfma_f32_32x32x16_bf16 v[96:111], v[188:191], a[24:27], v[96:111]
  ds_read_b64_tr_b16 a[16:17], v17 offset:4096
  ds_read_b64_tr_b16 a[18:19], v17 offset:4608
  buffer_load_dwordx4 v5, s[24:27], s3 offen offset:3072 lds
  v_mfma_f32_32x32x16_bf16 v[112:127], v[188:191], a[28:31], v[112:127]
  ds_read_b64_tr_b16 a[20:21], v18 offset:4096
  ds_read_b64_tr_b16 a[22:23], v18 offset:4608
  s_waitcnt lgkmcnt(8)
  v_mfma_f32_32x32x16_bf16 v[64:79], v[192:195], a[0:3], v[64:79]
  ds_read_b64_tr_b16 a[24:25], v17 offset:6144
  ds_read_b64_tr_b16 a[26:27], v17 offset:6656
  s_waitcnt vmcnt(19)
  v_add_u32 v21, 147456, v16
  v_xor_b32 v22, 64, v21
  ds_read_b64_tr_b16 a[48:49], v21 offset:0
  ds_read_b64_tr_b16 a[50:51], v21 offset:1024
  v_mfma_f32_32x32x16_bf16 v[80:95], v[192:195], a[4:7], v[80:95]
  ds_read_b64_tr_b16 a[28:29], v18 offset:6144
  ds_read_b64_tr_b16 a[30:31], v18 offset:6656
  ds_read_b64_tr_b16 a[52:53], v22 offset:0
  ds_read_b64_tr_b16 a[54:55], v22 offset:1024
  s_waitcnt lgkmcnt(12)
  v_mfma_f32_32x32x16_bf16 v[96:111], v[192:195], a[8:11], v[96:111]
  ds_read_b64_tr_b16 a[0:1], v17 offset:8192
  ds_read_b64_tr_b16 a[2:3], v17 offset:8704
  ds_read_b64_tr_b16 a[56:57], v21 offset:2048
  ds_read_b64_tr_b16 a[58:59], v21 offset:3072
  v_mfma_f32_32x32x16_bf16 v[112:127], v[192:195], a[12:15], v[112:127]
  ds_read_b64_tr_b16 a[4:5], v18 offset:8192
  ds_read_b64_tr_b16 a[6:7], v18 offset:8704
  ds_read_b64_tr_b16 a[60:61], v22 offset:2048
  ds_read_b64_tr_b16 a[62:63], v22 offset:3072
  s_waitcnt lgkmcnt(15)
  v_mfma_f32_32x32x16_bf16 v[64:79], v[196:199], a[16:19], v[64:79]
  ds_read_b64_tr_b16 a[8:9], v17 offset:10240
  ds_read_b64_tr_b16 a[10:11], v17 offset:10752
  v_mfma_f32_32x32x16_bf16 v[80:95], v[196:199], a[20:23], v[80:95]
  ds_read_b64_tr_b16 a[12:13], v18 offset:10240
  ds_read_b64_tr_b16 a[14:15], v18 offset:10752
  s_waitcnt lgkmcnt(4)
  s_add_u32 s4, s51, 360448
  v_mfma_f32_32x32x16_bf16 v[96:111], v[196:199], a[24:27], v[96:111]
  ds_read_b64_tr_b16 a[16:17], v17 offset:12288
  ds_read_b64_tr_b16 a[18:19], v17 offset:12800
  s_add_u32 m0, s46, 147456
  s_nop 0
  buffer_load_dwordx4 v6, s[28:31], s4 offen lds
  v_mfma_f32_32x32x16_bf16 v[112:127], v[196:199], a[28:31], v[112:127]
  ds_read_b64_tr_b16 a[20:21], v18 offset:12288
  ds_read_b64_tr_b16 a[22:23], v18 offset:12800
  buffer_load_dwordx4 v7, s[28:31], s4 offen offset:1024 lds
  v_mfma_f32_32x32x16_bf16 v[64:79], v[200:203], a[0:3], v[64:79]
  ds_read_b64_tr_b16 a[24:25], v17 offset:14336
  ds_read_b64_tr_b16 a[26:27], v17 offset:14848
  buffer_load_dwordx4 v8, s[28:31], s4 offen offset:2048 lds
  v_mfma_f32_32x32x16_bf16 v[80:95], v[200:203], a[4:7], v[80:95]
  ds_read_b64_tr_b16 a[28:29], v18 offset:14336
  ds_read_b64_tr_b16 a[30:31], v18 offset:14848
  buffer_load_dwordx4 v9, s[28:31], s4 offen offset:3072 lds
  s_waitcnt lgkmcnt(8)
  v_mfma_f32_32x32x16_bf16 v[96:111], v[200:203], a[8:11], v[96:111]
  s_barrier
  v_add_u32 v17, 81920, v14
  v_xor_b32 v18, 64, v17
  ds_read_b64_tr_b16 a[0:1], v17 offset:0
  ds_read_b64_tr_b16 a[2:3], v17 offset:512
  s_add_u32 s3, s65, 3
  s_and_b32 s3, s3, 7
  s_mul_i32 s3, s3, 229376
  s_add_u32 s3, s3, s49
  v_mfma_f32_32x32x16_bf16 v[112:127], v[200:203], a[12:15], v[112:127]
  ds_read_b64_tr_b16 a[4:5], v18 offset:0
  ds_read_b64_tr_b16 a[6:7], v18 offset:512
  s_add_u32 m0, s46, 49152
  s_nop 0
  buffer_load_dwordx4 v2, s[20:23], s3 offen lds
  s_waitcnt lgkmcnt(8)
  v_mfma_f32_32x32x16_bf16 v[64:79], v[204:207], a[16:19], v[64:79]
  ds_read_b64_tr_b16 a[8:9], v17 offset:2048
  ds_read_b64_tr_b16 a[10:11], v17 offset:2560
  buffer_load_dwordx4 v3, s[20:23], s3 offen offset:1024 lds
  v_mfma_f32_32x32x16_bf16 v[80:95], v[204:207], a[20:23], v[80:95]
  ds_read_b64_tr_b16 a[12:13], v18 offset:2048
  ds_read_b64_tr_b16 a[14:15], v18 offset:2560
  buffer_load_dwordx4 v4, s[24:27], s3 offen offset:2048 lds
  s_waitcnt lgkmcnt(8)
  v_mfma_f32_32x32x16_bf16 v[96:111], v[204:207], a[24:27], v[96:111]
  ds_read_b64_tr_b16 a[16:17], v17 offset:4096
  ds_read_b64_tr_b16 a[18:19], v17 offset:4608
  buffer_load_dwordx4 v5, s[24:27], s3 offen offset:3072 lds
  v_mfma_f32_32x32x16_bf16 v[112:127], v[204:207], a[28:31], v[112:127]
  ds_read_b64_tr_b16 a[20:21], v18 offset:4096
  ds_read_b64_tr_b16 a[22:23], v18 offset:4608
  s_waitcnt lgkmcnt(8)
  v_mfma_f32_32x32x16_bf16 v[64:79], v[208:211], a[0:3], v[64:79]
  ds_read_b64_tr_b16 a[24:25], v17 offset:6144
  ds_read_b64_tr_b16 a[26:27], v17 offset:6656
  s_waitcnt vmcnt(13)
  v_add_u32 v21, 131072, v16
  v_xor_b32 v22, 64, v21
  ds_read_b64_tr_b16 a[64:65], v21 offset:0
  ds_read_b64_tr_b16 a[66:67], v21 offset:1024
  v_mfma_f32_32x32x16_bf16 v[80:95], v[208:211], a[4:7], v[80:95]
  ds_read_b64_tr_b16 a[28:29], v18 offset:6144
  ds_read_b64_tr_b16 a[30:31], v18 offset:6656
  ds_read_b64_tr_b16 a[68:69], v22 offset:0
  ds_read_b64_tr_b16 a[70:71], v22 offset:1024
  s_waitcnt lgkmcnt(12)
  v_mfma_f32_32x32x16_bf16 v[96:111], v[208:211], a[8:11], v[96:111]
  ds_read_b64_tr_b16 a[0:1], v17 offset:8192
  ds_read_b64_tr_b16 a[2:3], v17 offset:8704
  ds_read_b64_tr_b16 a[72:73], v21 offset:2048
  ds_read_b64_tr_b16 a[74:75], v21 offset:3072
  v_mfma_f32_32x32x16_bf16 v[112:127], v[208:211], a[12:15], v[112:127]
  ds_read_b64_tr_b16 a[4:5], v18 offset:8192
  ds_read_b64_tr_b16 a[6:7], v18 offset:8704
  ds_read_b64_tr_b16 a[76:77], v22 offset:2048
  ds_read_b64_tr_b16 a[78:79], v22 offset:3072
  s_waitcnt lgkmcnt(15)
  v_mfma_f32_32x32x16_bf16 v[64:79], v[212:215], a[16:19], v[64:79]
  ds_read_b64_tr_b16 a[8:9], v17 offset:10240
  ds_read_b64_tr_b16 a[10:11], v17 offset:10752
  v_mfma_f32_32x32x16_bf16 v[80:95], v[212:215], a[20:23], v[80:95]
  ds_read_b64_tr_b16 a[12:13], v18 offset:10240
  ds_read_b64_tr_b16 a[14:15], v18 offset:10752
  s_waitcnt lgkmcnt(4)
  s_add_u32 s4, s51, 65536
  v_mfma_f32_32x32x16_bf16 v[96:111], v[212:215], a[24:27], v[96:111]
  ds_read_b64_tr_b16 a[16:17], v17 offset:12288
  ds_read_b64_tr_b16 a[18:19], v17 offset:12800
  s_add_u32 m0, s46, 131072
  s_nop 0
  buffer_load_dwordx4 v6, s[28:31], s4 offen lds
  v_mfma_f32_32x32x16_bf16 v[112:127], v[212:215], a[28:31], v[112:127]
  ds_read_b64_tr_b16 a[20:21], v18 offset:12288
  ds_read_b64_tr_b16 a[22:23], v18 offset:12800
  buffer_load_dwordx4 v7, s[28:31], s4 offen offset:1024 lds
  v_mfma_f32_32x32x16_bf16 v[64:79], v[216:219], a[0:3], v[64:79]
  ds_read_b64_tr_b16 a[24:25], v17 offset:14336
  ds_read_b64_tr_b16 a[26:27], v17 offset:14848
  buffer_load_dwordx4 v8, s[28:31], s4 offen offset:2048 lds
  v_mfma_f32_32x32x16_bf16 v[80:95], v[216:219], a[4:7], v[80:95]
  ds_read_b64_tr_b16 a[28:29], v18 offset:14336
  ds_read_b64_tr_b16 a[30:31], v18 offset:14848
  buffer_load_dwordx4 v9, s[28:31], s4 offen offset:3072 lds
  s_waitcnt lgkmcnt(8)
  v_mfma_f32_32x32x16_bf16 v[96:111], v[216:219], a[8:11], v[96:111]
  s_barrier
  v_add_u32 v17, 98304, v14
  v_xor_b32 v18, 64, v17
  ds_read_b64_tr_b16 a[0:1], v17 offset:0
  ds_read_b64_tr_b16 a[2:3], v17 offset:512
  s_add_u32 s3, s65, 4
  s_and_b32 s3, s3, 7
  s_mul_i32 s3, s3, 229376
  s_add_u32 s3, s3, s49
  v_mfma_f32_32x32x16_bf16 v[112:127], v[216:219], a[12:15], v[112:127]
  ds_read_b64_tr_b16 a[4:5], v18 offset:0
  ds_read_b64_tr_b16 a[6:7], v18 offset:512
  s_add_u32 m0, s46, 65536
  s_nop 0
  buffer_load_dwordx4 v2, s[20:23], s3 offen lds
  s_waitcnt lgkmcnt(8)
  v_mfma_f32_32x32x16_bf16 v[64:79], v[220:223], a[16:19], v[64:79]
  ds_read_b64_tr_b16 a[8:9], v17 offset:2048
  ds_read_b64_tr_b16 a[10:11], v17 offset:2560
  buffer_load_dwordx4 v3, s[20:23], s3 offen offset:1024 lds
  v_mfma_f32_32x32x16_bf16 v[80:95], v[220:223], a[20:23], v[80:95]
  ds_read_b64_tr_b16 a[12:13], v18 offset:2048
  ds_read_b64_tr_b16 a[14:15], v18 offset:2560
  buffer_load_dwordx4 v4, s[24:27], s3 offen offset:2048 lds
  s_waitcnt lgkmcnt(8)
  v_mfma_f32_32x32x16_bf16 v[96:111], v[220:223], a[24:27], v[96:111]
  ds_read_b64_tr_b16 a[16:17], v17 offset:4096
  ds_read_b64_tr_b16 a[18:19], v17 offset:4608
  buffer_load_dwordx4 v5, s[24:27], s3 offen offset:3072 lds
  v_mfma_f32_32x32x16_bf16 v[112:127], v[220:223], a[28:31], v[112:127]
  ds_read_b64_tr_b16 a[20:21], v18 offset:4096
  ds_read_b64_tr_b16 a[22:23], v18 offset:4608
  s_waitcnt lgkmcnt(8)
  v_mfma_f32_32x32x16_bf16 v[64:79], v[224:227], a[0:3], v[64:79]
  ds_read_b64_tr_b16 a[24:25], v17 offset:6144
  ds_read_b64_tr_b16 a[26:27], v17 offset:6656
  s_waitcnt vmcnt(12)
  v_add_u32 v21, 147456, v16
  v_xor_b32 v22, 64, v21
  ds_read_b64_tr_b16 a[80:81], v21 offset:0
  ds_read_b64_tr_b16 a[82:83], v21 offset:1024
  v_mfma_f32_32x32x16_bf16 v[80:95], v[224:227], a[4:7], v[80:95]
  ds_read_b64_tr_b16 a[28:29], v18 offset:6144
  ds_read_b64_tr_b16 a[30:31], v18 offset:6656
  ds_read_b64_tr_b16 a[84:85], v22 offset:0
  ds_read_b64_tr_b16 a[86:87], v22 offset:1024
  s_waitcnt lgkmcnt(12)
  v_mfma_f32_32x32x16_bf16 v[96:111], v[224:227], a[8:11], v[96:111]
  ds_read_b64_tr_b16 a[0:1], v17 offset:8192
  ds_read_b64_tr_b16 a[2:3], v17 offset:8704
  ds_read_b64_tr_b16 a[88:89], v21 offset:2048
  ds_read_b64_tr_b16 a[90:91], v21 offset:3072
  v_mfma_f32_32x32x16_bf16 v[112:127], v[224:227], a[12:15], v[112:127]
  ds_read_b64_tr_b16 a[4:5], v18 offset:8192
  ds_read_b64_tr_b16 a[6:7], v18 offset:8704
  ds_read_b64_tr_b16 a[92:93], v22 offset:2048
  ds_read_b64_tr_b16 a[94:95], v22 offset:3072
  s_waitcnt lgkmcnt(15)
  v_mfma_f32_32x32x16_bf16 v[64:79], v[228:231], a[16:19], v[64:79]
  ds_read_b64_tr_b16 a[8:9], v17 offset:10240
  ds_read_b64_tr_b16 a[10:11], v17 offset:10752
  v_mfma_f32_32x32x16_bf16 v[80:95], v[228:231], a[20:23], v[80:95]
  ds_read_b64_tr_b16 a[12:13], v18 offset:10240
  ds_read_b64_tr_b16 a[14:15], v18 offset:10752
  s_waitcnt lgkmcnt(4)
  s_add_u32 s4, s51, 98304
  v_mfma_f32_32x32x16_bf16 v[96:111], v[228:231], a[24:27], v[96:111]
  ds_read_b64_tr_b16 a[16:17], v17 offset:12288
  ds_read_b64_tr_b16 a[18:19], v17 offset:12800
  s_add_u32 m0, s46, 147456
  s_nop 0
  buffer_load_dwordx4 v6, s[28:31], s4 offen lds
  v_mfma_f32_32x32x16_bf16 v[112:127], v[228:231], a[28:31], v[112:127]
  ds_read_b64_tr_b16 a[20:21], v18 offset:12288
  ds_read_b64_tr_b16 a[22:23], v18 offset:12800
  buffer_load_dwordx4 v7, s[28:31], s4 offen offset:1024 lds
  v_mfma_f32_32x32x16_bf16 v[64:79], v[232:235], a[0:3], v[64:79]
  ds_read_b64_tr_b16 a[24:25], v17 offset:14336
  ds_read_b64_tr_b16 a[26:27], v17 offset:14848
  buffer_load_dwordx4 v8, s[28:31], s4 offen offset:2048 lds
  v_mfma_f32_32x32x16_bf16 v[80:95], v[232:235], a[4:7], v[80:95]
  ds_read_b64_tr_b16 a[28:29], v18 offset:14336
  ds_read_b64_tr_b16 a[30:31], v18 offset:14848
  buffer_load_dwordx4 v9, s[28:31], s4 offen offset:3072 lds
  s_cmp_eq_u32 s45, 0
  s_cselect_b32 s44, 64, 0
  s_mov_b64 exec, 0xf
  v_cmp_le_u32 vcc, s44, v31
  s_mov_b64 exec, -1
  s_nop 2
  s_cmp_eq_u64 vcc, 0xf
  s_cbranch_scc0 L_KV_slow_1
L_KV_pback_2:
  s_waitcnt lgkmcnt(8)
  v_mfma_f32_32x32x16_bf16 v[96:111], v[232:235], a[8:11], v[96:111]
  s_barrier
  v_add_u32 v17, 114688, v14
  v_xor_b32 v18, 64, v17
  ds_read_b64_tr_b16 a[0:1], v17 offset:0
  ds_read_b64_tr_b16 a[2:3], v17 offset:512
  s_add_u32 s3, s65, 5
  s_and_b32 s3, s3, 7
  s_mul_i32 s3, s3, 229376
  s_add_u32 s3, s3, s49
  v_mfma_f32_32x32x16_bf16 v[112:127], v[232:235], a[12:15], v[112:127]
  ds_read_b64_tr_b16 a[4:5], v18 offset:0
  ds_read_b64_tr_b16 a[6:7], v18 offset:512
  s_add_u32 m0, s46, 81920
  s_nop 0
  buffer_load_dwordx4 v2, s[20:23], s3 offen lds
  s_waitcnt lgkmcnt(8)
  v_mfma_f32_32x32x16_bf16 v[64:79], v[236:239], a[16:19], v[64:79]
  ds_read_b64_tr_b16 a[8:9], v17 offset:2048
  ds_read_b64_tr_b16 a[10:11], v17 offset:2560
  buffer_load_dwordx4 v3, s[20:23], s3 offen offset:1024 lds
  v_mfma_f32_32x32x16_bf16 v[80:95], v[236:239], a[20:23], v[80:95]
  ds_read_b64_tr_b16 a[12:13], v18 offset:2048
  ds_read_b64_tr_b16 a[14:15], v18 offset:2560
  buffer_load_dwordx4 v4, s[24:27], s3 offen offset:2048 lds
  s_waitcnt lgkmcnt(8)
  v_mfma_f32_32x32x16_bf16 v[96:111], v[236:239], a[24:27], v[96:111]
  ds_read_b64_tr_b16 a[16:17], v17 offset:4096
  ds_read_b64_tr_b16 a[18:19], v17 offset:4608
  buffer_load_dwordx4 v5, s[24:27], s3 offen offset:3072 lds
  v_mfma_f32_32x32x16_bf16 v[112:127], v[236:239], a[28:31], v[112:127]
  ds_read_b64_tr_b16 a[20:21], v18 offset:4096
  ds_read_b64_tr_b16 a[22:23], v18 offset:4608
  s_waitcnt lgkmcnt(8)
  v_mfma_f32_32x32x16_bf16 v[64:79], v[240:243], a[0:3], v[64:79]
  ds_read_b64_tr_b16 a[24:25], v17 offset:6144
  ds_read_b64_tr_b16 a[26:27], v17 offset:6656
  s_waitcnt vmcnt(12)
  v_add_u32 v21, 131072, v16
  v_xor_b32 v22, 64, v21
  ds_read_b64_tr_b16 a[96:97], v21 offset:0
  ds_read_b64_tr_b16 a[98:99], v21 offset:1024
  v_mfma_f32_32x32x16_bf16 v[80:95], v[240:243], a[4:7], v[80:95]
  ds_read_b64_tr_b16 a[28:29], v18 offset:6144
  ds_read_b64_tr_b16 a[30:31], v18 offset:6656
  ds_read_b64_tr_b16 a[100:101], v22 offset:0
  ds_read_b64_tr_b16 a[102:103], v22 offset:1024
  s_waitcnt lgkmcnt(12)
  v_mfma_f32_32x32x16_bf16 v[96:111], v[240:243], a[8:11], v[96:111]
  ds_read_b64_tr_b16 a[0:1], v17 offset:8192
  ds_read_b64_tr_b16 a[2:3], v17 offset:8704
  ds_read_b64_tr_b16 a[104:105], v21 offset:2048
  ds_read_b64_tr_b16 a[106:107], v21 offset:3072
  v_mfma_f32_32x32x16_bf16 v[112:127], v[240:243], a[12:15], v[112:127]
  ds_read_b64_tr_b16 a[4:5], v18 offset:8192
  ds_read_b64_tr_b16 a[6:7], v18 offset:8704
  ds_read_b64_tr_b16 a[108:109], v22 offset:2048
  ds_read_b64_tr_b16 a[110:111], v22 offset:3072
  s_waitcnt lgkmcnt(15)
  v_mfma_f32_32x32x16_bf16 v[64:79], v[244:247], a[16:19], v[64:79]
  ds_read_b64_tr_b16 a[8:9], v17 offset:10240
  ds_read_b64_tr_b16 a[10:11], v17 offset:10752
  v_mfma_f32_32x32x16_bf16 v[80:95], v[244:247], a[20:23], v[80:95]
  ds_read_b64_tr_b16 a[12:13], v18 offset:10240
  ds_read_b64_tr_b16 a[14:15], v18 offset:10752
  s_waitcnt lgkmcnt(4)
  s_add_u32 s4, s51, 393216
  v_mfma_f32_32x32x16_bf16 v[96:111], v[244:247], a[24:27], v[96:111]
  ds_read_b64_tr_b16 a[16:17], v17 offset:12288
  ds_read_b64_tr_b16 a[18:19], v17 offset:12800
  s_add_u32 m0, s46, 131072
  s_nop 0
  buffer_load_dwordx4 v6, s[28:31], s4 offen lds
  v_mfma_f32_32x32x16_bf16 v[112:127], v[244:247], a[28:31], v[112:127]
  ds_read_b64_tr_b16 a[20:21], v18 offset:12288
  ds_read_b64_tr_b16 a[22:23], v18 offset:12800
  buffer_load_dwordx4 v7, s[28:31], s4 offen offset:1024 lds
  v_mfma_f32_32x32x16_bf16 v[64:79], v[248:251], a[0:3], v[64:79]
  ds_read_b64_tr_b16 a[24:25], v17 offset:14336
  ds_read_b64_tr_b16 a[26:27], v17 offset:14848
  buffer_load_dwordx4 v8, s[28:31], s4 offen offset:2048 lds
  v_mfma_f32_32x32x16_bf16 v[80:95], v[248:251], a[4:7], v[80:95]
  ds_read_b64_tr_b16 a[28:29], v18 offset:14336
  ds_read_b64_tr_b16 a[30:31], v18 offset:14848
  buffer_load_dwordx4 v9, s[28:31], s4 offen offset:3072 lds
  s_waitcnt lgkmcnt(8)
  v_mfma_f32_32x32x16_bf16 v[96:111], v[248:251], a[8:11], v[96:111]
  s_barrier
  v_add_u32 v17, 0, v13
  v_xor_b32 v18, 32, v17
  v_xor_b32 v19, 64, v17
  v_xor_b32 v20, 96, v17
  ds_read_b64_tr_b16 a[0:1], v17 offset:0
  ds_read_b64_tr_b16 a[2:3], v17 offset:512
  v_mfma_f32_32x32x16_bf16 v[112:127], v[248:251], a[12:15], v[112:127]
  ds_read_b64_tr_b16 a[4:5], v18 offset:0
  ds_read_b64_tr_b16 a[6:7], v18 offset:512
  s_waitcnt lgkmcnt(8)
  v_mfma_f32_32x32x16_bf16 v[64:79], v[252:255], a[16:19], v[64:79]
  ds_read_b64_tr_b16 a[8:9], v19 offset:0
  ds_read_b64_tr_b16 a[10:11], v19 offset:512
  v_mfma_f32_32x32x16_bf16 v[80:95], v[252:255], a[20:23], v[80:95]
  ds_read_b64_tr_b16 a[12:13], v20 offset:0
  ds_read_b64_tr_b16 a[14:15], v20 offset:512
  s_waitcnt lgkmcnt(8)
  v_mfma_f32_32x32x16_bf16 v[96:111], v[252:255], a[24:27], v[96:111]
  ds_read_b64_tr_b16 a[16:17], v17 offset:4096
  ds_read_b64_tr_b16 a[18:19], v17 offset:4608
  v_mfma_f32_32x32x16_bf16 v[112:127], v[252:255], a[28:31], v[112:127]
  ds_read_b64_tr_b16 a[20:21], v18 offset:4096
  ds_read_b64_tr_b16 a[22:23], v18 offset:4608
  v_mov_b32 v62, 0x3fb8aa3b
  v_mov_b32 v63, 0x358637bd
  v_pk_mul_f32 v[26:27], v[64:65], v[62:63] op_sel_hi:[1,0]
  v_pk_mul_f32 v[28:29], v[66:67], v[62:63] op_sel_hi:[1,0]
  v_exp_f32 v26, v26 clamp
  v_exp_f32 v27, v27 clamp
  v_exp_f32 v28, v28 clamp
  v_exp_f32 v29, v29 clamp
  v_max_f32 v64, 0, v64
  v_max_f32 v65, 0, v65
  v_max_f32 v66, 0, v66
  v_max_f32 v67, 0, v67
  v_pk_add_f32 v[26:27], v[26:27], v[62:63] op_sel:[0,1] op_sel_hi:[1,1]
  v_pk_add_f32 v[28:29], v[28:29], v[62:63] op_sel:[0,1] op_sel_hi:[1,1]
  v_pk_add_f32 v[64:65], v[64:65], v[26:27]
  v_pk_add_f32 v[66:67], v[66:67], v[28:29]
  v_pk_mul_f32 v[26:27], v[68:69], v[62:63] op_sel_hi:[1,0]
  v_pk_mul_f32 v[28:29], v[70:71], v[62:63] op_sel_hi:[1,0]
  v_exp_f32 v26, v26 clamp
  v_exp_f32 v27, v27 clamp
  v_exp_f32 v28, v28 clamp
  v_exp_f32 v29, v29 clamp
  v_max_f32 v68, 0, v68
  v_max_f32 v69, 0, v69
  v_max_f32 v70, 0, v70
  v_max_f32 v71, 0, v71
  v_pk_add_f32 v[26:27], v[26:27], v[62:63] op_sel:[0,1] op_sel_hi:[1,1]
  v_pk_add_f32 v[28:29], v[28:29], v[62:63] op_sel:[0,1] op_sel_hi:[1,1]
  v_pk_add_f32 v[68:69], v[68:69], v[26:27]
  v_pk_add_f32 v[70:71], v[70:71], v[28:29]
  v_pk_mul_f32 v[26:27], v[72:73], v[62:63] op_sel_hi:[1,0]
  v_pk_mul_f32 v[28:29], v[74:75], v[62:63] op_sel_hi:[1,0]
  v_exp_f32 v26, v26 clamp
  v_exp_f32 v27, v27 clamp
  v_exp_f32 v28, v28 clamp
  v_exp_f32 v29, v29 clamp
  v_max_f32 v72, 0, v72
  v_max_f32 v73, 0, v73
  v_max_f32 v74, 0, v74
  v_max_f32 v75, 0, v75
  v_pk_add_f32 v[26:27], v[26:27], v[62:63] op_sel:[0,1] op_sel_hi:[1,1]
  v_pk_add_f32 v[28:29], v[28:29], v[62:63] op_sel:[0,1] op_sel_hi:[1,1]
  v_pk_add_f32 v[72:73], v[72:73], v[26:27]
  v_pk_add_f32 v[74:75], v[74:75], v[28:29]
  v_pk_mul_f32 v[26:27], v[76:77], v[62:63] op_sel_hi:[1,0]
  v_pk_mul_f32 v[28:29], v[78:79], v[62:63] op_sel_hi:[1,0]
  v_exp_f32 v26, v26 clamp
  v_exp_f32 v27, v27 clamp
  v_exp_f32 v28, v28 clamp
  v_exp_f32 v29, v29 clamp
  v_max_f32 v76, 0, v76
  v_max_f32 v77, 0, v77
  v_max_f32 v78, 0, v78
  v_max_f32 v79, 0, v79
  v_pk_add_f32 v[26:27], v[26:27], v[62:63] op_sel:[0,1] op_sel_hi:[1,1]
  v_pk_add_f32 v[28:29], v[28:29], v[62:63] op_sel:[0,1] op_sel_hi:[1,1]
  v_pk_add_f32 v[76:77], v[76:77], v[26:27]
  v_pk_add_f32 v[78:79], v[78:79], v[28:29]
  v_cvt_pk_bf16_f32 v32, v64, v65
  v_cvt_pk_bf16_f32 v33, v66, v67
  v_cvt_pk_bf16_f32 v34, v68, v69
  v_cvt_pk_bf16_f32 v35, v70, v71
  v_cvt_pk_bf16_f32 v36, v72, v73
  v_cvt_pk_bf16_f32 v37, v74, v75
  v_cvt_pk_bf16_f32 v38, v76, v77
  v_cvt_pk_bf16_f32 v39, v78, v79
  v_pk_add_f32 v[64:65], v[64:65], v[72:73]
  v_pk_add_f32 v[66:67], v[66:67], v[74:75]
  v_pk_add_f32 v[68:69], v[68:69], v[76:77]
  v_pk_add_f32 v[70:71], v[70:71], v[78:79]
  v_pk_add_f32 v[64:65], v[64:65], v[68:69]
  v_pk_add_f32 v[66:67], v[66:67], v[70:71]
  v_pk_add_f32 v[64:65], v[64:65], v[66:67]
  v_add_f32 v56, v64, v65
  v_pk_mul_f32 v[26:27], v[80:81], v[62:63] op_sel_hi:[1,0]
  v_pk_mul_f32 v[28:29], v[82:83], v[62:63] op_sel_hi:[1,0]
  v_exp_f32 v26, v26 clamp
  v_exp_f32 v27, v27 clamp
  v_exp_f32 v28, v28 clamp
  v_exp_f32 v29, v29 clamp
  v_max_f32 v80, 0, v80
  v_max_f32 v81, 0, v81
  v_max_f32 v82, 0, v82
  v_max_f32 v83, 0, v83
  v_pk_add_f32 v[26:27], v[26:27], v[62:63] op_sel:[0,1] op_sel_hi:[1,1]
  v_pk_add_f32 v[28:29], v[28:29], v[62:63] op_sel:[0,1] op_sel_hi:[1,1]
  v_pk_add_f32 v[80:81], v[80:81], v[26:27]
  v_pk_add_f32 v[82:83], v[82:83], v[28:29]
  v_pk_mul_f32 v[26:27], v[84:85], v[62:63] op_sel_hi:[1,0]
  v_pk_mul_f32 v[28:29], v[86:87], v[62:63] op_sel_hi:[1,0]
  v_exp_f32 v26, v26 clamp
  v_exp_f32 v27, v27 clamp
  v_exp_f32 v28, v28 clamp
  v_exp_f32 v29, v29 clamp
  v_max_f32 v84, 0, v84
  v_max_f32 v85, 0, v85
  v_max_f32 v86, 0, v86
  v_max_f32 v87, 0, v87
  v_pk_add_f32 v[26:27], v[26:27], v[62:63] op_sel:[0,1] op_sel_hi:[1,1]
  v_pk_add_f32 v[28:29], v[28:29], v[62:63] op_sel:[0,1] op_sel_hi:[1,1]
  v_pk_add_f32 v[84:85], v[84:85], v[26:27]
  v_pk_add_f32 v[86:87], v[86:87], v[28:29]
  v_pk_mul_f32 v[26:27], v[88:89], v[62:63] op_sel_hi:[1,0]
  v_pk_mul_f32 v[28:29], v[90:91], v[62:63] op_sel_hi:[1,0]
  v_exp_f32 v26, v26 clamp
  v_exp_f32 v27, v27 clamp
  v_exp_f32 v28, v28 clamp
  v_exp_f32 v29, v29 clamp
  v_max_f32 v88, 0, v88
  v_max_f32 v89, 0, v89
  v_max_f32 v90, 0, v90
  v_max_f32 v91, 0, v91
  v_pk_add_f32 v[26:27], v[26:27], v[62:63] op_sel:[0,1] op_sel_hi:[1,1]
  v_pk_add_f32 v[28:29], v[28:29], v[62:63] op_sel:[0,1] op_sel_hi:[1,1]
  v_pk_add_f32 v[88:89], v[88:89], v[26:27]
  v_pk_add_f32 v[90:91], v[90:91], v[28:29]
  v_pk_mul_f32 v[26:27], v[92:93], v[62:63] op_sel_hi:[1,0]
  v_pk_mul_f32 v[28:29], v[94:95], v[62:63] op_sel_hi:[1,0]
  v_exp_f32 v26, v26 clamp
  v_exp_f32 v27, v27 clamp
  v_exp_f32 v28, v28 clamp
  v_exp_f32 v29, v29 clamp
  v_max_f32 v92, 0, v92
  v_max_f32 v93, 0, v93
  v_max_f32 v94, 0, v94
  v_max_f32 v95, 0, v95
  v_pk_add_f32 v[26:27], v[26:27], v[62:63] op_sel:[0,1] op_sel_hi:[1,1]
  v_pk_add_f32 v[28:29], v[28:29], v[62:63] op_sel:[0,1] op_sel_hi:[1,1]
  v_pk_add_f32 v[92:93], v[92:93], v[26:27]
  v_pk_add_f32 v[94:95], v[94:95], v[28:29]
  v_cvt_pk_bf16_f32 v40, v80, v81
  v_cvt_pk_bf16_f32 v41, v82, v83
  v_cvt_pk_bf16_f32 v42, v84, v85
  v_cvt_pk_bf16_f32 v43, v86, v87
  v_cvt_pk_bf16_f32 v44, v88, v89
  v_cvt_pk_bf16_f32 v45, v90, v91
  v_cvt_pk_bf16_f32 v46, v92, v93
  v_cvt_pk_bf16_f32 v47, v94, v95
  v_pk_add_f32 v[80:81], v[80:81], v[88:89]
  v_pk_add_f32 v[82:83], v[82:83], v[90:91]
  v_pk_add_f32 v[84:85], v[84:85], v[92:93]
  v_pk_add_f32 v[86:87], v[86:87], v[94:95]
  v_pk_add_f32 v[80:81], v[80:81], v[84:85]
  v_pk_add_f32 v[82:83], v[82:83], v[86:87]
  v_pk_add_f32 v[80:81], v[80:81], v[82:83]
  v_add_f32 v57, v80, v81
  v_cvt_pk_bf16_f32 v48, v96, v97
  v_cvt_pk_bf16_f32 v49, v98, v99
  v_cvt_pk_bf16_f32 v50, v100, v101
  v_cvt_pk_bf16_f32 v51, v102, v103
  v_cvt_pk_bf16_f32 v52, v104, v105
  v_cvt_pk_bf16_f32 v53, v106, v107
  v_cvt_pk_bf16_f32 v54, v108, v109
  v_cvt_pk_bf16_f32 v55, v110, v111
  v_cvt_pk_bf16_f32 v112, v112, v113
  v_cvt_pk_bf16_f32 v113, v114, v115
  v_cvt_pk_bf16_f32 v114, v116, v117
  v_cvt_pk_bf16_f32 v115, v118, v119
  v_cvt_pk_bf16_f32 v116, v120, v121
  v_cvt_pk_bf16_f32 v117, v122, v123
  v_cvt_pk_bf16_f32 v118, v124, v125
  v_cvt_pk_bf16_f32 v119, v126, v127
  v_mfma_f32_32x32x16_bf16 v[64:79], v[32:35], v[48:51], 0
  v_mfma_f32_32x32x16_bf16 v[80:95], v[40:43], v[112:115], 0
  v_mfma_f32_32x32x16_bf16 v[64:79], v[36:39], v[52:55], v[64:79]
  v_mfma_f32_32x32x16_bf16 v[80:95], v[44:47], v[116:119], v[80:95]
  v_permlane32_swap_b32 v56, v57
  v_add_f32 v48, v56, v57
  s_lshl_b32 s6, s45, 10
  s_add_u32 s6, s6, 98304
  v_add_u32 v32, s6, v1
  s_add_u32 s6, s46, 98304
  v_add_u32 v33, s6, v1
  s_nop 3
  v_cndmask_b32 v64, v72, v64, s[84:85]
  v_cndmask_b32 v65, v73, v65, s[84:85]
  v_cndmask_b32 v66, v74, v66, s[84:85]
  v_cndmask_b32 v67, v75, v67, s[84:85]
  v_cndmask_b32 v68, v76, v68, s[84:85]
  v_cndmask_b32 v69, v77, v69, s[84:85]
  v_cndmask_b32 v70, v78, v70, s[84:85]
  v_cndmask_b32 v71, v79, v71, s[84:85]
  ds_write_b128 v32, v[64:67] offset:0
  ds_write_b128 v32, v[68:71] offset:4096
  v_cndmask_b32 v80, v88, v80, s[84:85]
  v_cndmask_b32 v81, v89, v81, s[84:85]
  v_cndmask_b32 v82, v90, v82, s[84:85]
  v_cndmask_b32 v83, v91, v83, s[84:85]
  v_cndmask_b32 v84, v92, v84, s[84:85]
  v_cndmask_b32 v85, v93, v85, s[84:85]
  v_cndmask_b32 v86, v94, v86, s[84:85]
  v_cndmask_b32 v87, v95, v87, s[84:85]
  ds_write_b128 v32, v[80:83] offset:8192
  ds_write_b128 v32, v[84:87] offset:12288
  s_waitcnt lgkmcnt(0)
  s_barrier
  s_add_u32 s6, s46, 98304
  v_add_u32 v33, s6, v0
  ds_read_b32 v96, v33 offset:0
  ds_read_b32 v97, v33 offset:256
  ds_read_b32 v98, v33 offset:512
  ds_read_b32 v99, v33 offset:768
  ds_read_b32 v100, v33 offset:1024
  ds_read_b32 v101, v33 offset:1280
  ds_read_b32 v102, v33 offset:1536
  ds_read_b32 v103, v33 offset:1792
  ds_read_b32 v104, v33 offset:2048
  ds_read_b32 v105, v33 offset:2304
  ds_read_b32 v106, v33 offset:2560
  ds_read_b32 v107, v33 offset:2816
  ds_read_b32 v108, v33 offset:3072
  ds_read_b32 v109, v33 offset:3328
  ds_read_b32 v110, v33 offset:3584
  ds_read_b32 v111, v33 offset:3840
  s_waitcnt lgkmcnt(8)
  v_pk_add_f32 v[36:37], v[96:97], v[100:101]
  v_pk_add_f32 v[38:39], v[98:99], v[102:103]
  s_waitcnt lgkmcnt(0)
  v_pk_add_f32 v[104:105], v[104:105], v[108:109]
  v_pk_add_f32 v[106:107], v[106:107], v[110:111]
  v_pk_add_f32 v[36:37], v[36:37], v[104:105]
  v_pk_add_f32 v[38:39], v[38:39], v[106:107]
  s_add_u32 s3, s65, 6
  s_and_b32 s3, s3, 7
  s_mul_i32 s3, s3, 229376
  s_add_u32 s3, s3, s49
  s_add_u32 m0, s46, 98304
  s_nop 0
  buffer_load_dwordx4 v2, s[20:23], s3 offen lds
  buffer_load_dwordx4 v3, s[20:23], s3 offen offset:1024 lds
  buffer_load_dwordx4 v4, s[24:27], s3 offen offset:2048 lds
  buffer_load_dwordx4 v5, s[24:27], s3 offen offset:3072 lds
  s_lshl_b32 s6, s45, 10
  s_add_u32 s6, s6, s68
  buffer_atomic_add_f32 v36, v0, s[36:39], s6 offen offset:0
  buffer_atomic_add_f32 v37, v0, s[36:39], s6 offen offset:256
  buffer_atomic_add_f32 v38, v0, s[36:39], s6 offen offset:512
  buffer_atomic_add_f32 v39, v0, s[36:39], s6 offen offset:768
  s_add_u32 s6, s68, 4096
  buffer_atomic_add_f32 v48, v0, s[36:39], s6 offen
  v_mfma_f32_32x32x16_bf16 v[64:79], a[0:3], v[128:131], 0
  ds_read_b64_tr_b16 a[24:25], v19 offset:4096
  ds_read_b64_tr_b16 a[26:27], v19 offset:4608
  s_waitcnt vmcnt(17)
  v_add_u32 v21, 147456, v16
  v_xor_b32 v22, 64, v21
  ds_read_b64_tr_b16 a[112:113], v21 offset:0
  ds_read_b64_tr_b16 a[114:115], v21 offset:1024
  v_mfma_f32_32x32x16_bf16 v[80:95], a[4:7], v[128:131], 0
  ds_read_b64_tr_b16 a[28:29], v20 offset:4096
  ds_read_b64_tr_b16 a[30:31], v20 offset:4608
  ds_read_b64_tr_b16 a[116:117], v22 offset:0
  ds_read_b64_tr_b16 a[118:119], v22 offset:1024
  v_mfma_f32_32x32x16_bf16 v[96:111], a[8:11], v[128:131], 0
  ds_read_b64_tr_b16 a[0:1], v17 offset:8192
  ds_read_b64_tr_b16 a[2:3], v17 offset:8704
  ds_read_b64_tr_b16 a[120:121], v21 offset:2048
  ds_read_b64_tr_b16 a[122:123], v21 offset:3072
  v_mfma_f32_32x32x16_bf16 v[112:127], a[12:15], v[128:131], 0
  ds_read_b64_tr_b16 a[4:5], v18 offset:8192
  ds_read_b64_tr_b16 a[6:7], v18 offset:8704
  ds_read_b64_tr_b16 a[124:125], v22 offset:2048
  ds_read_b64_tr_b16 a[126:127], v22 offset:3072
  v_mfma_f32_32x32x16_bf16 v[64:79], a[16:19], v[132:135], v[64:79]
  ds_read_b64_tr_b16 a[8:9], v19 offset:8192
  ds_read_b64_tr_b16 a[10:11], v19 offset:8704
  v_mfma_f32_32x32x16_bf16 v[80:95], a[20:23], v[132:135], v[80:95]
  ds_read_b64_tr_b16 a[12:13], v20 offset:8192
  ds_read_b64_tr_b16 a[14:15], v20 offset:8704
  s_waitcnt lgkmcnt(4)
  s_add_u32 s4, s51, 425984
  v_mfma_f32_32x32x16_bf16 v[96:111], a[24:27], v[132:135], v[96:111]
  ds_read_b64_tr_b16 a[16:17], v17 offset:12288
  ds_read_b64_tr_b16 a[18:19], v17 offset:12800
  s_add_u32 m0, s46, 147456
  s_nop 0
  buffer_load_dwordx4 v6, s[28:31], s4 offen lds
  v_mfma_f32_32x32x16_bf16 v[112:127], a[28:31], v[132:135], v[112:127]
  ds_read_b64_tr_b16 a[20:21], v18 offset:12288
  ds_read_b64_tr_b16 a[22:23], v18 offset:12800
  buffer_load_dwordx4 v7, s[28:31], s4 offen offset:1024 lds
  v_mfma_f32_32x32x16_bf16 v[64:79], a[0:3], v[136:139], v[64:79]
  ds_read_b64_tr_b16 a[24:25], v19 offset:12288
  ds_read_b64_tr_b16 a[26:27], v19 offset:12800
  buffer_load_dwordx4 v8, s[28:31], s4 offen offset:2048 lds
  v_mfma_f32_32x32x16_bf16 v[80:95], a[4:7], v[136:139], v[80:95]
  ds_read_b64_tr_b16 a[28:29], v20 offset:12288
  ds_read_b64_tr_b16 a[30:31], v20 offset:12800
  buffer_load_dwordx4 v9, s[28:31], s4 offen offset:3072 lds
  s_waitcnt lgkmcnt(8)
  v_mfma_f32_32x32x16_bf16 v[96:111], a[8:11], v[136:139], v[96:111]
  s_barrier
  v_add_u32 v17, 16384, v13
  v_xor_b32 v18, 32, v17
  v_xor_b32 v19, 64, v17
  v_xor_b32 v20, 96, v17
  ds_read_b64_tr_b16 a[0:1], v17 offset:0
  ds_read_b64_tr_b16 a[2:3], v17 offset:512
  s_add_u32 s3, s65, 7
  s_and_b32 s3, s3, 7
  s_mul_i32 s3, s3, 229376
  s_add_u32 s3, s3, s49
  v_mfma_f32_32x32x16_bf16 v[112:127], a[12:15], v[136:139], v[112:127]
  ds_read_b64_tr_b16 a[4:5], v18 offset:0
  ds_read_b64_tr_b16 a[6:7], v18 offset:512
  s_add_u32 m0, s46, 114688
  s_nop 0
  buffer_load_dwordx4 v2, s[20:23], s3 offen lds
  s_waitcnt lgkmcnt(8)
  v_mfma_f32_32x32x16_bf16 v[64:79], a[16:19], v[140:143], v[64:79]
  ds_read_b64_tr_b16 a[8:9], v19 offset:0
  ds_read_b64_tr_b16 a[10:11], v19 offset:512
  buffer_load_dwordx4 v3, s[20:23], s3 offen offset:1024 lds
  v_mfma_f32_32x32x16_bf16 v[80:95], a[20:23], v[140:143], v[80:95]
  ds_read_b64_tr_b16 a[12:13], v20 offset:0
  ds_read_b64_tr_b16 a[14:15], v20 offset:512
  buffer_load_dwordx4 v4, s[24:27], s3 offen offset:2048 lds
  s_waitcnt lgkmcnt(8)
  v_mfma_f32_32x32x16_bf16 v[96:111], a[24:27], v[140:143], v[96:111]
  ds_read_b64_tr_b16 a[16:17], v17 offset:4096
  ds_read_b64_tr_b16 a[18:19], v17 offset:4608
  buffer_load_dwordx4 v5, s[24:27], s3 offen offset:3072 lds
  v_mfma_f32_32x32x16_bf16 v[112:127], a[28:31], v[140:143], v[112:127]
  ds_read_b64_tr_b16 a[20:21], v18 offset:4096
  ds_read_b64_tr_b16 a[22:23], v18 offset:4608
  s_waitcnt lgkmcnt(8)
  v_mfma_f32_32x32x16_bf16 v[64:79], a[0:3], v[144:147], v[64:79]
  ds_read_b64_tr_b16 a[24:25], v19 offset:4096
  ds_read_b64_tr_b16 a[26:27], v19 offset:4608
  s_waitcnt vmcnt(17)
  v_add_u32 v21, 131072, v16
  v_xor_b32 v22, 64, v21
  ds_read_b64_tr_b16 a[128:129], v21 offset:0
  ds_read_b64_tr_b16 a[130:131], v21 offset:1024
  v_mfma_f32_32x32x16_bf16 v[80:95], a[4:7], v[144:147], v[80:95]
  ds_read_b64_tr_b16 a[28:29], v20 offset:4096
  ds_read_b64_tr_b16 a[30:31], v20 offset:4608
  ds_read_b64_tr_b16 a[132:133], v22 offset:0
  ds_read_b64_tr_b16 a[134:135], v22 offset:1024
  s_waitcnt lgkmcnt(12)
  v_mfma_f32_32x32x16_bf16 v[96:111], a[8:11], v[144:147], v[96:111]
  ds_read_b64_tr_b16 a[0:1], v17 offset:8192
  ds_read_b64_tr_b16 a[2:3], v17 offset:8704
  ds_read_b64_tr_b16 a[136:137], v21 offset:2048
  ds_read_b64_tr_b16 a[138:139], v21 offset:3072
  v_mfma_f32_32x32x16_bf16 v[112:127], a[12:15], v[144:147], v[112:127]
  ds_read_b64_tr_b16 a[4:5], v18 offset:8192
  ds_read_b64_tr_b16 a[6:7], v18 offset:8704
  ds_read_b64_tr_b16 a[140:141], v22 offset:2048
  ds_read_b64_tr_b16 a[142:143], v22 offset:3072
  s_waitcnt lgkmcnt(15)
  v_mfma_f32_32x32x16_bf16 v[64:79], a[16:19], v[148:151], v[64:79]
  ds_read_b64_tr_b16 a[8:9], v19 offset:8192
  ds_read_b64_tr_b16 a[10:11], v19 offset:8704
  v_mfma_f32_32x32x16_bf16 v[80:95], a[20:23], v[148:151], v[80:95]
  ds_read_b64_tr_b16 a[12:13], v20 offset:8192
  ds_read_b64_tr_b16 a[14:15], v20 offset:8704
  s_waitcnt lgkmcnt(4)
  s_add_u32 s4, s51, 131072
  v_mfma_f32_32x32x16_bf16 v[96:111], a[24:27], v[148:151], v[96:111]
  ds_read_b64_tr_b16 a[16:17], v17 offset:12288
  ds_read_b64_tr_b16 a[18:19], v17 offset:12800
  s_add_u32 m0, s46, 131072
  s_nop 0
  buffer_load_dwordx4 v6, s[28:31], s4 offen lds
  v_mfma_f32_32x32x16_bf16 v[112:127], a[28:31], v[148:151], v[112:127]
  ds_read_b64_tr_b16 a[20:21], v18 offset:12288
  ds_read_b64_tr_b16 a[22:23], v18 offset:12800
  buffer_load_dwordx4 v7, s[28:31], s4 offen offset:1024 lds
  v_mfma_f32_32x32x16_bf16 v[64:79], a[0:3], v[152:155], v[64:79]
  ds_read_b64_tr_b16 a[24:25], v19 offset:12288
  ds_read_b64_tr_b16 a[26:27], v19 offset:12800
  buffer_load_dwordx4 v8, s[28:31], s4 offen offset:2048 lds
  v_mfma_f32_32x32x16_bf16 v[80:95], a[4:7], v[152:155], v[80:95]
  ds_read_b64_tr_b16 a[28:29], v20 offset:12288
  ds_read_b64_tr_b16 a[30:31], v20 offset:12800
  buffer_load_dwordx4 v9, s[28:31], s4 offen offset:3072 lds
  v_lshrrev_b32 v60, 2, v30
  v_lshlrev_b32 v60, 7, v60
  v_and_b32 v59, 3, v30
  v_lshl_add_u32 v60, v59, 2, v60
  s_lshl_b32 s6, s62, 8
  s_lshl_b32 s7, s45, 4
  s_add_u32 s6, s6, s7
  s_add_u32 s6, s6, 10552320
  s_mov_b64 exec, 0xff
  buffer_load_dword v58, v60, s[36:39], s6 offen sc1
  s_mov_b64 exec, -1
  s_waitcnt lgkmcnt(8)
  s_nop 2
  v_mfma_f32_32x32x16_bf16 v[96:111], a[8:11], v[152:155], v[96:111]
  s_barrier
  v_add_u32 v17, 32768, v13
  v_xor_b32 v18, 32, v17
  v_xor_b32 v19, 64, v17
  v_xor_b32 v20, 96, v17
  ds_read_b64_tr_b16 a[0:1], v17 offset:0
  ds_read_b64_tr_b16 a[2:3], v17 offset:512
  v_add_u32 v2, 4096, v12
  v_add_u32 v4, 59392, v12
  v_xor_b32 v5, 32, v12
  v_add_u32 v3, 3072, v5
  v_add_u32 v5, 58368, v5
  s_add_u32 s3, s66, 0
  s_and_b32 s3, s3, 3
  s_mul_i32 s3, s3, 458752
  s_add_u32 s3, s3, s50
  v_mfma_f32_32x32x16_bf16 v[112:127], a[12:15], v[152:155], v[112:127]
  ds_read_b64_tr_b16 a[4:5], v18 offset:0
  ds_read_b64_tr_b16 a[6:7], v18 offset:512
  s_add_u32 m0, s46, 0
  s_nop 0
  buffer_load_dwordx4 v2, s[20:23], s3 offen lds
  s_waitcnt lgkmcnt(8)
  v_mfma_f32_32x32x16_bf16 v[64:79], a[16:19], v[156:159], v[64:79]
  ds_read_b64_tr_b16 a[8:9], v19 offset:0
  ds_read_b64_tr_b16 a[10:11], v19 offset:512
  buffer_load_dwordx4 v3, s[24:27], s3 offen offset:1024 lds
  v_mfma_f32_32x32x16_bf16 v[80:95], a[20:23], v[156:159], v[80:95]
  ds_read_b64_tr_b16 a[12:13], v20 offset:0
  ds_read_b64_tr_b16 a[14:15], v20 offset:512
  buffer_load_dwordx4 v4, s[20:23], s3 offen offset:2048 lds
  s_waitcnt lgkmcnt(8)
  v_mfma_f32_32x32x16_bf16 v[96:111], a[24:27], v[156:159], v[96:111]
  ds_read_b64_tr_b16 a[16:17], v17 offset:4096
  ds_read_b64_tr_b16 a[18:19], v17 offset:4608
  buffer_load_dwordx4 v5, s[24:27], s3 offen offset:3072 lds
  v_mfma_f32_32x32x16_bf16 v[112:127], a[28:31], v[156:159], v[112:127]
  ds_read_b64_tr_b16 a[20:21], v18 offset:4096
  ds_read_b64_tr_b16 a[22:23], v18 offset:4608
  s_waitcnt lgkmcnt(8)
  v_mfma_f32_32x32x16_bf16 v[64:79], a[0:3], v[160:163], v[64:79]
  ds_read_b64_tr_b16 a[24:25], v19 offset:4096
  ds_read_b64_tr_b16 a[26:27], v19 offset:4608
  s_waitcnt vmcnt(13)
  v_add_u32 v21, 147456, v16
  v_xor_b32 v22, 64, v21
  ds_read_b64_tr_b16 a[144:145], v21 offset:0
  ds_read_b64_tr_b16 a[146:147], v21 offset:1024
  v_mfma_f32_32x32x16_bf16 v[80:95], a[4:7], v[160:163], v[80:95]
  ds_read_b64_tr_b16 a[28:29], v20 offset:4096
  ds_read_b64_tr_b16 a[30:31], v20 offset:4608
  ds_read_b64_tr_b16 a[148:149], v22 offset:0
  ds_read_b64_tr_b16 a[150:151], v22 offset:1024
  s_waitcnt lgkmcnt(12)
  v_mfma_f32_32x32x16_bf16 v[96:111], a[8:11], v[160:163], v[96:111]
  ds_read_b64_tr_b16 a[0:1], v17 offset:8192
  ds_read_b64_tr_b16 a[2:3], v17 offset:8704
  ds_read_b64_tr_b16 a[152:153], v21 offset:2048
  ds_read_b64_tr_b16 a[154:155], v21 offset:3072
  v_mfma_f32_32x32x16_bf16 v[112:127], a[12:15], v[160:163], v[112:127]
  ds_read_b64_tr_b16 a[4:5], v18 offset:8192
  ds_read_b64_tr_b16 a[6:7], v18 offset:8704
  ds_read_b64_tr_b16 a[156:157], v22 offset:2048
  ds_read_b64_tr_b16 a[158:159], v22 offset:3072
  s_waitcnt lgkmcnt(15)
  v_mfma_f32_32x32x16_bf16 v[64:79], a[16:19], v[164:167], v[64:79]
  ds_read_b64_tr_b16 a[8:9], v19 offset:8192
  ds_read_b64_tr_b16 a[10:11], v19 offset:8704
  v_mfma_f32_32x32x16_bf16 v[80:95], a[20:23], v[164:167], v[80:95]
  ds_read_b64_tr_b16 a[12:13], v20 offset:8192
  ds_read_b64_tr_b16 a[14:15], v20 offset:8704
  s_waitcnt lgkmcnt(4)
  s_add_u32 s4, s51, 163840
  v_mfma_f32_32x32x16_bf16 v[96:111], a[24:27], v[164:167], v[96:111]
  ds_read_b64_tr_b16 a[16:17], v17 offset:12288
  ds_read_b64_tr_b16 a[18:19], v17 offset:12800
  s_add_u32 m0, s46, 147456
  s_nop 0
  buffer_load_dwordx4 v6, s[28:31], s4 offen lds
  v_mfma_f32_32x32x16_bf16 v[112:127], a[28:31], v[164:167], v[112:127]
  ds_read_b64_tr_b16 a[20:21], v18 offset:12288
  ds_read_b64_tr_b16 a[22:23], v18 offset:12800
  buffer_load_dwordx4 v7, s[28:31], s4 offen offset:1024 lds
  v_mfma_f32_32x32x16_bf16 v[64:79], a[0:3], v[168:171], v[64:79]
  ds_read_b64_tr_b16 a[24:25], v19 offset:12288
  ds_read_b64_tr_b16 a[26:27], v19 offset:12800
  buffer_load_dwordx4 v8, s[28:31], s4 offen offset:2048 lds
  v_mfma_f32_32x32x16_bf16 v[80:95], a[4:7], v[168:171], v[80:95]
  ds_read_b64_tr_b16 a[28:29], v20 offset:12288
  ds_read_b64_tr_b16 a[30:31], v20 offset:12800
  buffer_load_dwordx4 v9, s[28:31], s4 offen offset:3072 lds
  s_waitcnt lgkmcnt(8)
  v_mfma_f32_32x32x16_bf16 v[96:111], a[8:11], v[168:171], v[96:111]
  s_barrier
  v_add_u32 v17, 49152, v13
  v_xor_b32 v18, 32, v17
  v_xor_b32 v19, 64, v17
  v_xor_b32 v20, 96, v17
  s_mov_b64 exec, 1
  v_mov_b32 v61, 1
  buffer_store_dword v61, v25, s[36:39], s69 offen sc1
  s_mov_b64 exec, -1
  ds_read_b64_tr_b16 a[0:1], v17 offset:0
  ds_read_b64_tr_b16 a[2:3], v17 offset:512
  s_add_u32 s3, s66, 1
  s_and_b32 s3, s3, 3
  s_mul_i32 s3, s3, 458752
  s_add_u32 s3, s3, s50
  v_mfma_f32_32x32x16_bf16 v[112:127], a[12:15], v[168:171], v[112:127]
  ds_read_b64_tr_b16 a[4:5], v18 offset:0
  ds_read_b64_tr_b16 a[6:7], v18 offset:512
  s_add_u32 m0, s46, 16384
  s_nop 0
  buffer_load_dwordx4 v2, s[20:23], s3 offen lds
  s_waitcnt lgkmcnt(8)
  v_mfma_f32_32x32x16_bf16 v[64:79], a[16:19], v[172:175], v[64:79]
  ds_read_b64_tr_b16 a[8:9], v19 offset:0
  ds_read_b64_tr_b16 a[10:11], v19 offset:512
  buffer_load_dwordx4 v3, s[24:27], s3 offen offset:1024 lds
  v_mfma_f32_32x32x16_bf16 v[80:95], a[20:23], v[172:175], v[80:95]
  ds_read_b64_tr_b16 a[12:13], v20 offset:0
  ds_read_b64_tr_b16 a[14:15], v20 offset:512
  buffer_load_dwordx4 v4, s[20:23], s3 offen offset:2048 lds
  s_waitcnt lgkmcnt(8)
  v_mfma_f32_32x32x16_bf16 v[96:111], a[24:27], v[172:175], v[96:111]
  ds_read_b64_tr_b16 a[16:17], v17 offset:4096
  ds_read_b64_tr_b16 a[18:19], v17 offset:4608
  buffer_load_dwordx4 v5, s[24:27], s3 offen offset:3072 lds
  v_mfma_f32_32x32x16_bf16 v[112:127], a[28:31], v[172:175], v[112:127]
  ds_read_b64_tr_b16 a[20:21], v18 offset:4096
  ds_read_b64_tr_b16 a[22:23], v18 offset:4608
  s_waitcnt lgkmcnt(8)
  v_mfma_f32_32x32x16_bf16 v[64:79], a[0:3], v[176:179], v[64:79]
  ds_read_b64_tr_b16 a[24:25], v19 offset:4096
  ds_read_b64_tr_b16 a[26:27], v19 offset:4608
  s_waitcnt vmcnt(14)
  v_add_u32 v21, 131072, v16
  v_xor_b32 v22, 64, v21
  ds_read_b64_tr_b16 a[160:161], v21 offset:0
  ds_read_b64_tr_b16 a[162:163], v21 offset:1024
  v_mfma_f32_32x32x16_bf16 v[80:95], a[4:7], v[176:179], v[80:95]
  ds_read_b64_tr_b16 a[28:29], v20 offset:4096
  ds_read_b64_tr_b16 a[30:31], v20 offset:4608
  ds_read_b64_tr_b16 a[164:165], v22 offset:0
  ds_read_b64_tr_b16 a[166:167], v22 offset:1024
  s_waitcnt lgkmcnt(12)
  v_mfma_f32_32x32x16_bf16 v[96:111], a[8:11], v[176:179], v[96:111]
  ds_read_b64_tr_b16 a[0:1], v17 offset:8192
  ds_read_b64_tr_b16 a[2:3], v17 offset:8704
  ds_read_b64_tr_b16 a[168:169], v21 offset:2048
  ds_read_b64_tr_b16 a[170:171], v21 offset:3072
  v_mfma_f32_32x32x16_bf16 v[112:127], a[12:15], v[176:179], v[112:127]
  ds_read_b64_tr_b16 a[4:5], v18 offset:8192
  ds_read_b64_tr_b16 a[6:7], v18 offset:8704
  ds_read_b64_tr_b16 a[172:173], v22 offset:2048
  ds_read_b64_tr_b16 a[174:175], v22 offset:3072
  s_waitcnt lgkmcnt(15)
  v_mfma_f32_32x32x16_bf16 v[64:79], a[16:19], v[180:183], v[64:79]
  ds_read_b64_tr_b16 a[8:9], v19 offset:8192
  ds_read_b64_tr_b16 a[10:11], v19 offset:8704
  v_mfma_f32_32x32x16_bf16 v[80:95], a[20:23], v[180:183], v[80:95]
  ds_read_b64_tr_b16 a[12:13], v20 offset:8192
  ds_read_b64_tr_b16 a[14:15], v20 offset:8704
  s_waitcnt lgkmcnt(4)
  s_add_u32 s4, s51, 262144
  v_mfma_f32_32x32x16_bf16 v[96:111], a[24:27], v[180:183], v[96:111]
  ds_read_b64_tr_b16 a[16:17], v17 offset:12288
  ds_read_b64_tr_b16 a[18:19], v17 offset:12800
  s_add_u32 m0, s46, 131072
  s_nop 0
  buffer_load_dwordx4 v6, s[28:31], s4 offen lds
  v_mfma_f32_32x32x16_bf16 v[112:127], a[28:31], v[180:183], v[112:127]
  ds_read_b64_tr_b16 a[20:21], v18 offset:12288
  ds_read_b64_tr_b16 a[22:23], v18 offset:12800
  buffer_load_dwordx4 v7, s[28:31], s4 offen offset:1024 lds
  v_mfma_f32_32x32x16_bf16 v[64:79], a[0:3], v[184:187], v[64:79]
  ds_read_b64_tr_b16 a[24:25], v19 offset:12288
  ds_read_b64_tr_b16 a[26:27], v19 offset:12800
  buffer_load_dwordx4 v8, s[28:31], s4 offen offset:2048 lds
  v_mfma_f32_32x32x16_bf16 v[80:95], a[4:7], v[184:187], v[80:95]
  ds_read_b64_tr_b16 a[28:29], v20 offset:12288
  ds_read_b64_tr_b16 a[30:31], v20 offset:12800
  buffer_load_dwordx4 v9, s[28:31], s4 offen offset:3072 lds
  s_waitcnt lgkmcnt(8)
  v_mfma_f32_32x32x16_bf16 v[96:111], a[8:11], v[184:187], v[96:111]
  s_barrier
  v_add_u32 v17, 65536, v13
  v_xor_b32 v18, 32, v17
  v_xor_b32 v19, 64, v17
  v_xor_b32 v20, 96, v17
  ds_read_b64_tr_b16 a[0:1], v17 offset:0
  ds_read_b64_tr_b16 a[2:3], v17 offset:512
  s_add_u32 s3, s66, 2
  s_and_b32 s3, s3, 3
  s_mul_i32 s3, s3, 458752
  s_add_u32 s3, s3, s50
  v_mfma_f32_32x32x16_bf16 v[112:127], a[12:15], v[184:187], v[112:127]
  ds_read_b64_tr_b16 a[4:5], v18 offset:0
  ds_read_b64_tr_b16 a[6:7], v18 offset:512
  s_add_u32 m0, s46, 32768
  s_nop 0
  buffer_load_dwordx4 v2, s[20:23], s3 offen lds
  s_waitcnt lgkmcnt(8)
  v_mfma_f32_32x32x16_bf16 v[64:79], a[16:19], v[188:191], v[64:79]
  ds_read_b64_tr_b16 a[8:9], v19 offset:0
  ds_read_b64_tr_b16 a[10:11], v19 offset:512
  buffer_load_dwordx4 v3, s[24:27], s3 offen offset:1024 lds
  v_mfma_f32_32x32x16_bf16 v[80:95], a[20:23], v[188:191], v[80:95]
  ds_read_b64_tr_b16 a[12:13], v20 offset:0
  ds_read_b64_tr_b16 a[14:15], v20 offset:512
  buffer_load_dwordx4 v4, s[20:23], s3 offen offset:2048 lds
  s_waitcnt lgkmcnt(8)
  v_mfma_f32_32x32x16_bf16 v[96:111], a[24:27], v[188:191], v[96:111]
  ds_read_b64_tr_b16 a[16:17], v17 offset:4096
  ds_read_b64_tr_b16 a[18:19], v17 offset:4608
  buffer_load_dwordx4 v5, s[24:27], s3 offen offset:3072 lds
  v_mfma_f32_32x32x16_bf16 v[112:127], a[28:31], v[188:191], v[112:127]
  ds_read_b64_tr_b16 a[20:21], v18 offset:4096
  ds_read_b64_tr_b16 a[22:23], v18 offset:4608
  s_waitcnt lgkmcnt(8)
  v_mfma_f32_32x32x16_bf16 v[64:79], a[0:3], v[192:195], v[64:79]
  ds_read_b64_tr_b16 a[24:25], v19 offset:4096
  ds_read_b64_tr_b16 a[26:27], v19 offset:4608
  s_waitcnt vmcnt(13)
  v_add_u32 v21, 147456, v16
  v_xor_b32 v22, 64, v21
  ds_read_b64_tr_b16 a[176:177], v21 offset:0
  ds_read_b64_tr_b16 a[178:179], v21 offset:1024
  v_mfma_f32_32x32x16_bf16 v[80:95], a[4:7], v[192:195], v[80:95]
  ds_read_b64_tr_b16 a[28:29], v20 offset:4096
  ds_read_b64_tr_b16 a[30:31], v20 offset:4608
  ds_read_b64_tr_b16 a[180:181], v22 offset:0
  ds_read_b64_tr_b16 a[182:183], v22 offset:1024
  s_waitcnt lgkmcnt(12)
  v_mfma_f32_32x32x16_bf16 v[96:111], a[8:11], v[192:195], v[96:111]
  ds_read_b64_tr_b16 a[0:1], v17 offset:8192
  ds_read_b64_tr_b16 a[2:3], v17 offset:8704
  ds_read_b64_tr_b16 a[184:185], v21 offset:2048
  ds_read_b64_tr_b16 a[186:187], v21 offset:3072
  v_mfma_f32_32x32x16_bf16 v[112:127], a[12:15], v[192:195], v[112:127]
  ds_read_b64_tr_b16 a[4:5], v18 offset:8192
  ds_read_b64_tr_b16 a[6:7], v18 offset:8704
  ds_read_b64_tr_b16 a[188:189], v22 offset:2048
  ds_read_b64_tr_b16 a[190:191], v22 offset:3072
  s_waitcnt lgkmcnt(15)
  v_mfma_f32_32x32x16_bf16 v[64:79], a[16:19], v[196:199], v[64:79]
  ds_read_b64_tr_b16 a[8:9], v19 offset:8192
  ds_read_b64_tr_b16 a[10:11], v19 offset:8704
  v_mfma_f32_32x32x16_bf16 v[80:95], a[20:23], v[196:199], v[80:95]
  ds_read_b64_tr_b16 a[12:13], v20 offset:8192
  ds_read_b64_tr_b16 a[14:15], v20 offset:8704
  s_waitcnt lgkmcnt(4)
  s_add_u32 s4, s51, 294912
  v_mfma_f32_32x32x16_bf16 v[96:111], a[24:27], v[196:199], v[96:111]
  ds_read_b64_tr_b16 a[16:17], v17 offset:12288
  ds_read_b64_tr_b16 a[18:19], v17 offset:12800
  s_add_u32 m0, s46, 147456
  s_nop 0
  buffer_load_dwordx4 v6, s[28:31], s4 offen lds
  v_mfma_f32_32x32x16_bf16 v[112:127], a[28:31], v[196:199], v[112:127]
  ds_read_b64_tr_b16 a[20:21], v18 offset:12288
  ds_read_b64_tr_b16 a[22:23], v18 offset:12800
  buffer_load_dwordx4 v7, s[28:31], s4 offen offset:1024 lds
  v_mfma_f32_32x32x16_bf16 v[64:79], a[0:3], v[200:203], v[64:79]
  ds_read_b64_tr_b16 a[24:25], v19 offset:12288
  ds_read_b64_tr_b16 a[26:27], v19 offset:12800
  buffer_load_dwordx4 v8, s[28:31], s4 offen offset:2048 lds
  v_mfma_f32_32x32x16_bf16 v[80:95], a[4:7], v[200:203], v[80:95]
  ds_read_b64_tr_b16 a[28:29], v20 offset:12288
  ds_read_b64_tr_b16 a[30:31], v20 offset:12800
  buffer_load_dwordx4 v9, s[28:31], s4 offen offset:3072 lds
  s_waitcnt lgkmcnt(8)
  v_mfma_f32_32x32x16_bf16 v[96:111], a[8:11], v[200:203], v[96:111]
  s_barrier
  v_add_u32 v17, 81920, v13
  v_xor_b32 v18, 32, v17
  v_xor_b32 v19, 64, v17
  v_xor_b32 v20, 96, v17
  ds_read_b64_tr_b16 a[0:1], v17 offset:0
  ds_read_b64_tr_b16 a[2:3], v17 offset:512
  s_add_u32 s3, s66, 3
  s_and_b32 s3, s3, 3
  s_mul_i32 s3, s3, 458752
  s_add_u32 s3, s3, s50
  v_mfma_f32_32x32x16_bf16 v[112:127], a[12:15], v[200:203], v[112:127]
  ds_read_b64_tr_b16 a[4:5], v18 offset:0
  ds_read_b64_tr_b16 a[6:7], v18 offset:512
  s_add_u32 m0, s46, 49152
  s_nop 0
  buffer_load_dwordx4 v2, s[20:23], s3 offen lds
  s_waitcnt lgkmcnt(8)
  v_mfma_f32_32x32x16_bf16 v[64:79], a[16:19], v[204:207], v[64:79]
  ds_read_b64_tr_b16 a[8:9], v19 offset:0
  ds_read_b64_tr_b16 a[10:11], v19 offset:512
  buffer_load_dwordx4 v3, s[24:27], s3 offen offset:1024 lds
  v_mfma_f32_32x32x16_bf16 v[80:95], a[20:23], v[204:207], v[80:95]
  ds_read_b64_tr_b16 a[12:13], v20 offset:0
  ds_read_b64_tr_b16 a[14:15], v20 offset:512
  buffer_load_dwordx4 v4, s[20:23], s3 offen offset:2048 lds
  s_waitcnt lgkmcnt(8)
  v_mfma_f32_32x32x16_bf16 v[96:111], a[24:27], v[204:207], v[96:111]
  ds_read_b64_tr_b16 a[16:17], v17 offset:4096
  ds_read_b64_tr_b16 a[18:19], v17 offset:4608
  buffer_load_dwordx4 v5, s[24:27], s3 offen offset:3072 lds
  v_mfma_f32_32x32x16_bf16 v[112:127], a[28:31], v[204:207], v[112:127]
  ds_read_b64_tr_b16 a[20:21], v18 offset:4096
  ds_read_b64_tr_b16 a[22:23], v18 offset:4608
  s_waitcnt lgkmcnt(8)
  v_mfma_f32_32x32x16_bf16 v[64:79], a[0:3], v[208:211], v[64:79]
  ds_read_b64_tr_b16 a[24:25], v19 offset:4096
  ds_read_b64_tr_b16 a[26:27], v19 offset:4608
  s_waitcnt vmcnt(12)
  v_add_u32 v21, 131072, v16
  v_xor_b32 v22, 64, v21
  ds_read_b64_tr_b16 a[192:193], v21 offset:0
  ds_read_b64_tr_b16 a[194:195], v21 offset:1024
  v_mfma_f32_32x32x16_bf16 v[80:95], a[4:7], v[208:211], v[80:95]
  ds_read_b64_tr_b16 a[28:29], v20 offset:4096
  ds_read_b64_tr_b16 a[30:31], v20 offset:4608
  ds_read_b64_tr_b16 a[196:197], v22 offset:0
  ds_read_b64_tr_b16 a[198:199], v22 offset:1024
  s_waitcnt lgkmcnt(12)
  v_mfma_f32_32x32x16_bf16 v[96:111], a[8:11], v[208:211], v[96:111]
  ds_read_b64_tr_b16 a[0:1], v17 offset:8192
  ds_read_b64_tr_b16 a[2:3], v17 offset:8704
  ds_read_b64_tr_b16 a[200:201], v21 offset:2048
  ds_read_b64_tr_b16 a[202:203], v21 offset:3072
  v_mfma_f32_32x32x16_bf16 v[112:127], a[12:15], v[208:211], v[112:127]
  ds_read_b64_tr_b16 a[4:5], v18 offset:8192
  ds_read_b64_tr_b16 a[6:7], v18 offset:8704
  ds_read_b64_tr_b16 a[204:205], v22 offset:2048
  ds_read_b64_tr_b16 a[206:207], v22 offset:3072
  s_waitcnt lgkmcnt(15)
  v_mfma_f32_32x32x16_bf16 v[64:79], a[16:19], v[212:215], v[64:79]
  ds_read_b64_tr_b16 a[8:9], v19 offset:8192
  ds_read_b64_tr_b16 a[10:11], v19 offset:8704
  v_mfma_f32_32x32x16_bf16 v[80:95], a[20:23], v[212:215], v[80:95]
  ds_read_b64_tr_b16 a[12:13], v20 offset:8192
  ds_read_b64_tr_b16 a[14:15], v20 offset:8704
  s_waitcnt lgkmcnt(4)
  s_add_u32 s4, s51, 196608
  v_mfma_f32_32x32x16_bf16 v[96:111], a[24:27], v[212:215], v[96:111]
  ds_read_b64_tr_b16 a[16:17], v17 offset:12288
  ds_read_b64_tr_b16 a[18:19], v17 offset:12800
  s_add_u32 m0, s46, 131072
  s_nop 0
  buffer_load_dwordx4 v6, s[28:31], s4 offen lds
  v_mfma_f32_32x32x16_bf16 v[112:127], a[28:31], v[212:215], v[112:127]
  ds_read_b64_tr_b16 a[20:21], v18 offset:12288
  ds_read_b64_tr_b16 a[22:23], v18 offset:12800
  buffer_load_dwordx4 v7, s[28:31], s4 offen offset:1024 lds
  v_mfma_f32_32x32x16_bf16 v[64:79], a[0:3], v[216:219], v[64:79]
  ds_read_b64_tr_b16 a[24:25], v19 offset:12288
  ds_read_b64_tr_b16 a[26:27], v19 offset:12800
  buffer_load_dwordx4 v8, s[28:31], s4 offen offset:2048 lds
  v_mfma_f32_32x32x16_bf16 v[80:95], a[4:7], v[216:219], v[80:95]
  ds_read_b64_tr_b16 a[28:29], v20 offset:12288
  ds_read_b64_tr_b16 a[30:31], v20 offset:12800
  buffer_load_dwordx4 v9, s[28:31], s4 offen offset:3072 lds
  v_readlane_b32 s76, v58, 0
  v_readlane_b32 s77, v58, 1
  v_readlane_b32 s78, v58, 2
  v_readlane_b32 s79, v58, 3
  v_readlane_b32 s80, v58, 4
  v_readlane_b32 s81, v58, 5
  v_readlane_b32 s82, v58, 6
  v_readlane_b32 s83, v58, 7
  s_nop 0
  s_xor_b32 s76, s76, s80
  s_xor_b32 s77, s77, s81
  s_xor_b32 s78, s78, s82
  s_xor_b32 s79, s79, s83
  s_waitcnt lgkmcnt(8)
  v_mfma_f32_32x32x16_bf16 v[96:111], a[8:11], v[216:219], v[96:111]
  s_barrier
  v_add_u32 v17, 98304, v13
  v_xor_b32 v18, 32, v17
  v_xor_b32 v19, 64, v17
  v_xor_b32 v20, 96, v17
  ds_read_b64_tr_b16 a[0:1], v17 offset:0
  ds_read_b64_tr_b16 a[2:3], v17 offset:512
  v_mfma_f32_32x32x16_bf16 v[112:127], a[12:15], v[216:219], v[112:127]
  ds_read_b64_tr_b16 a[4:5], v18 offset:0
  ds_read_b64_tr_b16 a[6:7], v18 offset:512
  s_waitcnt lgkmcnt(8)
  v_mfma_f32_32x32x16_bf16 v[64:79], a[16:19], v[220:223], v[64:79]
  ds_read_b64_tr_b16 a[8:9], v19 offset:0
  ds_read_b64_tr_b16 a[10:11], v19 offset:512
  v_mfma_f32_32x32x16_bf16 v[80:95], a[20:23], v[220:223], v[80:95]
  ds_read_b64_tr_b16 a[12:13], v20 offset:0
  ds_read_b64_tr_b16 a[14:15], v20 offset:512
  s_waitcnt lgkmcnt(8)
  v_mfma_f32_32x32x16_bf16 v[96:111], a[24:27], v[220:223], v[96:111]
  ds_read_b64_tr_b16 a[16:17], v17 offset:4096
  ds_read_b64_tr_b16 a[18:19], v17 offset:4608
  v_mfma_f32_32x32x16_bf16 v[112:127], a[28:31], v[220:223], v[112:127]
  ds_read_b64_tr_b16 a[20:21], v18 offset:4096
  ds_read_b64_tr_b16 a[22:23], v18 offset:4608
  s_waitcnt lgkmcnt(8)
  v_mfma_f32_32x32x16_bf16 v[64:79], a[0:3], v[224:227], v[64:79]
  ds_read_b64_tr_b16 a[24:25], v19 offset:4096
  ds_read_b64_tr_b16 a[26:27], v19 offset:4608
  s_waitcnt vmcnt(8)
  v_add_u32 v21, 147456, v16
  v_xor_b32 v22, 64, v21
  ds_read_b64_tr_b16 a[208:209], v21 offset:0
  ds_read_b64_tr_b16 a[210:211], v21 offset:1024
  v_mfma_f32_32x32x16_bf16 v[80:95], a[4:7], v[224:227], v[80:95]
  ds_read_b64_tr_b16 a[28:29], v20 offset:4096
  ds_read_b64_tr_b16 a[30:31], v20 offset:4608
  ds_read_b64_tr_b16 a[212:213], v22 offset:0
  ds_read_b64_tr_b16 a[214:215], v22 offset:1024
  s_waitcnt lgkmcnt(12)
  v_mfma_f32_32x32x16_bf16 v[96:111], a[8:11], v[224:227], v[96:111]
  ds_read_b64_tr_b16 a[0:1], v17 offset:8192
  ds_read_b64_tr_b16 a[2:3], v17 offset:8704
  ds_read_b64_tr_b16 a[216:217], v21 offset:2048
  ds_read_b64_tr_b16 a[218:219], v21 offset:3072
  v_mfma_f32_32x32x16_bf16 v[112:127], a[12:15], v[224:227], v[112:127]
  ds_read_b64_tr_b16 a[4:5], v18 offset:8192
  ds_read_b64_tr_b16 a[6:7], v18 offset:8704
  ds_read_b64_tr_b16 a[220:221], v22 offset:2048
  ds_read_b64_tr_b16 a[222:223], v22 offset:3072
  s_waitcnt lgkmcnt(15)
  v_mfma_f32_32x32x16_bf16 v[64:79], a[16:19], v[228:231], v[64:79]
  ds_read_b64_tr_b16 a[8:9], v19 offset:8192
  ds_read_b64_tr_b16 a[10:11], v19 offset:8704
  v_mfma_f32_32x32x16_bf16 v[80:95], a[20:23], v[228:231], v[80:95]
  ds_read_b64_tr_b16 a[12:13], v20 offset:8192
  ds_read_b64_tr_b16 a[14:15], v20 offset:8704
  s_waitcnt lgkmcnt(4)
  s_add_u32 s4, s51, 229376
  v_mfma_f32_32x32x16_bf16 v[96:111], a[24:27], v[228:231], v[96:111]
  ds_read_b64_tr_b16 a[16:17], v17 offset:12288
  ds_read_b64_tr_b16 a[18:19], v17 offset:12800
  s_add_u32 m0, s46, 147456
  s_nop 0
  buffer_load_dwordx4 v6, s[28:31], s4 offen lds
  v_mfma_f32_32x32x16_bf16 v[112:127], a[28:31], v[228:231], v[112:127]
  ds_read_b64_tr_b16 a[20:21], v18 offset:12288
  ds_read_b64_tr_b16 a[22:23], v18 offset:12800
  buffer_load_dwordx4 v7, s[28:31], s4 offen offset:1024 lds
  v_mfma_f32_32x32x16_bf16 v[64:79], a[0:3], v[232:235], v[64:79]
  ds_read_b64_tr_b16 a[24:25], v19 offset:12288
  ds_read_b64_tr_b16 a[26:27], v19 offset:12800
  buffer_load_dwordx4 v8, s[28:31], s4 offen offset:2048 lds
  v_mfma_f32_32x32x16_bf16 v[80:95], a[4:7], v[232:235], v[80:95]
  ds_read_b64_tr_b16 a[28:29], v20 offset:12288
  ds_read_b64_tr_b16 a[30:31], v20 offset:12800
  buffer_load_dwordx4 v9, s[28:31], s4 offen offset:3072 lds
  s_waitcnt lgkmcnt(8)
  v_mfma_f32_32x32x16_bf16 v[96:111], a[8:11], v[232:235], v[96:111]
  s_barrier
  v_add_u32 v17, 114688, v13
  v_xor_b32 v18, 32, v17
  v_xor_b32 v19, 64, v17
  v_xor_b32 v20, 96, v17
  ds_read_b64_tr_b16 a[0:1], v17 offset:0
  ds_read_b64_tr_b16 a[2:3], v17 offset:512
  v_mfma_f32_32x32x16_bf16 v[112:127], a[12:15], v[232:235], v[112:127]
  ds_read_b64_tr_b16 a[4:5], v18 offset:0
  ds_read_b64_tr_b16 a[6:7], v18 offset:512
  s_waitcnt lgkmcnt(8)
  v_mfma_f32_32x32x16_bf16 v[64:79], a[16:19], v[236:239], v[64:79]
  ds_read_b64_tr_b16 a[8:9], v19 offset:0
  ds_read_b64_tr_b16 a[10:11], v19 offset:512
  v_mfma_f32_32x32x16_bf16 v[80:95], a[20:23], v[236:239], v[80:95]
  ds_read_b64_tr_b16 a[12:13], v20 offset:0
  ds_read_b64_tr_b16 a[14:15], v20 offset:512
  s_waitcnt lgkmcnt(8)
  v_mfma_f32_32x32x16_bf16 v[96:111], a[24:27], v[236:239], v[96:111]
  ds_read_b64_tr_b16 a[16:17], v17 offset:4096
  ds_read_b64_tr_b16 a[18:19], v17 offset:4608
  v_mfma_f32_32x32x16_bf16 v[112:127], a[28:31], v[236:239], v[112:127]
  ds_read_b64_tr_b16 a[20:21], v18 offset:4096
  ds_read_b64_tr_b16 a[22:23], v18 offset:4608
  s_waitcnt lgkmcnt(8)
  v_mfma_f32_32x32x16_bf16 v[64:79], a[0:3], v[240:243], v[64:79]
  ds_read_b64_tr_b16 a[24:25], v19 offset:4096
  ds_read_b64_tr_b16 a[26:27], v19 offset:4608
  s_waitcnt vmcnt(4)
  v_add_u32 v21, 131072, v16
  v_xor_b32 v22, 64, v21
  ds_read_b64_tr_b16 a[224:225], v21 offset:0
  ds_read_b64_tr_b16 a[226:227], v21 offset:1024
  v_mfma_f32_32x32x16_bf16 v[80:95], a[4:7], v[240:243], v[80:95]
  ds_read_b64_tr_b16 a[28:29], v20 offset:4096
  ds_read_b64_tr_b16 a[30:31], v20 offset:4608
  ds_read_b64_tr_b16 a[228:229], v22 offset:0
  ds_read_b64_tr_b16 a[230:231], v22 offset:1024
  s_waitcnt lgkmcnt(12)
  v_mfma_f32_32x32x16_bf16 v[96:111], a[8:11], v[240:243], v[96:111]
  ds_read_b64_tr_b16 a[0:1], v17 offset:8192
  ds_read_b64_tr_b16 a[2:3], v17 offset:8704
  ds_read_b64_tr_b16 a[232:233], v21 offset:2048
  ds_read_b64_tr_b16 a[234:235], v21 offset:3072
  v_mfma_f32_32x32x16_bf16 v[112:127], a[12:15], v[240:243], v[112:127]
  ds_read_b64_tr_b16 a[4:5], v18 offset:8192
  ds_read_b64_tr_b16 a[6:7], v18 offset:8704
  ds_read_b64_tr_b16 a[236:237], v22 offset:2048
  ds_read_b64_tr_b16 a[238:239], v22 offset:3072
  s_waitcnt lgkmcnt(15)
  v_mfma_f32_32x32x16_bf16 v[64:79], a[16:19], v[244:247], v[64:79]
  ds_read_b64_tr_b16 a[8:9], v19 offset:8192
  ds_read_b64_tr_b16 a[10:11], v19 offset:8704
  v_mfma_f32_32x32x16_bf16 v[80:95], a[20:23], v[244:247], v[80:95]
  ds_read_b64_tr_b16 a[12:13], v20 offset:8192
  ds_read_b64_tr_b16 a[14:15], v20 offset:8704
  s_waitcnt lgkmcnt(4)
  s_add_u32 s4, s52, 0
  v_mfma_f32_32x32x16_bf16 v[96:111], a[24:27], v[244:247], v[96:111]
  ds_read_b64_tr_b16 a[16:17], v17 offset:12288
  ds_read_b64_tr_b16 a[18:19], v17 offset:12800
  s_add_u32 m0, s46, 131072
  s_nop 0
  buffer_load_dwordx4 v6, s[16:19], s4 offen lds
  v_mfma_f32_32x32x16_bf16 v[112:127], a[28:31], v[244:247], v[112:127]
  ds_read_b64_tr_b16 a[20:21], v18 offset:12288
  ds_read_b64_tr_b16 a[22:23], v18 offset:12800
  buffer_load_dwordx4 v7, s[16:19], s4 offen offset:1024 lds
  v_mfma_f32_32x32x16_bf16 v[64:79], a[0:3], v[248:251], v[64:79]
  ds_read_b64_tr_b16 a[24:25], v19 offset:12288
  ds_read_b64_tr_b16 a[26:27], v19 offset:12800
  buffer_load_dwordx4 v8, s[16:19], s4 offen offset:2048 lds
  v_mfma_f32_32x32x16_bf16 v[80:95], a[4:7], v[248:251], v[80:95]
  ds_read_b64_tr_b16 a[28:29], v20 offset:12288
  ds_read_b64_tr_b16 a[30:31], v20 offset:12800
  buffer_load_dwordx4 v9, s[16:19], s4 offen offset:3072 lds
  s_waitcnt lgkmcnt(8)
  v_mfma_f32_32x32x16_bf16 v[96:111], a[8:11], v[248:251], v[96:111]
  s_barrier
  v_add_u32 v17, 0, v15
  v_xor_b32 v18, 32, v17
  ds_read_b64_tr_b16 a[0:1], v17 offset:0
  ds_read_b64_tr_b16 a[2:3], v17 offset:256
  s_add_u32 s4, s52, 65536
  v_mfma_f32_32x32x16_bf16 v[112:127], a[12:15], v[248:251], v[112:127]
  ds_read_b64_tr_b16 a[4:5], v18 offset:0
  ds_read_b64_tr_b16 a[6:7], v18 offset:256
  s_add_u32 m0, s46, 65536
  s_nop 0
  buffer_load_dwordx4 v6, s[16:19], s4 offen lds
  s_waitcnt lgkmcnt(8)
  v_mfma_f32_32x32x16_bf16 v[64:79], a[16:19], v[252:255], v[64:79]
  ds_read_b64_tr_b16 a[8:9], v17 offset:2048
  ds_read_b64_tr_b16 a[10:11], v17 offset:2304
  buffer_load_dwordx4 v7, s[16:19], s4 offen offset:1024 lds
  v_mfma_f32_32x32x16_bf16 v[80:95], a[20:23], v[252:255], v[80:95]
  ds_read_b64_tr_b16 a[12:13], v18 offset:2048
  ds_read_b64_tr_b16 a[14:15], v18 offset:2304
  buffer_load_dwordx4 v8, s[16:19], s4 offen offset:2048 lds
  s_waitcnt lgkmcnt(8)
  v_mfma_f32_32x32x16_bf16 v[96:111], a[24:27], v[252:255], v[96:111]
  ds_read_b64_tr_b16 a[16:17], v17 offset:4096
  ds_read_b64_tr_b16 a[18:19], v17 offset:4352
  buffer_load_dwordx4 v9, s[16:19], s4 offen offset:3072 lds
  v_mfma_f32_32x32x16_bf16 v[112:127], a[28:31], v[252:255], v[112:127]
  ds_read_b64_tr_b16 a[20:21], v18 offset:4096
  ds_read_b64_tr_b16 a[22:23], v18 offset:4352
  v_pk_mul_f32 v[48:49], v[64:65], v[72:73]
  v_pk_mul_f32 v[50:51], v[66:67], v[74:75]
  v_pk_mul_f32 v[52:53], v[68:69], v[76:77]
  v_pk_mul_f32 v[54:55], v[70:71], v[78:79]
  v_cvt_pk_bf16_f32 v32, v48, v49
  v_cvt_pk_bf16_f32 v33, v50, v51
  v_cvt_pk_bf16_f32 v34, v52, v53
  v_cvt_pk_bf16_f32 v35, v54, v55
  buffer_store_dwordx4 v[32:35], v1, s[36:39], s55 offen sc1
  v_pk_mul_f32 v[48:49], v[80:81], v[88:89]
  v_pk_mul_f32 v[50:51], v[82:83], v[90:91]
  v_pk_mul_f32 v[52:53], v[84:85], v[92:93]
  v_pk_mul_f32 v[54:55], v[86:87], v[94:95]
  v_cvt_pk_bf16_f32 v36, v48, v49
  v_cvt_pk_bf16_f32 v37, v50, v51
  v_cvt_pk_bf16_f32 v38, v52, v53
  v_cvt_pk_bf16_f32 v39, v54, v55
  buffer_store_dwordx4 v[36:39], v1, s[36:39], s55 offen offset:2048 sc1
  v_pk_mul_f32 v[48:49], v[96:97], v[104:105]
  v_pk_mul_f32 v[50:51], v[98:99], v[106:107]
  v_pk_mul_f32 v[52:53], v[100:101], v[108:109]
  v_pk_mul_f32 v[54:55], v[102:103], v[110:111]
  v_cvt_pk_bf16_f32 v40, v48, v49
  v_cvt_pk_bf16_f32 v41, v50, v51
  v_cvt_pk_bf16_f32 v42, v52, v53
  v_cvt_pk_bf16_f32 v43, v54, v55
  s_add_u32 s7, s55, 4096
  buffer_store_dwordx4 v[40:43], v1, s[36:39], s7 offen sc1
  v_pk_mul_f32 v[48:49], v[112:113], v[120:121]
  v_pk_mul_f32 v[50:51], v[114:115], v[122:123]
  v_pk_mul_f32 v[52:53], v[116:117], v[124:125]
  v_pk_mul_f32 v[54:55], v[118:119], v[126:127]
  v_cvt_pk_bf16_f32 v44, v48, v49
  v_cvt_pk_bf16_f32 v45, v50, v51
  v_cvt_pk_bf16_f32 v46, v52, v53
  v_cvt_pk_bf16_f32 v47, v54, v55
  buffer_store_dwordx4 v[44:47], v1, s[36:39], s7 offen offset:2048 sc1
  v_bitop3_b32 v26, v32, v33, s72 bitop3:0x96
  v_bitop3_b32 v26, v34, v35, v26 bitop3:0x96
  v_bitop3_b32 v26, v36, v37, v26 bitop3:0x96
  v_bitop3_b32 v26, v38, v39, v26 bitop3:0x96
  v_bitop3_b32 v26, v40, v41, v26 bitop3:0x96
  v_bitop3_b32 v26, v42, v43, v26 bitop3:0x96
  v_bitop3_b32 v26, v44, v45, v26 bitop3:0x96
  v_bitop3_b32 v26, v46, v47, v26 bitop3:0x96
  s_sub_u32 s6, s55, s53
  s_lshr_b32 s6, s6, 2
  s_add_u32 s6, s6, s73
  buffer_store_dword v26, v0, s[36:39], s6 offen sc1
  s_waitcnt lgkmcnt(8)
  v_mfma_f32_32x32x16_bf16 v[64:79], a[0:3], v[128:131], 0
  ds_read_b64_tr_b16 a[24:25], v17 offset:6144
  ds_read_b64_tr_b16 a[26:27], v17 offset:6400
  s_waitcnt vmcnt(13)
  v_add_u32 v21, 147456, v16
  v_xor_b32 v22, 64, v21
  ds_read_b64_tr_b16 a[240:241], v21 offset:0
  ds_read_b64_tr_b16 a[242:243], v21 offset:1024
  v_mfma_f32_32x32x16_bf16 v[80:95], a[4:7], v[128:131], 0
  ds_read_b64_tr_b16 a[28:29], v18 offset:6144
  ds_read_b64_tr_b16 a[30:31], v18 offset:6400
  ds_read_b64_tr_b16 a[244:245], v22 offset:0
  ds_read_b64_tr_b16 a[246:247], v22 offset:1024
  s_waitcnt lgkmcnt(12)
  v_mfma_f32_32x32x16_bf16 v[64:79], a[8:11], v[132:135], v[64:79]
  ds_read_b64_tr_b16 a[0:1], v17 offset:8192
  ds_read_b64_tr_b16 a[2:3], v17 offset:8448
  ds_read_b64_tr_b16 a[248:249], v21 offset:2048
  ds_read_b64_tr_b16 a[250:251], v21 offset:3072
  v_mfma_f32_32x32x16_bf16 v[80:95], a[12:15], v[132:135], v[80:95]
  ds_read_b64_tr_b16 a[4:5], v18 offset:8192
  ds_read_b64_tr_b16 a[6:7], v18 offset:8448
  ds_read_b64_tr_b16 a[252:253], v22 offset:2048
  ds_read_b64_tr_b16 a[254:255], v22 offset:3072
  s_waitcnt lgkmcnt(15)
  v_mfma_f32_32x32x16_bf16 v[64:79], a[16:19], v[136:139], v[64:79]
  ds_read_b64_tr_b16 a[8:9], v17 offset:10240
  ds_read_b64_tr_b16 a[10:11], v17 offset:10496
  v_mfma_f32_32x32x16_bf16 v[80:95], a[20:23], v[136:139], v[80:95]
  ds_read_b64_tr_b16 a[12:13], v18 offset:10240
  ds_read_b64_tr_b16 a[14:15], v18 offset:10496
  s_waitcnt lgkmcnt(4)
  s_add_u32 s4, s52, 32768
  v_mfma_f32_32x32x16_bf16 v[64:79], a[24:27], v[140:143], v[64:79]
  ds_read_b64_tr_b16 a[16:17], v17 offset:12288
  ds_read_b64_tr_b16 a[18:19], v17 offset:12544
  s_add_u32 m0, s46, 147456
  s_nop 0
  buffer_load_dwordx4 v6, s[16:19], s4 offen lds
  v_mfma_f32_32x32x16_bf16 v[80:95], a[28:31], v[140:143], v[80:95]
  ds_read_b64_tr_b16 a[20:21], v18 offset:12288
  ds_read_b64_tr_b16 a[22:23], v18 offset:12544
  buffer_load_dwordx4 v7, s[16:19], s4 offen offset:1024 lds
  s_add_u32 s6, s57, 0
  buffer_load_dwordx4 v[128:131], v1, s[36:39], s6 offen sc1
  buffer_load_dwordx4 v[132:135], v1, s[36:39], s6 offen offset:1024 sc1
  buffer_load_dwordx4 v[136:139], v1, s[36:39], s6 offen offset:2048 sc1
  buffer_load_dwordx4 v[140:143], v1, s[36:39], s6 offen offset:3072 sc1
  v_mfma_f32_32x32x16_bf16 v[64:79], a[0:3], v[144:147], v[64:79]
  ds_read_b64_tr_b16 a[24:25], v17 offset:14336
  ds_read_b64_tr_b16 a[26:27], v17 offset:14592
  buffer_load_dwordx4 v8, s[16:19], s4 offen offset:2048 lds
  v_mfma_f32_32x32x16_bf16 v[80:95], a[4:7], v[144:147], v[80:95]
  ds_read_b64_tr_b16 a[28:29], v18 offset:14336
  ds_read_b64_tr_b16 a[30:31], v18 offset:14592
  buffer_load_dwordx4 v9, s[16:19], s4 offen offset:3072 lds
  s_waitcnt lgkmcnt(8)
  v_mfma_f32_32x32x16_bf16 v[64:79], a[8:11], v[148:151], v[64:79]
  s_barrier
  v_add_u32 v17, 16384, v15
  v_xor_b32 v18, 32, v17
  ds_read_b64_tr_b16 a[0:1], v17 offset:0
  ds_read_b64_tr_b16 a[2:3], v17 offset:256
  s_add_u32 s4, s52, 98304
  v_mfma_f32_32x32x16_bf16 v[80:95], a[12:15], v[148:151], v[80:95]
  ds_read_b64_tr_b16 a[4:5], v18 offset:0
  ds_read_b64_tr_b16 a[6:7], v18 offset:256
  s_add_u32 m0, s46, 81920
  s_nop 0
  buffer_load_dwordx4 v6, s[16:19], s4 offen lds
  s_waitcnt lgkmcnt(8)
  v_mfma_f32_32x32x16_bf16 v[64:79], a[16:19], v[152:155], v[64:79]
  ds_read_b64_tr_b16 a[8:9], v17 offset:2048
  ds_read_b64_tr_b16 a[10:11], v17 offset:2304
  buffer_load_dwordx4 v7, s[16:19], s4 offen offset:1024 lds
  v_mfma_f32_32x32x16_bf16 v[80:95], a[20:23], v[152:155], v[80:95]
  ds_read_b64_tr_b16 a[12:13], v18 offset:2048
  ds_read_b64_tr_b16 a[14:15], v18 offset:2304
  buffer_load_dwordx4 v8, s[16:19], s4 offen offset:2048 lds
  s_waitcnt lgkmcnt(8)
  v_mfma_f32_32x32x16_bf16 v[64:79], a[24:27], v[156:159], v[64:79]
  ds_read_b64_tr_b16 a[16:17], v17 offset:4096
  ds_read_b64_tr_b16 a[18:19], v17 offset:4352
  buffer_load_dwordx4 v9, s[16:19], s4 offen offset:3072 lds
  v_mfma_f32_32x32x16_bf16 v[80:95], a[28:31], v[156:159], v[80:95]
  ds_read_b64_tr_b16 a[20:21], v18 offset:4096
  ds_read_b64_tr_b16 a[22:23], v18 offset:4352
  s_add_u32 s6, s57, 4096
  buffer_load_dwordx4 v[144:147], v1, s[36:39], s6 offen sc1
  buffer_load_dwordx4 v[148:151], v1, s[36:39], s6 offen offset:1024 sc1
  buffer_load_dwordx4 v[152:155], v1, s[36:39], s6 offen offset:2048 sc1
  buffer_load_dwordx4 v[156:159], v1, s[36:39], s6 offen offset:3072 sc1
  s_add_u32 s6, s74, 0
  buffer_load_dword v2, v0, s[36:39], s6 offen sc1
  buffer_load_dword v3, v0, s[36:39], s6 offen offset:256 sc1
  s_waitcnt lgkmcnt(8)
  v_mfma_f32_32x32x16_bf16 v[64:79], a[0:3], v[160:163], v[64:79]
  ds_read_b64_tr_b16 a[24:25], v17 offset:6144
  ds_read_b64_tr_b16 a[26:27], v17 offset:6400
  v_mfma_f32_32x32x16_bf16 v[80:95], a[4:7], v[160:163], v[80:95]
  ds_read_b64_tr_b16 a[28:29], v18 offset:6144
  ds_read_b64_tr_b16 a[30:31], v18 offset:6400
  s_waitcnt lgkmcnt(8)
  v_mfma_f32_32x32x16_bf16 v[64:79], a[8:11], v[164:167], v[64:79]
  ds_read_b64_tr_b16 a[0:1], v17 offset:8192
  ds_read_b64_tr_b16 a[2:3], v17 offset:8448
  v_mfma_f32_32x32x16_bf16 v[80:95], a[12:15], v[164:167], v[80:95]
  ds_read_b64_tr_b16 a[4:5], v18 offset:8192
  ds_read_b64_tr_b16 a[6:7], v18 offset:8448
  s_waitcnt lgkmcnt(8)
  v_mfma_f32_32x32x16_bf16 v[64:79], a[16:19], v[168:171], v[64:79]
  ds_read_b64_tr_b16 a[8:9], v17 offset:10240
  ds_read_b64_tr_b16 a[10:11], v17 offset:10496
  v_mfma_f32_32x32x16_bf16 v[80:95], a[20:23], v[168:171], v[80:95]
  ds_read_b64_tr_b16 a[12:13], v18 offset:10240
  ds_read_b64_tr_b16 a[14:15], v18 offset:10496
  s_waitcnt lgkmcnt(8)
  v_mfma_f32_32x32x16_bf16 v[64:79], a[24:27], v[172:175], v[64:79]
  ds_read_b64_tr_b16 a[16:17], v17 offset:12288
  ds_read_b64_tr_b16 a[18:19], v17 offset:12544
  v_mfma_f32_32x32x16_bf16 v[80:95], a[28:31], v[172:175], v[80:95]
  ds_read_b64_tr_b16 a[20:21], v18 offset:12288
  ds_read_b64_tr_b16 a[22:23], v18 offset:12544
  s_add_u32 s6, s57, 40960
  buffer_load_dwordx4 v[160:163], v1, s[36:39], s6 offen sc1
  buffer_load_dwordx4 v[164:167], v1, s[36:39], s6 offen offset:1024 sc1
  buffer_load_dwordx4 v[168:171], v1, s[36:39], s6 offen offset:2048 sc1
  buffer_load_dwordx4 v[172:175], v1, s[36:39], s6 offen offset:3072 sc1
  s_waitcnt lgkmcnt(8)
  v_mfma_f32_32x32x16_bf16 v[64:79], a[0:3], v[176:179], v[64:79]
  ds_read_b64_tr_b16 a[24:25], v17 offset:14336
  ds_read_b64_tr_b16 a[26:27], v17 offset:14592
  v_mfma_f32_32x32x16_bf16 v[80:95], a[4:7], v[176:179], v[80:95]
  ds_read_b64_tr_b16 a[28:29], v18 offset:14336
  ds_read_b64_tr_b16 a[30:31], v18 offset:14592
  s_waitcnt lgkmcnt(8)
  v_mfma_f32_32x32x16_bf16 v[64:79], a[8:11], v[180:183], v[64:79]
  s_barrier
  v_add_u32 v17, 32768, v15
  v_xor_b32 v18, 32, v17
  ds_read_b64_tr_b16 a[0:1], v17 offset:0
  ds_read_b64_tr_b16 a[2:3], v17 offset:256
  v_mfma_f32_32x32x16_bf16 v[80:95], a[12:15], v[180:183], v[80:95]
  ds_read_b64_tr_b16 a[4:5], v18 offset:0
  ds_read_b64_tr_b16 a[6:7], v18 offset:256
  s_waitcnt lgkmcnt(8)
  v_mfma_f32_32x32x16_bf16 v[64:79], a[16:19], v[184:187], v[64:79]
  ds_read_b64_tr_b16 a[8:9], v17 offset:2048
  ds_read_b64_tr_b16 a[10:11], v17 offset:2304
  v_mfma_f32_32x32x16_bf16 v[80:95], a[20:23], v[184:187], v[80:95]
  ds_read_b64_tr_b16 a[12:13], v18 offset:2048
  ds_read_b64_tr_b16 a[14:15], v18 offset:2304
  s_waitcnt lgkmcnt(8)
  v_mfma_f32_32x32x16_bf16 v[64:79], a[24:27], v[188:191], v[64:79]
  ds_read_b64_tr_b16 a[16:17], v17 offset:4096
  ds_read_b64_tr_b16 a[18:19], v17 offset:4352
  v_mfma_f32_32x32x16_bf16 v[80:95], a[28:31], v[188:191], v[80:95]
  ds_read_b64_tr_b16 a[20:21], v18 offset:4096
  ds_read_b64_tr_b16 a[22:23], v18 offset:4352
  s_add_u32 s6, s57, 45056
  buffer_load_dwordx4 v[176:179], v1, s[36:39], s6 offen sc1
  buffer_load_dwordx4 v[180:183], v1, s[36:39], s6 offen offset:1024 sc1
  buffer_load_dwordx4 v[184:187], v1, s[36:39], s6 offen offset:2048 sc1
  buffer_load_dwordx4 v[188:191], v1, s[36:39], s6 offen offset:3072 sc1
  s_add_u32 s6, s74, 10240
  buffer_load_dword v4, v0, s[36:39], s6 offen sc1
  buffer_load_dword v5, v0, s[36:39], s6 offen offset:256 sc1
  s_waitcnt lgkmcnt(8)
  v_mfma_f32_32x32x16_bf16 v[64:79], a[0:3], v[192:195], v[64:79]
  ds_read_b64_tr_b16 a[24:25], v17 offset:6144
  ds_read_b64_tr_b16 a[26:27], v17 offset:6400
  v_mfma_f32_32x32x16_bf16 v[80:95], a[4:7], v[192:195], v[80:95]
  ds_read_b64_tr_b16 a[28:29], v18 offset:6144
  ds_read_b64_tr_b16 a[30:31], v18 offset:6400
  s_waitcnt lgkmcnt(8)
  v_mfma_f32_32x32x16_bf16 v[64:79], a[8:11], v[196:199], v[64:79]
  ds_read_b64_tr_b16 a[0:1], v17 offset:8192
  ds_read_b64_tr_b16 a[2:3], v17 offset:8448
  v_mfma_f32_32x32x16_bf16 v[80:95], a[12:15], v[196:199], v[80:95]
  ds_read_b64_tr_b16 a[4:5], v18 offset:8192
  ds_read_b64_tr_b16 a[6:7], v18 offset:8448
  s_waitcnt lgkmcnt(8)
  v_mfma_f32_32x32x16_bf16 v[64:79], a[16:19], v[200:203], v[64:79]
  ds_read_b64_tr_b16 a[8:9], v17 offset:10240
  ds_read_b64_tr_b16 a[10:11], v17 offset:10496
  v_mfma_f32_32x32x16_bf16 v[80:95], a[20:23], v[200:203], v[80:95]
  ds_read_b64_tr_b16 a[12:13], v18 offset:10240
  ds_read_b64_tr_b16 a[14:15], v18 offset:10496
  s_waitcnt lgkmcnt(8)
  v_mfma_f32_32x32x16_bf16 v[64:79], a[24:27], v[204:207], v[64:79]
  ds_read_b64_tr_b16 a[16:17], v17 offset:12288
  ds_read_b64_tr_b16 a[18:19], v17 offset:12544
  v_mfma_f32_32x32x16_bf16 v[80:95], a[28:31], v[204:207], v[80:95]
  ds_read_b64_tr_b16 a[20:21], v18 offset:12288
  ds_read_b64_tr_b16 a[22:23], v18 offset:12544
  s_add_u32 s6, s57, 8192
  buffer_load_dwordx4 v[192:195], v1, s[36:39], s6 offen sc1
  buffer_load_dwordx4 v[196:199], v1, s[36:39], s6 offen offset:1024 sc1
  buffer_load_dwordx4 v[200:203], v1, s[36:39], s6 offen offset:2048 sc1
  buffer_load_dwordx4 v[204:207], v1, s[36:39], s6 offen offset:3072 sc1
  s_waitcnt lgkmcnt(8)
  v_mfma_f32_32x32x16_bf16 v[64:79], a[0:3], v[208:211], v[64:79]
  ds_read_b64_tr_b16 a[24:25], v17 offset:14336
  ds_read_b64_tr_b16 a[26:27], v17 offset:14592
  v_mfma_f32_32x32x16_bf16 v[80:95], a[4:7], v[208:211], v[80:95]
  ds_read_b64_tr_b16 a[28:29], v18 offset:14336
  ds_read_b64_tr_b16 a[30:31], v18 offset:14592
  s_waitcnt lgkmcnt(8)
  v_mfma_f32_32x32x16_bf16 v[64:79], a[8:11], v[212:215], v[64:79]
  s_barrier
  v_add_u32 v17, 49152, v15
  v_xor_b32 v18, 32, v17
  ds_read_b64_tr_b16 a[0:1], v17 offset:0
  ds_read_b64_tr_b16 a[2:3], v17 offset:256
  v_mfma_f32_32x32x16_bf16 v[80:95], a[12:15], v[212:215], v[80:95]
  ds_read_b64_tr_b16 a[4:5], v18 offset:0
  ds_read_b64_tr_b16 a[6:7], v18 offset:256
  s_waitcnt lgkmcnt(8)
  v_mfma_f32_32x32x16_bf16 v[64:79], a[16:19], v[216:219], v[64:79]
  ds_read_b64_tr_b16 a[8:9], v17 offset:2048
  ds_read_b64_tr_b16 a[10:11], v17 offset:2304
  v_mfma_f32_32x32x16_bf16 v[80:95], a[20:23], v[216:219], v[80:95]
  ds_read_b64_tr_b16 a[12:13], v18 offset:2048
  ds_read_b64_tr_b16 a[14:15], v18 offset:2304
  s_waitcnt lgkmcnt(8)
  v_mfma_f32_32x32x16_bf16 v[64:79], a[24:27], v[220:223], v[64:79]
  ds_read_b64_tr_b16 a[16:17], v17 offset:4096
  ds_read_b64_tr_b16 a[18:19], v17 offset:4352
  v_mfma_f32_32x32x16_bf16 v[80:95], a[28:31], v[220:223], v[80:95]
  ds_read_b64_tr_b16 a[20:21], v18 offset:4096
  ds_read_b64_tr_b16 a[22:23], v18 offset:4352
  s_add_u32 s6, s57, 12288
  buffer_load_dwordx4 v[208:211], v1, s[36:39], s6 offen sc1
  buffer_load_dwordx4 v[212:215], v1, s[36:39], s6 offen offset:1024 sc1
  buffer_load_dwordx4 v[216:219], v1, s[36:39], s6 offen offset:2048 sc1
  buffer_load_dwordx4 v[220:223], v1, s[36:39], s6 offen offset:3072 sc1
  s_add_u32 s6, s74, 2048
  buffer_load_dword v6, v0, s[36:39], s6 offen sc1
  buffer_load_dword v7, v0, s[36:39], s6 offen offset:256 sc1
  s_waitcnt lgkmcnt(8)
  v_mfma_f32_32x32x16_bf16 v[64:79], a[0:3], v[224:227], v[64:79]
  ds_read_b64_tr_b16 a[24:25], v17 offset:6144
  ds_read_b64_tr_b16 a[26:27], v17 offset:6400
  v_mfma_f32_32x32x16_bf16 v[80:95], a[4:7], v[224:227], v[80:95]
  ds_read_b64_tr_b16 a[28:29], v18 offset:6144
  ds_read_b64_tr_b16 a[30:31], v18 offset:6400
  s_waitcnt lgkmcnt(8)
  v_mfma_f32_32x32x16_bf16 v[64:79], a[8:11], v[228:231], v[64:79]
  ds_read_b64_tr_b16 a[0:1], v17 offset:8192
  ds_read_b64_tr_b16 a[2:3], v17 offset:8448
  v_mfma_f32_32x32x16_bf16 v[80:95], a[12:15], v[228:231], v[80:95]
  ds_read_b64_tr_b16 a[4:5], v18 offset:8192
  ds_read_b64_tr_b16 a[6:7], v18 offset:8448
  s_waitcnt lgkmcnt(8)
  v_mfma_f32_32x32x16_bf16 v[64:79], a[16:19], v[232:235], v[64:79]
  ds_read_b64_tr_b16 a[8:9], v17 offset:10240
  ds_read_b64_tr_b16 a[10:11], v17 offset:10496
  v_mfma_f32_32x32x16_bf16 v[80:95], a[20:23], v[232:235], v[80:95]
  ds_read_b64_tr_b16 a[12:13], v18 offset:10240
  ds_read_b64_tr_b16 a[14:15], v18 offset:10496
  s_waitcnt lgkmcnt(8)
  v_mfma_f32_32x32x16_bf16 v[64:79], a[24:27], v[236:239], v[64:79]
  ds_read_b64_tr_b16 a[16:17], v17 offset:12288
  ds_read_b64_tr_b16 a[18:19], v17 offset:12544
  v_mfma_f32_32x32x16_bf16 v[80:95], a[28:31], v[236:239], v[80:95]
  ds_read_b64_tr_b16 a[20:21], v18 offset:12288
  ds_read_b64_tr_b16 a[22:23], v18 offset:12544
  s_add_u32 s6, s57, 49152
  buffer_load_dwordx4 v[224:227], v1, s[36:39], s6 offen sc1
  buffer_load_dwordx4 v[228:231], v1, s[36:39], s6 offen offset:1024 sc1
  buffer_load_dwordx4 v[232:235], v1, s[36:39], s6 offen offset:2048 sc1
  buffer_load_dwordx4 v[236:239], v1, s[36:39], s6 offen offset:3072 sc1
  s_waitcnt lgkmcnt(8)
  v_mfma_f32_32x32x16_bf16 v[64:79], a[0:3], v[240:243], v[64:79]
  ds_read_b64_tr_b16 a[24:25], v17 offset:14336
  ds_read_b64_tr_b16 a[26:27], v17 offset:14592
  v_mfma_f32_32x32x16_bf16 v[80:95], a[4:7], v[240:243], v[80:95]
  ds_read_b64_tr_b16 a[28:29], v18 offset:14336
  ds_read_b64_tr_b16 a[30:31], v18 offset:14592
  s_waitcnt lgkmcnt(8)
  v_mfma_f32_32x32x16_bf16 v[64:79], a[8:11], v[244:247], v[64:79]
  v_mfma_f32_32x32x16_bf16 v[80:95], a[12:15], v[244:247], v[80:95]
  s_waitcnt lgkmcnt(4)
  v_mfma_f32_32x32x16_bf16 v[64:79], a[16:19], v[248:251], v[64:79]
  v_mfma_f32_32x32x16_bf16 v[80:95], a[20:23], v[248:251], v[80:95]
  s_waitcnt lgkmcnt(0)
  v_mfma_f32_32x32x16_bf16 v[64:79], a[24:27], v[252:255], v[64:79]
  v_mfma_f32_32x32x16_bf16 v[80:95], a[28:31], v[252:255], v[80:95]
  s_add_u32 s6, s57, 53248
  buffer_load_dwordx4 v[240:243], v1, s[36:39], s6 offen sc1
  buffer_load_dwordx4 v[244:247], v1, s[36:39], s6 offen offset:1024 sc1
  buffer_load_dwordx4 v[248:251], v1, s[36:39], s6 offen offset:2048 sc1
  buffer_load_dwordx4 v[252:255], v1, s[36:39], s6 offen offset:3072 sc1
  s_add_u32 s6, s74, 12288
  buffer_load_dword v8, v0, s[36:39], s6 offen sc1
  buffer_load_dword v9, v0, s[36:39], s6 offen offset:256 sc1
  s_nop 2
  v_pk_mul_f32 v[48:49], v[64:65], v[72:73]
  v_pk_mul_f32 v[50:51], v[66:67], v[74:75]
  v_pk_mul_f32 v[52:53], v[68:69], v[76:77]
  v_pk_mul_f32 v[54:55], v[70:71], v[78:79]
  v_cvt_pk_bf16_f32 v32, v48, v49
  v_cvt_pk_bf16_f32 v33, v50, v51
  v_cvt_pk_bf16_f32 v34, v52, v53
  v_cvt_pk_bf16_f32 v35, v54, v55
  buffer_store_dwordx4 v[32:35], v1, s[36:39], s56 offen sc1
  v_pk_mul_f32 v[48:49], v[80:81], v[88:89]
  v_pk_mul_f32 v[50:51], v[82:83], v[90:91]
  v_pk_mul_f32 v[52:53], v[84:85], v[92:93]
  v_pk_mul_f32 v[54:55], v[86:87], v[94:95]
  v_cvt_pk_bf16_f32 v36, v48, v49
  v_cvt_pk_bf16_f32 v37, v50, v51
  v_cvt_pk_bf16_f32 v38, v52, v53
  v_cvt_pk_bf16_f32 v39, v54, v55
  buffer_store_dwordx4 v[36:39], v1, s[36:39], s56 offen offset:2048 sc1
  v_bitop3_b32 v26, v32, v33, s72 bitop3:0x96
  v_bitop3_b32 v26, v34, v35, v26 bitop3:0x96
  v_bitop3_b32 v26, v36, v37, v26 bitop3:0x96
  v_bitop3_b32 v26, v38, v39, v26 bitop3:0x96
  s_sub_u32 s6, s56, s53
  s_lshr_b32 s6, s6, 2
  s_add_u32 s6, s6, s73
  buffer_store_dword v26, v0, s[36:39], s6 offen sc1
  v_lshrrev_b32 v32, 3, v30
  v_lshlrev_b32 v32, 10, v32
  v_and_b32 v33, 7, v30
  v_lshl_add_u32 v32, v33, 4, v32
  s_lshl_b32 s7, s62, 16
  s_lshl_b32 s44, s45, 14
  s_add_u32 s7, s7, s44
  s_lshl_b32 s44, s63, 7
  s_add_u32 s75, s7, s44
  s_add_u32 s7, s75, 4096
  buffer_load_dwordx4 v[48:51], v32, s[8:11], s7 offen
  s_add_u32 s7, s7, 8192
  buffer_load_dwordx4 v[52:55], v32, s[8:11], s7 offen
  s_waitcnt vmcnt(35)
  v_bitop3_b32 v36, v128, v129, v130 bitop3:0x96
  v_bitop3_b32 v37, v145, v146, v147 bitop3:0x96
  v_bitop3_b32 v36, v131, v132, v36 bitop3:0x96
  v_bitop3_b32 v37, v148, v149, v37 bitop3:0x96
  v_bitop3_b32 v36, v133, v134, v36 bitop3:0x96
  v_bitop3_b32 v37, v150, v151, v37 bitop3:0x96
  v_bitop3_b32 v36, v135, v136, v36 bitop3:0x96
  v_bitop3_b32 v37, v152, v153, v37 bitop3:0x96
  v_bitop3_b32 v36, v137, v138, v36 bitop3:0x96
  v_bitop3_b32 v37, v154, v155, v37 bitop3:0x96
  v_bitop3_b32 v36, v139, v140, v36 bitop3:0x96
  v_bitop3_b32 v37, v156, v157, v37 bitop3:0x96
  v_bitop3_b32 v36, v141, v142, v36 bitop3:0x96
  v_bitop3_b32 v37, v158, v159, v37 bitop3:0x96
  v_bitop3_b32 v36, v143, v144, v36 bitop3:0x96
  v_bitop3_b32 v37, v2, v3, v37 bitop3:0x96
  v_bitop3_b32 v36, v36, v37, s76 bitop3:0x96
  v_cmp_ne_u32 vcc, 0, v36
  s_nop 3
  s_cbranch_vccnz L_KV_bad_4
L_KV_back_5:
  v_mfma_f32_32x32x16_bf16 v[64:79], a[32:35], v[128:131], 0
  v_mfma_f32_32x32x16_bf16 v[80:95], a[32:35], v[132:135], 0
  v_mfma_f32_32x32x16_bf16 v[96:111], a[36:39], v[128:131], 0
  v_mfma_f32_32x32x16_bf16 v[112:127], a[36:39], v[132:135], 0
  v_mfma_f32_32x32x16_bf16 v[64:79], a[40:43], v[136:139], v[64:79]
  v_mfma_f32_32x32x16_bf16 v[80:95], a[40:43], v[140:143], v[80:95]
  s_add_u32 s86, s57, 16384
  buffer_load_dwordx4 v[128:131], v1, s[36:39], s86 offen sc1
  v_mfma_f32_32x32x16_bf16 v[96:111], a[44:47], v[136:139], v[96:111]
  v_mfma_f32_32x32x16_bf16 v[112:127], a[44:47], v[140:143], v[112:127]
  buffer_load_dwordx4 v[132:135], v1, s[36:39], s86 offen offset:1024 sc1
  v_mfma_f32_32x32x16_bf16 v[64:79], a[48:51], v[144:147], v[64:79]
  s_waitcnt vmcnt(27)
  v_bitop3_b32 v38, v160, v161, v162 bitop3:0x96
  v_bitop3_b32 v39, v177, v178, v179 bitop3:0x96
  v_mfma_f32_32x32x16_bf16 v[80:95], a[48:51], v[148:151], v[80:95]
  buffer_load_dwordx4 v[136:139], v1, s[36:39], s86 offen offset:2048 sc1
  v_bitop3_b32 v38, v163, v164, v38 bitop3:0x96
  v_bitop3_b32 v39, v180, v181, v39 bitop3:0x96
  v_bitop3_b32 v38, v165, v166, v38 bitop3:0x96
  v_mfma_f32_32x32x16_bf16 v[96:111], a[52:55], v[144:147], v[96:111]
  v_bitop3_b32 v39, v182, v183, v39 bitop3:0x96
  v_bitop3_b32 v38, v167, v168, v38 bitop3:0x96
  v_mfma_f32_32x32x16_bf16 v[112:127], a[52:55], v[148:151], v[112:127]
  buffer_load_dwordx4 v[140:143], v1, s[36:39], s86 offen offset:3072 sc1
  v_bitop3_b32 v39, v184, v185, v39 bitop3:0x96
  v_bitop3_b32 v38, v169, v170, v38 bitop3:0x96
  v_mfma_f32_32x32x16_bf16 v[64:79], a[56:59], v[152:155], v[64:79]
  v_bitop3_b32 v39, v186, v187, v39 bitop3:0x96
  v_bitop3_b32 v38, v171, v172, v38 bitop3:0x96
  v_mfma_f32_32x32x16_bf16 v[80:95], a[56:59], v[156:159], v[80:95]
  s_add_u32 s86, s57, 20480
  buffer_load_dwordx4 v[144:147], v1, s[36:39], s86 offen sc1
  v_bitop3_b32 v39, v188, v189, v39 bitop3:0x96
  v_bitop3_b32 v38, v173, v174, v38 bitop3:0x96
  v_mfma_f32_32x32x16_bf16 v[96:111], a[60:63], v[152:155], v[96:111]
  v_bitop3_b32 v39, v190, v191, v39 bitop3:0x96
  v_bitop3_b32 v38, v175, v176, v38 bitop3:0x96
  v_mfma_f32_32x32x16_bf16 v[112:127], a[60:63], v[156:159], v[112:127]
  buffer_load_dwordx4 v[148:151], v1, s[36:39], s86 offen offset:1024 sc1
  v_bitop3_b32 v39, v4, v5, v39 bitop3:0x96
  v_bitop3_b32 v38, v38, v39, s79 bitop3:0x96
  v_cmp_ne_u32 vcc, 0, v38
  s_nop 3
  s_cbranch_vccnz L_KV_bad_7
L_KV_back_8:
  v_mfma_f32_32x32x16_bf16 v[64:79], a[64:67], v[160:163], v[64:79]
  v_mfma_f32_32x32x16_bf16 v[80:95], a[64:67], v[164:167], v[80:95]
  buffer_load_dwordx4 v[152:155], v1, s[36:39], s86 offen offset:2048 sc1
  v_mfma_f32_32x32x16_bf16 v[96:111], a[68:71], v[160:163], v[96:111]
  v_mfma_f32_32x32x16_bf16 v[112:127], a[68:71], v[164:167], v[112:127]
  buffer_load_dwordx4 v[156:159], v1, s[36:39], s86 offen offset:3072 sc1
  v_mfma_f32_32x32x16_bf16 v[64:79], a[72:75], v[168:171], v[64:79]
  v_mfma_f32_32x32x16_bf16 v[80:95], a[72:75], v[172:175], v[80:95]
  s_add_u32 s6, s74, 4096
  buffer_load_dword v10, v0, s[36:39], s6 offen sc1
  buffer_load_dword v11, v0, s[36:39], s6 offen offset:256 sc1
  s_add_u32 s86, s57, 32768
  buffer_load_dwordx4 v[160:163], v1, s[36:39], s86 offen sc1
  v_mfma_f32_32x32x16_bf16 v[96:111], a[76:79], v[168:171], v[96:111]
  v_mfma_f32_32x32x16_bf16 v[112:127], a[76:79], v[172:175], v[112:127]
  buffer_load_dwordx4 v[164:167], v1, s[36:39], s86 offen offset:1024 sc1
  v_mfma_f32_32x32x16_bf16 v[64:79], a[80:83], v[176:179], v[64:79]
  s_waitcnt vmcnt(27)
  v_bitop3_b32 v36, v192, v193, v194 bitop3:0x96
  v_bitop3_b32 v37, v209, v210, v211 bitop3:0x96
  v_mfma_f32_32x32x16_bf16 v[80:95], a[80:83], v[180:183], v[80:95]
  buffer_load_dwordx4 v[168:171], v1, s[36:39], s86 offen offset:2048 sc1
  v_bitop3_b32 v36, v195, v196, v36 bitop3:0x96
  v_bitop3_b32 v37, v212, v213, v37 bitop3:0x96
  v_bitop3_b32 v36, v197, v198, v36 bitop3:0x96
  v_mfma_f32_32x32x16_bf16 v[96:111], a[84:87], v[176:179], v[96:111]
  v_bitop3_b32 v37, v214, v215, v37 bitop3:0x96
  v_bitop3_b32 v36, v199, v200, v36 bitop3:0x96
  v_mfma_f32_32x32x16_bf16 v[112:127], a[84:87], v[180:183], v[112:127]
  buffer_load_dwordx4 v[172:175], v1, s[36:39], s86 offen offset:3072 sc1
  v_bitop3_b32 v37, v216, v217, v37 bitop3:0x96
  v_bitop3_b32 v36, v201, v202, v36 bitop3:0x96
  v_mfma_f32_32x32x16_bf16 v[64:79], a[88:91], v[184:187], v[64:79]
  v_bitop3_b32 v37, v218, v219, v37 bitop3:0x96
  v_bitop3_b32 v36, v203, v204, v36 bitop3:0x96
  v_mfma_f32_32x32x16_bf16 v[80:95], a[88:91], v[188:191], v[80:95]
  s_add_u32 s86, s57, 36864
  buffer_load_dwordx4 v[176:179], v1, s[36:39], s86 offen sc1
  v_bitop3_b32 v37, v220, v221, v37 bitop3:0x96
  v_bitop3_b32 v36, v205, v206, v36 bitop3:0x96
  v_mfma_f32_32x32x16_bf16 v[96:111], a[92:95], v[184:187], v[96:111]
  v_bitop3_b32 v37, v222, v223, v37 bitop3:0x96
  v_bitop3_b32 v36, v207, v208, v36 bitop3:0x96
  v_mfma_f32_32x32x16_bf16 v[112:127], a[92:95], v[188:191], v[112:127]
  buffer_load_dwordx4 v[180:183], v1, s[36:39], s86 offen offset:1024 sc1
  v_bitop3_b32 v37, v6, v7, v37 bitop3:0x96
  v_bitop3_b32 v36, v36, v37, s76 bitop3:0x96
  v_cmp_ne_u32 vcc, 0, v36
  s_nop 3
  s_cbranch_vccnz L_KV_bad_10
L_KV_back_11:
  v_mfma_f32_32x32x16_bf16 v[64:79], a[96:99], v[192:195], v[64:79]
  v_mfma_f32_32x32x16_bf16 v[80:95], a[96:99], v[196:199], v[80:95]
  buffer_load_dwordx4 v[184:187], v1, s[36:39], s86 offen offset:2048 sc1
  v_mfma_f32_32x32x16_bf16 v[96:111], a[100:103], v[192:195], v[96:111]
  v_mfma_f32_32x32x16_bf16 v[112:127], a[100:103], v[196:199], v[112:127]
  buffer_load_dwordx4 v[188:191], v1, s[36:39], s86 offen offset:3072 sc1
  v_mfma_f32_32x32x16_bf16 v[64:79], a[104:107], v[200:203], v[64:79]
  v_mfma_f32_32x32x16_bf16 v[80:95], a[104:107], v[204:207], v[80:95]
  s_add_u32 s6, s74, 8192
  buffer_load_dword v12, v0, s[36:39], s6 offen sc1
  buffer_load_dword v13, v0, s[36:39], s6 offen offset:256 sc1
  s_add_u32 s86, s57, 24576
  buffer_load_dwordx4 v[192:195], v1, s[36:39], s86 offen sc1
  v_mfma_f32_32x32x16_bf16 v[96:111], a[108:111], v[200:203], v[96:111]
  v_mfma_f32_32x32x16_bf16 v[112:127], a[108:111], v[204:207], v[112:127]
  buffer_load_dwordx4 v[196:199], v1, s[36:39], s86 offen offset:1024 sc1
  v_mfma_f32_32x32x16_bf16 v[64:79], a[112:115], v[208:211], v[64:79]
  s_waitcnt vmcnt(27)
  v_bitop3_b32 v38, v224, v225, v226 bitop3:0x96
  v_bitop3_b32 v39, v241, v242, v243 bitop3:0x96
  v_mfma_f32_32x32x16_bf16 v[80:95], a[112:115], v[212:215], v[80:95]
  buffer_load_dwordx4 v[200:203], v1, s[36:39], s86 offen offset:2048 sc1
  v_bitop3_b32 v38, v227, v228, v38 bitop3:0x96
  v_bitop3_b32 v39, v244, v245, v39 bitop3:0x96
  v_bitop3_b32 v38, v229, v230, v38 bitop3:0x96
  v_mfma_f32_32x32x16_bf16 v[96:111], a[116:119], v[208:211], v[96:111]
  v_bitop3_b32 v39, v246, v247, v39 bitop3:0x96
  v_bitop3_b32 v38, v231, v232, v38 bitop3:0x96
  v_mfma_f32_32x32x16_bf16 v[112:127], a[116:119], v[212:215], v[112:127]
  buffer_load_dwordx4 v[204:207], v1, s[36:39], s86 offen offset:3072 sc1
  v_bitop3_b32 v39, v248, v249, v39 bitop3:0x96
  v_bitop3_b32 v38, v233, v234, v38 bitop3:0x96
  v_mfma_f32_32x32x16_bf16 v[64:79], a[120:123], v[216:219], v[64:79]
  v_bitop3_b32 v39, v250, v251, v39 bitop3:0x96
  v_bitop3_b32 v38, v235, v236, v38 bitop3:0x96
  v_mfma_f32_32x32x16_bf16 v[80:95], a[120:123], v[220:223], v[80:95]
  s_add_u32 s6, s74, 6144
  buffer_load_dword v2, v0, s[36:39], s6 offen sc1
  buffer_load_dword v3, v0, s[36:39], s6 offen offset:256 sc1
  s_add_u32 s86, s57, 28672
  buffer_load_dwordx4 v[208:211], v1, s[36:39], s86 offen sc1
  v_bitop3_b32 v39, v252, v253, v39 bitop3:0x96
  v_bitop3_b32 v38, v237, v238, v38 bitop3:0x96
  v_mfma_f32_32x32x16_bf16 v[96:111], a[124:127], v[216:219], v[96:111]
  v_bitop3_b32 v39, v254, v255, v39 bitop3:0x96
  v_bitop3_b32 v38, v239, v240, v38 bitop3:0x96
  v_mfma_f32_32x32x16_bf16 v[112:127], a[124:127], v[220:223], v[112:127]
  buffer_load_dwordx4 v[212:215], v1, s[36:39], s86 offen offset:1024 sc1
  v_bitop3_b32 v39, v8, v9, v39 bitop3:0x96
  v_bitop3_b32 v38, v38, v39, s79 bitop3:0x96
  v_cmp_ne_u32 vcc, 0, v38
  s_nop 3
  s_cbranch_vccnz L_KV_bad_13
L_KV_back_14:
  v_mfma_f32_32x32x16_bf16 v[64:79], a[128:131], v[224:227], v[64:79]
  v_mfma_f32_32x32x16_bf16 v[80:95], a[128:131], v[228:231], v[80:95]
  buffer_load_dwordx4 v[216:219], v1, s[36:39], s86 offen offset:2048 sc1
  v_mfma_f32_32x32x16_bf16 v[96:111], a[132:135], v[224:227], v[96:111]
  v_mfma_f32_32x32x16_bf16 v[112:127], a[132:135], v[228:231], v[112:127]
  buffer_load_dwordx4 v[220:223], v1, s[36:39], s86 offen offset:3072 sc1
  v_mfma_f32_32x32x16_bf16 v[64:79], a[136:139], v[232:235], v[64:79]
  v_mfma_f32_32x32x16_bf16 v[80:95], a[136:139], v[236:239], v[80:95]
  s_add_u32 s6, s74, 7168
  buffer_load_dword v4, v0, s[36:39], s6 offen sc1
  buffer_load_dword v5, v0, s[36:39], s6 offen offset:256 sc1
  s_add_u32 s86, s58, 0
  buffer_load_dwordx4 v[224:227], v1, s[36:39], s86 offen sc1
  v_mfma_f32_32x32x16_bf16 v[96:111], a[140:143], v[232:235], v[96:111]
  v_mfma_f32_32x32x16_bf16 v[112:127], a[140:143], v[236:239], v[112:127]
  buffer_load_dwordx4 v[228:231], v1, s[36:39], s86 offen offset:1024 sc1
  v_mfma_f32_32x32x16_bf16 v[64:79], a[144:147], v[240:243], v[64:79]
  s_waitcnt vmcnt(24)
  v_bitop3_b32 v36, v128, v129, v130 bitop3:0x96
  v_bitop3_b32 v37, v145, v146, v147 bitop3:0x96
  v_mfma_f32_32x32x16_bf16 v[80:95], a[144:147], v[244:247], v[80:95]
  buffer_load_dwordx4 v[232:235], v1, s[36:39], s86 offen offset:2048 sc1
  v_bitop3_b32 v36, v131, v132, v36 bitop3:0x96
  v_bitop3_b32 v37, v148, v149, v37 bitop3:0x96
  v_bitop3_b32 v36, v133, v134, v36 bitop3:0x96
  v_mfma_f32_32x32x16_bf16 v[96:111], a[148:151], v[240:243], v[96:111]
  v_bitop3_b32 v37, v150, v151, v37 bitop3:0x96
  v_bitop3_b32 v36, v135, v136, v36 bitop3:0x96
  v_mfma_f32_32x32x16_bf16 v[112:127], a[148:151], v[244:247], v[112:127]
  buffer_load_dwordx4 v[236:239], v1, s[36:39], s86 offen offset:3072 sc1
  v_bitop3_b32 v37, v152, v153, v37 bitop3:0x96
  v_bitop3_b32 v36, v137, v138, v36 bitop3:0x96
  v_mfma_f32_32x32x16_bf16 v[64:79], a[152:155], v[248:251], v[64:79]
  v_bitop3_b32 v37, v154, v155, v37 bitop3:0x96
  v_bitop3_b32 v36, v139, v140, v36 bitop3:0x96
  v_mfma_f32_32x32x16_bf16 v[80:95], a[152:155], v[252:255], v[80:95]
  s_add_u32 s86, s58, 4096
  buffer_load_dwordx4 v[240:243], v1, s[36:39], s86 offen sc1
  v_bitop3_b32 v37, v156, v157, v37 bitop3:0x96
  v_bitop3_b32 v36, v141, v142, v36 bitop3:0x96
  v_mfma_f32_32x32x16_bf16 v[96:111], a[156:159], v[248:251], v[96:111]
  v_bitop3_b32 v37, v158, v159, v37 bitop3:0x96
  v_bitop3_b32 v36, v143, v144, v36 bitop3:0x96
  v_mfma_f32_32x32x16_bf16 v[112:127], a[156:159], v[252:255], v[112:127]
  buffer_load_dwordx4 v[244:247], v1, s[36:39], s86 offen offset:1024 sc1
  v_bitop3_b32 v37, v10, v11, v37 bitop3:0x96
  v_bitop3_b32 v36, v36, v37, s77 bitop3:0x96
  v_cmp_ne_u32 vcc, 0, v36
  s_nop 3
  s_cbranch_vccnz L_KV_bad_16
L_KV_back_17:
  v_mfma_f32_32x32x16_bf16 v[64:79], a[160:163], v[128:131], v[64:79]
  v_mfma_f32_32x32x16_bf16 v[80:95], a[160:163], v[132:135], v[80:95]
  buffer_load_dwordx4 v[248:251], v1, s[36:39], s86 offen offset:2048 sc1
  v_mfma_f32_32x32x16_bf16 v[96:111], a[164:167], v[128:131], v[96:111]
  v_mfma_f32_32x32x16_bf16 v[112:127], a[164:167], v[132:135], v[112:127]
  buffer_load_dwordx4 v[252:255], v1, s[36:39], s86 offen offset:3072 sc1
  v_mfma_f32_32x32x16_bf16 v[64:79], a[168:171], v[136:139], v[64:79]
  v_mfma_f32_32x32x16_bf16 v[80:95], a[168:171], v[140:143], v[80:95]
  s_mul_i32 s7, s45, 10240
  s_sub_u32 s7, s74, s7
  s_add_u32 s6, s7, 57344
  buffer_load_dword v6, v0, s[36:39], s6 offen sc1
  buffer_load_dword v7, v0, s[36:39], s6 offen offset:256 sc1
  s_add_u32 s86, s58, 8192
  buffer_load_dwordx4 v[128:131], v1, s[36:39], s86 offen sc1
  v_mfma_f32_32x32x16_bf16 v[96:111], a[172:175], v[136:139], v[96:111]
  v_mfma_f32_32x32x16_bf16 v[112:127], a[172:175], v[140:143], v[112:127]
  buffer_load_dwordx4 v[132:135], v1, s[36:39], s86 offen offset:1024 sc1
  v_mfma_f32_32x32x16_bf16 v[64:79], a[176:179], v[144:147], v[64:79]
  s_waitcnt vmcnt(24)
  v_bitop3_b32 v38, v160, v161, v162 bitop3:0x96
  v_bitop3_b32 v39, v177, v178, v179 bitop3:0x96
  v_mfma_f32_32x32x16_bf16 v[80:95], a[176:179], v[148:151], v[80:95]
  buffer_load_dwordx4 v[136:139], v1, s[36:39], s86 offen offset:2048 sc1
  v_bitop3_b32 v38, v163, v164, v38 bitop3:0x96
  v_bitop3_b32 v39, v180, v181, v39 bitop3:0x96
  v_bitop3_b32 v38, v165, v166, v38 bitop3:0x96
  v_mfma_f32_32x32x16_bf16 v[96:111], a[180:183], v[144:147], v[96:111]
  v_bitop3_b32 v39, v182, v183, v39 bitop3:0x96
  v_bitop3_b32 v38, v167, v168, v38 bitop3:0x96
  v_mfma_f32_32x32x16_bf16 v[112:127], a[180:183], v[148:151], v[112:127]
  buffer_load_dwordx4 v[140:143], v1, s[36:39], s86 offen offset:3072 sc1
  v_bitop3_b32 v39, v184, v185, v39 bitop3:0x96
  v_bitop3_b32 v38, v169, v170, v38 bitop3:0x96
  v_mfma_f32_32x32x16_bf16 v[64:79], a[184:187], v[152:155], v[64:79]
  v_bitop3_b32 v39, v186, v187, v39 bitop3:0x96
  v_bitop3_b32 v38, v171, v172, v38 bitop3:0x96
  v_mfma_f32_32x32x16_bf16 v[80:95], a[184:187], v[156:159], v[80:95]
  s_add_u32 s86, s58, 12288
  buffer_load_dwordx4 v[144:147], v1, s[36:39], s86 offen sc1
  v_bitop3_b32 v39, v188, v189, v39 bitop3:0x96
  v_bitop3_b32 v38, v173, v174, v38 bitop3:0x96
  v_mfma_f32_32x32x16_bf16 v[96:111], a[188:191], v[152:155], v[96:111]
  v_bitop3_b32 v39, v190, v191, v39 bitop3:0x96
  v_bitop3_b32 v38, v175, v176, v38 bitop3:0x96
  v_mfma_f32_32x32x16_bf16 v[112:127], a[188:191], v[156:159], v[112:127]
  buffer_load_dwordx4 v[148:151], v1, s[36:39], s86 offen offset:1024 sc1
  v_bitop3_b32 v39, v12, v13, v39 bitop3:0x96
  v_bitop3_b32 v38, v38, v39, s78 bitop3:0x96
  v_cmp_ne_u32 vcc, 0, v38
  s_nop 3
  s_cbranch_vccnz L_KV_bad_19
L_KV_back_20:
  v_mfma_f32_32x32x16_bf16 v[64:79], a[192:195], v[160:163], v[64:79]
  v_mfma_f32_32x32x16_bf16 v[80:95], a[192:195], v[164:167], v[80:95]
  buffer_load_dwordx4 v[152:155], v1, s[36:39], s86 offen offset:2048 sc1
  v_mfma_f32_32x32x16_bf16 v[96:111], a[196:199], v[160:163], v[96:111]
  v_mfma_f32_32x32x16_bf16 v[112:127], a[196:199], v[164:167], v[112:127]
  buffer_load_dwordx4 v[156:159], v1, s[36:39], s86 offen offset:3072 sc1
  v_mfma_f32_32x32x16_bf16 v[64:79], a[200:203], v[168:171], v[64:79]
  v_mfma_f32_32x32x16_bf16 v[80:95], a[200:203], v[172:175], v[80:95]
  s_mul_i32 s7, s45, 10240
  s_sub_u32 s7, s74, s7
  s_add_u32 s6, s7, 59392
  buffer_load_dword v8, v0, s[36:39], s6 offen sc1
  buffer_load_dword v9, v0, s[36:39], s6 offen offset:256 sc1
  v_mfma_f32_32x32x16_bf16 v[96:111], a[204:207], v[168:171], v[96:111]
  v_mfma_f32_32x32x16_bf16 v[112:127], a[204:207], v[172:175], v[112:127]
  v_mfma_f32_32x32x16_bf16 v[64:79], a[208:211], v[176:179], v[64:79]
  s_waitcnt vmcnt(26)
  v_bitop3_b32 v36, v192, v193, v194 bitop3:0x96
  v_mfma_f32_32x32x16_bf16 v[80:95], a[208:211], v[180:183], v[80:95]
  v_bitop3_b32 v37, v201, v202, v203 bitop3:0x96
  v_bitop3_b32 v36, v195, v196, v36 bitop3:0x96
  v_mfma_f32_32x32x16_bf16 v[96:111], a[212:215], v[176:179], v[96:111]
  v_bitop3_b32 v37, v204, v205, v37 bitop3:0x96
  v_mfma_f32_32x32x16_bf16 v[112:127], a[212:215], v[180:183], v[112:127]
  v_bitop3_b32 v36, v197, v198, v36 bitop3:0x96
  v_mfma_f32_32x32x16_bf16 v[64:79], a[216:219], v[184:187], v[64:79]
  v_bitop3_b32 v37, v206, v207, v37 bitop3:0x96
  v_mfma_f32_32x32x16_bf16 v[80:95], a[216:219], v[188:191], v[80:95]
  v_bitop3_b32 v36, v199, v200, v36 bitop3:0x96
  v_mfma_f32_32x32x16_bf16 v[96:111], a[220:223], v[184:187], v[96:111]
  v_bitop3_b32 v37, v2, v3, v37 bitop3:0x96
  v_mfma_f32_32x32x16_bf16 v[112:127], a[220:223], v[188:191], v[112:127]
  v_bitop3_b32 v36, v36, v37, s77 bitop3:0x96
  v_cmp_ne_u32 vcc, 0, v36
  s_nop 3
  s_cbranch_vccnz L_KV_bad_22
L_KV_back_23:
  v_mfma_f32_32x32x16_bf16 v[64:79], a[224:227], v[192:195], v[64:79]
  s_waitcnt vmcnt(20)
  v_bitop3_b32 v38, v208, v209, v210 bitop3:0x96
  v_mfma_f32_32x32x16_bf16 v[80:95], a[224:227], v[196:199], v[80:95]
  v_bitop3_b32 v39, v217, v218, v219 bitop3:0x96
  v_bitop3_b32 v38, v211, v212, v38 bitop3:0x96
  v_mfma_f32_32x32x16_bf16 v[96:111], a[228:231], v[192:195], v[96:111]
  v_bitop3_b32 v39, v220, v221, v39 bitop3:0x96
  v_mfma_f32_32x32x16_bf16 v[112:127], a[228:231], v[196:199], v[112:127]
  v_bitop3_b32 v38, v213, v214, v38 bitop3:0x96
  v_mfma_f32_32x32x16_bf16 v[64:79], a[232:235], v[200:203], v[64:79]
  v_bitop3_b32 v39, v222, v223, v39 bitop3:0x96
  v_mfma_f32_32x32x16_bf16 v[80:95], a[232:235], v[204:207], v[80:95]
  v_bitop3_b32 v38, v215, v216, v38 bitop3:0x96
  v_mfma_f32_32x32x16_bf16 v[96:111], a[236:239], v[200:203], v[96:111]
  v_bitop3_b32 v39, v4, v5, v39 bitop3:0x96
  v_mfma_f32_32x32x16_bf16 v[112:127], a[236:239], v[204:207], v[112:127]
  v_bitop3_b32 v38, v38, v39, s78 bitop3:0x96
  v_cmp_ne_u32 vcc, 0, v38
  s_nop 3
  s_cbranch_vccnz L_KV_bad_25
L_KV_back_26:
  v_add_u32 v21, 131072, v16
  v_xor_b32 v22, 64, v21
  ds_read_b64_tr_b16 a[0:1], v21 offset:0
  ds_read_b64_tr_b16 a[2:3], v21 offset:1024
  ds_read_b64_tr_b16 a[4:5], v22 offset:0
  ds_read_b64_tr_b16 a[6:7], v22 offset:1024
  v_mfma_f32_32x32x16_bf16 v[64:79], a[240:243], v[208:211], v[64:79]
  s_waitcnt vmcnt(10)
  v_bitop3_b32 v36, v224, v225, v226 bitop3:0x96
  v_bitop3_b32 v37, v241, v242, v243 bitop3:0x96
  v_mfma_f32_32x32x16_bf16 v[80:95], a[240:243], v[212:215], v[80:95]
  v_bitop3_b32 v36, v227, v228, v36 bitop3:0x96
  v_bitop3_b32 v37, v244, v245, v37 bitop3:0x96
  v_bitop3_b32 v36, v229, v230, v36 bitop3:0x96
  v_mfma_f32_32x32x16_bf16 v[96:111], a[244:247], v[208:211], v[96:111]
  v_bitop3_b32 v37, v246, v247, v37 bitop3:0x96
  v_bitop3_b32 v36, v231, v232, v36 bitop3:0x96
  v_mfma_f32_32x32x16_bf16 v[112:127], a[244:247], v[212:215], v[112:127]
  v_bitop3_b32 v37, v248, v249, v37 bitop3:0x96
  v_bitop3_b32 v36, v233, v234, v36 bitop3:0x96
  ds_read_b64_tr_b16 a[8:9], v21 offset:2048
  ds_read_b64_tr_b16 a[10:11], v21 offset:3072
  ds_read_b64_tr_b16 a[12:13], v22 offset:2048
  ds_read_b64_tr_b16 a[14:15], v22 offset:3072
  v_mfma_f32_32x32x16_bf16 v[64:79], a[248:251], v[216:219], v[64:79]
  v_bitop3_b32 v37, v250, v251, v37 bitop3:0x96
  v_bitop3_b32 v36, v235, v236, v36 bitop3:0x96
  v_mfma_f32_32x32x16_bf16 v[80:95], a[248:251], v[220:223], v[80:95]
  v_bitop3_b32 v37, v252, v253, v37 bitop3:0x96
  v_bitop3_b32 v36, v237, v238, v36 bitop3:0x96
  v_mfma_f32_32x32x16_bf16 v[96:111], a[252:255], v[216:219], v[96:111]
  v_bitop3_b32 v37, v254, v255, v37 bitop3:0x96
  v_bitop3_b32 v36, v239, v240, v36 bitop3:0x96
  v_mfma_f32_32x32x16_bf16 v[112:127], a[252:255], v[220:223], v[112:127]
  v_bitop3_b32 v37, v6, v7, v37 bitop3:0x96
  v_bitop3_b32 v36, v36, v37, s76 bitop3:0x96
  v_cmp_ne_u32 vcc, 0, v36
  s_nop 3
  s_cbranch_vccnz L_KV_bad_28
L_KV_back_29:
  v_add_u32 v21, 147456, v16
  v_xor_b32 v22, 64, v21
  ds_read_b64_tr_b16 a[16:17], v21 offset:0
  ds_read_b64_tr_b16 a[18:19], v21 offset:1024
  ds_read_b64_tr_b16 a[20:21], v22 offset:0
  ds_read_b64_tr_b16 a[22:23], v22 offset:1024
  s_waitcnt lgkmcnt(10)
  v_mfma_f32_32x32x16_bf16 v[64:79], a[0:3], v[224:227], v[64:79]
  v_mfma_f32_32x32x16_bf16 v[80:95], a[0:3], v[228:231], v[80:95]
  s_waitcnt lgkmcnt(8)
  v_mfma_f32_32x32x16_bf16 v[96:111], a[4:7], v[224:227], v[96:111]
  v_mfma_f32_32x32x16_bf16 v[112:127], a[4:7], v[228:231], v[112:127]
  ds_read_b64_tr_b16 a[24:25], v21 offset:2048
  ds_read_b64_tr_b16 a[26:27], v21 offset:3072
  ds_read_b64_tr_b16 a[28:29], v22 offset:2048
  ds_read_b64_tr_b16 a[30:31], v22 offset:3072
  s_waitcnt lgkmcnt(10)
  v_mfma_f32_32x32x16_bf16 v[64:79], a[8:11], v[232:235], v[64:79]
  v_mfma_f32_32x32x16_bf16 v[80:95], a[8:11], v[236:239], v[80:95]
  s_waitcnt lgkmcnt(8)
  v_mfma_f32_32x32x16_bf16 v[96:111], a[12:15], v[232:235], v[96:111]
  v_mfma_f32_32x32x16_bf16 v[112:127], a[12:15], v[236:239], v[112:127]
  v_add_u32 v21, 65536, v16
  v_xor_b32 v22, 64, v21
  ds_read_b64_tr_b16 a[0:1], v21 offset:0
  ds_read_b64_tr_b16 a[2:3], v21 offset:1024
  ds_read_b64_tr_b16 a[4:5], v22 offset:0
  ds_read_b64_tr_b16 a[6:7], v22 offset:1024
  s_waitcnt lgkmcnt(10)
  v_mfma_f32_32x32x16_bf16 v[64:79], a[16:19], v[240:243], v[64:79]
  s_waitcnt vmcnt(0)
  v_bitop3_b32 v38, v128, v129, v130 bitop3:0x96
  v_bitop3_b32 v39, v145, v146, v147 bitop3:0x96
  v_mfma_f32_32x32x16_bf16 v[80:95], a[16:19], v[244:247], v[80:95]
  v_bitop3_b32 v38, v131, v132, v38 bitop3:0x96
  v_bitop3_b32 v39, v148, v149, v39 bitop3:0x96
  v_bitop3_b32 v38, v133, v134, v38 bitop3:0x96
  s_waitcnt lgkmcnt(8)
  v_mfma_f32_32x32x16_bf16 v[96:111], a[20:23], v[240:243], v[96:111]
  v_bitop3_b32 v39, v150, v151, v39 bitop3:0x96
  v_bitop3_b32 v38, v135, v136, v38 bitop3:0x96
  v_mfma_f32_32x32x16_bf16 v[112:127], a[20:23], v[244:247], v[112:127]
  v_bitop3_b32 v39, v152, v153, v39 bitop3:0x96
  v_bitop3_b32 v38, v137, v138, v38 bitop3:0x96
  ds_read_b64_tr_b16 a[8:9], v21 offset:2048
  ds_read_b64_tr_b16 a[10:11], v21 offset:3072
  ds_read_b64_tr_b16 a[12:13], v22 offset:2048
  ds_read_b64_tr_b16 a[14:15], v22 offset:3072
  s_waitcnt lgkmcnt(10)
  v_mfma_f32_32x32x16_bf16 v[64:79], a[24:27], v[248:251], v[64:79]
  v_bitop3_b32 v39, v154, v155, v39 bitop3:0x96
  v_bitop3_b32 v38, v139, v140, v38 bitop3:0x96
  v_mfma_f32_32x32x16_bf16 v[80:95], a[24:27], v[252:255], v[80:95]
  v_bitop3_b32 v39, v156, v157, v39 bitop3:0x96
  v_bitop3_b32 v38, v141, v142, v38 bitop3:0x96
  s_waitcnt lgkmcnt(8)
  v_mfma_f32_32x32x16_bf16 v[96:111], a[28:31], v[248:251], v[96:111]
  v_bitop3_b32 v39, v158, v159, v39 bitop3:0x96
  v_bitop3_b32 v38, v143, v144, v38 bitop3:0x96
  v_mfma_f32_32x32x16_bf16 v[112:127], a[28:31], v[252:255], v[112:127]
  v_bitop3_b32 v39, v8, v9, v39 bitop3:0x96
  v_bitop3_b32 v38, v38, v39, s79 bitop3:0x96
  v_cmp_ne_u32 vcc, 0, v38
  s_nop 3
  s_cbranch_vccnz L_KV_bad_31
L_KV_back_32:
  v_add_u32 v21, 81920, v16
  v_xor_b32 v22, 64, v21
  ds_read_b64_tr_b16 a[16:17], v21 offset:0
  ds_read_b64_tr_b16 a[18:19], v21 offset:1024
  ds_read_b64_tr_b16 a[20:21], v22 offset:0
  ds_read_b64_tr_b16 a[22:23], v22 offset:1024
  s_waitcnt lgkmcnt(10)
  v_mfma_f32_32x32x16_bf16 v[64:79], a[0:3], v[128:131], v[64:79]
  v_mfma_f32_32x32x16_bf16 v[80:95], a[0:3], v[132:135], v[80:95]
  s_waitcnt lgkmcnt(8)
  v_mfma_f32_32x32x16_bf16 v[96:111], a[4:7], v[128:131], v[96:111]
  v_mfma_f32_32x32x16_bf16 v[112:127], a[4:7], v[132:135], v[112:127]
  ds_read_b64_tr_b16 a[24:25], v21 offset:2048
  ds_read_b64_tr_b16 a[26:27], v21 offset:3072
  ds_read_b64_tr_b16 a[28:29], v22 offset:2048
  ds_read_b64_tr_b16 a[30:31], v22 offset:3072
  s_waitcnt lgkmcnt(10)
  v_mfma_f32_32x32x16_bf16 v[64:79], a[8:11], v[136:139], v[64:79]
  v_mfma_f32_32x32x16_bf16 v[80:95], a[8:11], v[140:143], v[80:95]
  s_waitcnt lgkmcnt(8)
  v_mfma_f32_32x32x16_bf16 v[96:111], a[12:15], v[136:139], v[96:111]
  v_mfma_f32_32x32x16_bf16 v[112:127], a[12:15], v[140:143], v[112:127]
  s_waitcnt lgkmcnt(6)
  v_mfma_f32_32x32x16_bf16 v[64:79], a[16:19], v[144:147], v[64:79]
  v_mfma_f32_32x32x16_bf16 v[80:95], a[16:19], v[148:151], v[80:95]
  s_waitcnt lgkmcnt(4)
  v_mfma_f32_32x32x16_bf16 v[96:111], a[20:23], v[144:147], v[96:111]
  v_mfma_f32_32x32x16_bf16 v[112:127], a[20:23], v[148:151], v[112:127]
  s_waitcnt lgkmcnt(2)
  v_mfma_f32_32x32x16_bf16 v[64:79], a[24:27], v[152:155], v[64:79]
  v_mfma_f32_32x32x16_bf16 v[80:95], a[24:27], v[156:159], v[80:95]
  s_waitcnt lgkmcnt(0)
  v_mfma_f32_32x32x16_bf16 v[96:111], a[28:31], v[152:155], v[96:111]
  v_mfma_f32_32x32x16_bf16 v[112:127], a[28:31], v[156:159], v[112:127]
  s_lshl_b32 s6, s45, 13
  v_add_u32 v33, s6, v1
  v_xor_b32 v40, 0, v33
  v_xor_b32 v41, 32, v33
  v_xor_b32 v42, 64, v33
  v_xor_b32 v43, 96, v33
  v_xor_b32 v44, 128, v33
  v_xor_b32 v45, 160, v33
  v_xor_b32 v46, 192, v33
  v_xor_b32 v47, 224, v33
  ds_write_b128 v40, v[64:67] offset:0
  ds_write_b128 v41, v[68:71] offset:1024
  ds_write_b128 v42, v[72:75] offset:2048
  ds_write_b128 v43, v[76:79] offset:3072
  ds_write_b128 v44, v[96:99] offset:4096
  ds_write_b128 v45, v[100:103] offset:5120
  ds_write_b128 v46, v[104:107] offset:6144
  ds_write_b128 v47, v[108:111] offset:7168
  ds_write_b128 v40, v[80:83] offset:32768
  ds_write_b128 v41, v[84:87] offset:33792
  ds_write_b128 v42, v[88:91] offset:34816
  ds_write_b128 v43, v[92:95] offset:35840
  ds_write_b128 v44, v[112:115] offset:36864
  ds_write_b128 v45, v[116:119] offset:37888
  ds_write_b128 v46, v[120:123] offset:38912
  ds_write_b128 v47, v[124:127] offset:39936
  v_lshrrev_b32 v34, 3, v30
  s_and_b32 s6, s45, 1
  s_lshl_b32 s6, s6, 4
  v_add_u32 v34, s6, v34
  v_and_b32 v35, 7, v30
  v_lshlrev_b32 v36, 1, v35
  v_xor_b32 v37, v34, v36
  v_lshlrev_b32 v37, 4, v37
  v_lshl_add_u32 v37, v35, 10, v37
  s_lshr_b32 s6, s45, 1
  s_lshl_b32 s6, s6, 15
  v_add_u32 v37, s6, v37
  v_xor_b32 v38, 128, v37
  s_waitcnt lgkmcnt(0)
  s_barrier
  ds_read_b128 v[128:131], v37 offset:0
  ds_read_b128 v[132:135], v37 offset:512
  ds_read_b128 v[136:139], v37 offset:8192
  ds_read_b128 v[140:143], v37 offset:8704
  ds_read_b128 v[144:147], v37 offset:16384
  ds_read_b128 v[148:151], v37 offset:16896
  ds_read_b128 v[152:155], v37 offset:24576
  ds_read_b128 v[156:159], v37 offset:25088
  ds_read_b128 v[160:163], v38 offset:0
  ds_read_b128 v[164:167], v38 offset:512
  ds_read_b128 v[168:171], v38 offset:8192
  ds_read_b128 v[172:175], v38 offset:8704
  ds_read_b128 v[176:179], v38 offset:16384
  ds_read_b128 v[180:183], v38 offset:16896
  ds_read_b128 v[184:187], v38 offset:24576
  ds_read_b128 v[188:191], v38 offset:25088
  v_lshlrev_b32 v64, 16, v48
  v_and_b32 v65, 0xffff0000, v48
  v_lshlrev_b32 v66, 16, v49
  v_and_b32 v67, 0xffff0000, v49
  v_lshlrev_b32 v68, 16, v50
  v_and_b32 v69, 0xffff0000, v50
  v_lshlrev_b32 v70, 16, v51
  v_and_b32 v71, 0xffff0000, v51
  v_lshlrev_b32 v72, 16, v52
  v_and_b32 v73, 0xffff0000, v52
  v_lshlrev_b32 v74, 16, v53
  v_and_b32 v75, 0xffff0000, v53
  v_lshlrev_b32 v76, 16, v54
  v_and_b32 v77, 0xffff0000, v54
  v_lshlrev_b32 v78, 16, v55
  v_and_b32 v79, 0xffff0000, v55
  s_waitcnt lgkmcnt(14)
  v_pk_add_f32 v[64:65], v[64:65], v[128:129]
  v_pk_add_f32 v[66:67], v[66:67], v[130:131]
  v_pk_add_f32 v[68:69], v[68:69], v[132:133]
  v_pk_add_f32 v[70:71], v[70:71], v[134:135]
  s_waitcnt lgkmcnt(12)
  v_pk_add_f32 v[64:65], v[64:65], v[136:137]
  v_pk_add_f32 v[66:67], v[66:67], v[138:139]
  v_pk_add_f32 v[68:69], v[68:69], v[140:141]
  v_pk_add_f32 v[70:71], v[70:71], v[142:143]
  s_waitcnt lgkmcnt(10)
  v_pk_add_f32 v[64:65], v[64:65], v[144:145]
  v_pk_add_f32 v[66:67], v[66:67], v[146:147]
  v_pk_add_f32 v[68:69], v[68:69], v[148:149]
  v_pk_add_f32 v[70:71], v[70:71], v[150:151]
  s_waitcnt lgkmcnt(8)
  v_pk_add_f32 v[64:65], v[64:65], v[152:153]
  v_pk_add_f32 v[66:67], v[66:67], v[154:155]
  v_pk_add_f32 v[68:69], v[68:69], v[156:157]
  v_pk_add_f32 v[70:71], v[70:71], v[158:159]
  v_cvt_pk_bf16_f32 v56, v64, v65
  v_cvt_pk_bf16_f32 v57, v66, v67
  v_cvt_pk_bf16_f32 v58, v68, v69
  v_cvt_pk_bf16_f32 v59, v70, v71
  buffer_store_dwordx4 v[56:59], v32, s[32:35], s75 offen
  s_waitcnt lgkmcnt(6)
  v_pk_add_f32 v[72:73], v[72:73], v[160:161]
  v_pk_add_f32 v[74:75], v[74:75], v[162:163]
  v_pk_add_f32 v[76:77], v[76:77], v[164:165]
  v_pk_add_f32 v[78:79], v[78:79], v[166:167]
  s_waitcnt lgkmcnt(4)
  v_pk_add_f32 v[72:73], v[72:73], v[168:169]
  v_pk_add_f32 v[74:75], v[74:75], v[170:171]
  v_pk_add_f32 v[76:77], v[76:77], v[172:173]
  v_pk_add_f32 v[78:79], v[78:79], v[174:175]
  s_waitcnt lgkmcnt(2)
  v_pk_add_f32 v[72:73], v[72:73], v[176:177]
  v_pk_add_f32 v[74:75], v[74:75], v[178:179]
  v_pk_add_f32 v[76:77], v[76:77], v[180:181]
  v_pk_add_f32 v[78:79], v[78:79], v[182:183]
  s_waitcnt lgkmcnt(0)
  v_pk_add_f32 v[72:73], v[72:73], v[184:185]
  v_pk_add_f32 v[74:75], v[74:75], v[186:187]
  v_pk_add_f32 v[76:77], v[76:77], v[188:189]
  v_pk_add_f32 v[78:79], v[78:79], v[190:191]
  v_cvt_pk_bf16_f32 v60, v72, v73
  v_cvt_pk_bf16_f32 v61, v74, v75
  v_cvt_pk_bf16_f32 v62, v76, v77
  v_cvt_pk_bf16_f32 v63, v78, v79
  s_add_u32 s7, s75, 8192
  buffer_store_dwordx4 v[60:63], v32, s[32:35], s7 offen
  s_endpgm
L_KV_slow_1:
  s_mov_b32 s70, 0
L_KV_spin_3:
  s_add_u32 s70, s70, 1
  s_cmp_ge_u32 s70, 100000
  s_cbranch_scc1 L_KV_pback_2
  s_sleep 1
  v_lshlrev_b32 v60, 6, v30
  v_add_u32 v60, v60, v25
  s_mov_b64 exec, 0xf
  buffer_load_dword v31, v60, s[40:43], 0 offen sc1
  s_waitcnt vmcnt(0)
  v_cmp_le_u32 vcc, s44, v31
  s_mov_b64 exec, -1
  s_nop 2
  s_cmp_eq_u64 vcc, 0xf
  s_cbranch_scc0 L_KV_spin_3
  s_branch L_KV_pback_2
L_KV_bad_4:
  s_mov_b32 s70, 0
L_KV_retry_6:
  s_add_u32 s70, s70, 1
  s_cmp_ge_u32 s70, 100000
  s_cbranch_scc1 L_KV_back_5
  s_add_u32 s6, s57, 0
  buffer_load_dwordx4 v[128:131], v1, s[36:39], s6 offen sc1
  buffer_load_dwordx4 v[132:135], v1, s[36:39], s6 offen offset:1024 sc1
  buffer_load_dwordx4 v[136:139], v1, s[36:39], s6 offen offset:2048 sc1
  buffer_load_dwordx4 v[140:143], v1, s[36:39], s6 offen offset:3072 sc1
  s_add_u32 s6, s57, 4096
  buffer_load_dwordx4 v[144:147], v1, s[36:39], s6 offen sc1
  buffer_load_dwordx4 v[148:151], v1, s[36:39], s6 offen offset:1024 sc1
  buffer_load_dwordx4 v[152:155], v1, s[36:39], s6 offen offset:2048 sc1
  buffer_load_dwordx4 v[156:159], v1, s[36:39], s6 offen offset:3072 sc1
  s_add_u32 s6, s74, 0
  buffer_load_dword v2, v0, s[36:39], s6 offen sc1
  buffer_load_dword v3, v0, s[36:39], s6 offen offset:256 sc1
  s_waitcnt vmcnt(0)
  v_bitop3_b32 v36, v128, v129, v130 bitop3:0x96
  v_bitop3_b32 v37, v145, v146, v147 bitop3:0x96
  v_bitop3_b32 v36, v131, v132, v36 bitop3:0x96
  v_bitop3_b32 v37, v148, v149, v37 bitop3:0x96
  v_bitop3_b32 v36, v133, v134, v36 bitop3:0x96
  v_bitop3_b32 v37, v150, v151, v37 bitop3:0x96
  v_bitop3_b32 v36, v135, v136, v36 bitop3:0x96
  v_bitop3_b32 v37, v152, v153, v37 bitop3:0x96
  v_bitop3_b32 v36, v137, v138, v36 bitop3:0x96
  v_bitop3_b32 v37, v154, v155, v37 bitop3:0x96
  v_bitop3_b32 v36, v139, v140, v36 bitop3:0x96
  v_bitop3_b32 v37, v156, v157, v37 bitop3:0x96
  v_bitop3_b32 v36, v141, v142, v36 bitop3:0x96
  v_bitop3_b32 v37, v158, v159, v37 bitop3:0x96
  v_bitop3_b32 v36, v143, v144, v36 bitop3:0x96
  v_bitop3_b32 v37, v2, v3, v37 bitop3:0x96
  v_bitop3_b32 v36, v36, v37, s76 bitop3:0x96
  v_cmp_ne_u32 vcc, 0, v36
  s_nop 3
  s_cbranch_vccnz L_KV_retry_6
  s_branch L_KV_back_5
L_KV_bad_7:
  s_mov_b32 s70, 0
L_KV_retry_9:
  s_add_u32 s70, s70, 1
  s_cmp_ge_u32 s70, 100000
  s_cbranch_scc1 L_KV_back_8
  s_add_u32 s6, s57, 40960
  buffer_load_dwordx4 v[160:163], v1, s[36:39], s6 offen sc1
  buffer_load_dwordx4 v[164:167], v1, s[36:39], s6 offen offset:1024 sc1
  buffer_load_dwordx4 v[168:171], v1, s[36:39], s6 offen offset:2048 sc1
  buffer_load_dwordx4 v[172:175], v1, s[36:39], s6 offen offset:3072 sc1
  s_add_u32 s6, s57, 45056
  buffer_load_dwordx4 v[176:179], v1, s[36:39], s6 offen sc1
  buffer_load_dwordx4 v[180:183], v1, s[36:39], s6 offen offset:1024 sc1
  buffer_load_dwordx4 v[184:187], v1, s[36:39], s6 offen offset:2048 sc1
  buffer_load_dwordx4 v[188:191], v1, s[36:39], s6 offen offset:3072 sc1
  s_add_u32 s6, s74, 10240
  buffer_load_dword v4, v0, s[36:39], s6 offen sc1
  buffer_load_dword v5, v0, s[36:39], s6 offen offset:256 sc1
  s_waitcnt vmcnt(0)
  v_bitop3_b32 v38, v160, v161, v162 bitop3:0x96
  v_bitop3_b32 v39, v177, v178, v179 bitop3:0x96
  v_bitop3_b32 v38, v163, v164, v38 bitop3:0x96
  v_bitop3_b32 v39, v180, v181, v39 bitop3:0x96
  v_bitop3_b32 v38, v165, v166, v38 bitop3:0x96
  v_bitop3_b32 v39, v182, v183, v39 bitop3:0x96
  v_bitop3_b32 v38, v167, v168, v38 bitop3:0x96
  v_bitop3_b32 v39, v184, v185, v39 bitop3:0x96
  v_bitop3_b32 v38, v169, v170, v38 bitop3:0x96
  v_bitop3_b32 v39, v186, v187, v39 bitop3:0x96
  v_bitop3_b32 v38, v171, v172, v38 bitop3:0x96
  v_bitop3_b32 v39, v188, v189, v39 bitop3:0x96
  v_bitop3_b32 v38, v173, v174, v38 bitop3:0x96
  v_bitop3_b32 v39, v190, v191, v39 bitop3:0x96
  v_bitop3_b32 v38, v175, v176, v38 bitop3:0x96
  v_bitop3_b32 v39, v4, v5, v39 bitop3:0x96
  v_bitop3_b32 v38, v38, v39, s79 bitop3:0x96
  v_cmp_ne_u32 vcc, 0, v38
  s_nop 3
  s_cbranch_vccnz L_KV_retry_9
  s_branch L_KV_back_8
L_KV_bad_10:
  s_mov_b32 s70, 0
L_KV_retry_12:
  s_add_u32 s70, s70, 1
  s_cmp_ge_u32 s70, 100000
  s_cbranch_scc1 L_KV_back_11
  s_add_u32 s6, s57, 8192
  buffer_load_dwordx4 v[192:195], v1, s[36:39], s6 offen sc1
  buffer_load_dwordx4 v[196:199], v1, s[36:39], s6 offen offset:1024 sc1
  buffer_load_dwordx4 v[200:203], v1, s[36:39], s6 offen offset:2048 sc1
  buffer_load_dwordx4 v[204:207], v1, s[36:39], s6 offen offset:3072 sc1
  s_add_u32 s6, s57, 12288
  buffer_load_dwordx4 v[208:211], v1, s[36:39], s6 offen sc1
  buffer_load_dwordx4 v[212:215], v1, s[36:39], s6 offen offset:1024 sc1
  buffer_load_dwordx4 v[216:219], v1, s[36:39], s6 offen offset:2048 sc1
  buffer_load_dwordx4 v[220:223], v1, s[36:39], s6 offen offset:3072 sc1
  s_add_u32 s6, s74, 2048
  buffer_load_dword v6, v0, s[36:39], s6 offen sc1
  buffer_load_dword v7, v0, s[36:39], s6 offen offset:256 sc1
  s_waitcnt vmcnt(0)
  v_bitop3_b32 v36, v192, v193, v194 bitop3:0x96
  v_bitop3_b32 v37, v209, v210, v211 bitop3:0x96
  v_bitop3_b32 v36, v195, v196, v36 bitop3:0x96
  v_bitop3_b32 v37, v212, v213, v37 bitop3:0x96
  v_bitop3_b32 v36, v197, v198, v36 bitop3:0x96
  v_bitop3_b32 v37, v214, v215, v37 bitop3:0x96
  v_bitop3_b32 v36, v199, v200, v36 bitop3:0x96
  v_bitop3_b32 v37, v216, v217, v37 bitop3:0x96
  v_bitop3_b32 v36, v201, v202, v36 bitop3:0x96
  v_bitop3_b32 v37, v218, v219, v37 bitop3:0x96
  v_bitop3_b32 v36, v203, v204, v36 bitop3:0x96
  v_bitop3_b32 v37, v220, v221, v37 bitop3:0x96
  v_bitop3_b32 v36, v205, v206, v36 bitop3:0x96
  v_bitop3_b32 v37, v222, v223, v37 bitop3:0x96
  v_bitop3_b32 v36, v207, v208, v36 bitop3:0x96
  v_bitop3_b32 v37, v6, v7, v37 bitop3:0x96
  v_bitop3_b32 v36, v36, v37, s76 bitop3:0x96
  v_cmp_ne_u32 vcc, 0, v36
  s_nop 3
  s_cbranch_vccnz L_KV_retry_12
  s_branch L_KV_back_11
L_KV_bad_13:
  s_mov_b32 s70, 0
L_KV_retry_15:
  s_add_u32 s70, s70, 1
  s_cmp_ge_u32 s70, 100000
  s_cbranch_scc1 L_KV_back_14
  s_add_u32 s6, s57, 49152
  buffer_load_dwordx4 v[224:227], v1, s[36:39], s6 offen sc1
  buffer_load_dwordx4 v[228:231], v1, s[36:39], s6 offen offset:1024 sc1
  buffer_load_dwordx4 v[232:235], v1, s[36:39], s6 offen offset:2048 sc1
  buffer_load_dwordx4 v[236:239], v1, s[36:39], s6 offen offset:3072 sc1
  s_add_u32 s6, s57, 53248
  buffer_load_dwordx4 v[240:243], v1, s[36:39], s6 offen sc1
  buffer_load_dwordx4 v[244:247], v1, s[36:39], s6 offen offset:1024 sc1
  buffer_load_dwordx4 v[248:251], v1, s[36:39], s6 offen offset:2048 sc1
  buffer_load_dwordx4 v[252:255], v1, s[36:39], s6 offen offset:3072 sc1
  s_add_u32 s6, s74, 12288
  buffer_load_dword v8, v0, s[36:39], s6 offen sc1
  buffer_load_dword v9, v0, s[36:39], s6 offen offset:256 sc1
  s_waitcnt vmcnt(0)
  v_bitop3_b32 v38, v224, v225, v226 bitop3:0x96
  v_bitop3_b32 v39, v241, v242, v243 bitop3:0x96
  v_bitop3_b32 v38, v227, v228, v38 bitop3:0x96
  v_bitop3_b32 v39, v244, v245, v39 bitop3:0x96
  v_bitop3_b32 v38, v229, v230, v38 bitop3:0x96
  v_bitop3_b32 v39, v246, v247, v39 bitop3:0x96
  v_bitop3_b32 v38, v231, v232, v38 bitop3:0x96
  v_bitop3_b32 v39, v248, v249, v39 bitop3:0x96
  v_bitop3_b32 v38, v233, v234, v38 bitop3:0x96
  v_bitop3_b32 v39, v250, v251, v39 bitop3:0x96
  v_bitop3_b32 v38, v235, v236, v38 bitop3:0x96
  v_bitop3_b32 v39, v252, v253, v39 bitop3:0x96
  v_bitop3_b32 v38, v237, v238, v38 bitop3:0x96
  v_bitop3_b32 v39, v254, v255, v39 bitop3:0x96
  v_bitop3_b32 v38, v239, v240, v38 bitop3:0x96
  v_bitop3_b32 v39, v8, v9, v39 bitop3:0x96
  v_bitop3_b32 v38, v38, v39, s79 bitop3:0x96
  v_cmp_ne_u32 vcc, 0, v38
  s_nop 3
  s_cbranch_vccnz L_KV_retry_15
  s_branch L_KV_back_14
L_KV_bad_16:
  s_mov_b32 s70, 0
L_KV_retry_18:
  s_add_u32 s70, s70, 1
  s_cmp_ge_u32 s70, 100000
  s_cbranch_scc1 L_KV_back_17
  s_add_u32 s6, s57, 16384
  buffer_load_dwordx4 v[128:131], v1, s[36:39], s6 offen sc1
  buffer_load_dwordx4 v[132:135], v1, s[36:39], s6 offen offset:1024 sc1
  buffer_load_dwordx4 v[136:139], v1, s[36:39], s6 offen offset:2048 sc1
  buffer_load_dwordx4 v[140:143], v1, s[36:39], s6 offen offset:3072 sc1
  s_add_u32 s6, s57, 20480
  buffer_load_dwordx4 v[144:147], v1, s[36:39], s6 offen sc1
  buffer_load_dwordx4 v[148:151], v1, s[36:39], s6 offen offset:1024 sc1
  buffer_load_dwordx4 v[152:155], v1, s[36:39], s6 offen offset:2048 sc1
  buffer_load_dwordx4 v[156:159], v1, s[36:39], s6 offen offset:3072 sc1
  s_add_u32 s6, s74, 4096
  buffer_load_dword v10, v0, s[36:39], s6 offen sc1
  buffer_load_dword v11, v0, s[36:39], s6 offen offset:256 sc1
  s_waitcnt vmcnt(0)
  v_bitop3_b32 v36, v128, v129, v130 bitop3:0x96
  v_bitop3_b32 v37, v145, v146, v147 bitop3:0x96
  v_bitop3_b32 v36, v131, v132, v36 bitop3:0x96
  v_bitop3_b32 v37, v148, v149, v37 bitop3:0x96
  v_bitop3_b32 v36, v133, v134, v36 bitop3:0x96
  v_bitop3_b32 v37, v150, v151, v37 bitop3:0x96
  v_bitop3_b32 v36, v135, v136, v36 bitop3:0x96
  v_bitop3_b32 v37, v152, v153, v37 bitop3:0x96
  v_bitop3_b32 v36, v137, v138, v36 bitop3:0x96
  v_bitop3_b32 v37, v154, v155, v37 bitop3:0x96
  v_bitop3_b32 v36, v139, v140, v36 bitop3:0x96
  v_bitop3_b32 v37, v156, v157, v37 bitop3:0x96
  v_bitop3_b32 v36, v141, v142, v36 bitop3:0x96
  v_bitop3_b32 v37, v158, v159, v37 bitop3:0x96
  v_bitop3_b32 v36, v143, v144, v36 bitop3:0x96
  v_bitop3_b32 v37, v10, v11, v37 bitop3:0x96
  v_bitop3_b32 v36, v36, v37, s77 bitop3:0x96
  v_cmp_ne_u32 vcc, 0, v36
  s_nop 3
  s_cbranch_vccnz L_KV_retry_18
  s_branch L_KV_back_17
L_KV_bad_19:
  s_mov_b32 s70, 0
L_KV_retry_21:
  s_add_u32 s70, s70, 1
  s_cmp_ge_u32 s70, 100000
  s_cbranch_scc1 L_KV_back_20
  s_add_u32 s6, s57, 32768
  buffer_load_dwordx4 v[160:163], v1, s[36:39], s6 offen sc1
  buffer_load_dwordx4 v[164:167], v1, s[36:39], s6 offen offset:1024 sc1
  buffer_load_dwordx4 v[168:171], v1, s[36:39], s6 offen offset:2048 sc1
  buffer_load_dwordx4 v[172:175], v1, s[36:39], s6 offen offset:3072 sc1
  s_add_u32 s6, s57, 36864
  buffer_load_dwordx4 v[176:179], v1, s[36:39], s6 offen sc1
  buffer_load_dwordx4 v[180:183], v1, s[36:39], s6 offen offset:1024 sc1
  buffer_load_dwordx4 v[184:187], v1, s[36:39], s6 offen offset:2048 sc1
  buffer_load_dwordx4 v[188:191], v1, s[36:39], s6 offen offset:3072 sc1
  s_add_u32 s6, s74, 8192
  buffer_load_dword v12, v0, s[36:39], s6 offen sc1
  buffer_load_dword v13, v0, s[36:39], s6 offen offset:256 sc1
  s_waitcnt vmcnt(0)
  v_bitop3_b32 v38, v160, v161, v162 bitop3:0x96
  v_bitop3_b32 v39, v177, v178, v179 bitop3:0x96
  v_bitop3_b32 v38, v163, v164, v38 bitop3:0x96
  v_bitop3_b32 v39, v180, v181, v39 bitop3:0x96
  v_bitop3_b32 v38, v165, v166, v38 bitop3:0x96
  v_bitop3_b32 v39, v182, v183, v39 bitop3:0x96
  v_bitop3_b32 v38, v167, v168, v38 bitop3:0x96
  v_bitop3_b32 v39, v184, v185, v39 bitop3:0x96
  v_bitop3_b32 v38, v169, v170, v38 bitop3:0x96
  v_bitop3_b32 v39, v186, v187, v39 bitop3:0x96
  v_bitop3_b32 v38, v171, v172, v38 bitop3:0x96
  v_bitop3_b32 v39, v188, v189, v39 bitop3:0x96
  v_bitop3_b32 v38, v173, v174, v38 bitop3:0x96
  v_bitop3_b32 v39, v190, v191, v39 bitop3:0x96
  v_bitop3_b32 v38, v175, v176, v38 bitop3:0x96
  v_bitop3_b32 v39, v12, v13, v39 bitop3:0x96
  v_bitop3_b32 v38, v38, v39, s78 bitop3:0x96
  v_cmp_ne_u32 vcc, 0, v38
  s_nop 3
  s_cbranch_vccnz L_KV_retry_21
  s_branch L_KV_back_20
L_KV_bad_22:
  s_mov_b32 s70, 0
L_KV_retry_24:
  s_add_u32 s70, s70, 1
  s_cmp_ge_u32 s70, 100000
  s_cbranch_scc1 L_KV_back_23
  s_add_u32 s6, s57, 24576
  buffer_load_dwordx4 v[192:195], v1, s[36:39], s6 offen sc1
  buffer_load_dwordx4 v[196:199], v1, s[36:39], s6 offen offset:1024 sc1
  buffer_load_dwordx4 v[200:203], v1, s[36:39], s6 offen offset:2048 sc1
  buffer_load_dwordx4 v[204:207], v1, s[36:39], s6 offen offset:3072 sc1
  s_add_u32 s6, s74, 6144
  buffer_load_dword v2, v0, s[36:39], s6 offen sc1
  buffer_load_dword v3, v0, s[36:39], s6 offen offset:256 sc1
  s_waitcnt vmcnt(0)
  v_bitop3_b32 v36, v192, v193, v194 bitop3:0x96
  v_bitop3_b32 v37, v201, v202, v203 bitop3:0x96
  v_bitop3_b32 v36, v195, v196, v36 bitop3:0x96
  v_bitop3_b32 v37, v204, v205, v37 bitop3:0x96
  v_bitop3_b32 v36, v197, v198, v36 bitop3:0x96
  v_bitop3_b32 v37, v206, v207, v37 bitop3:0x96
  v_bitop3_b32 v36, v199, v200, v36 bitop3:0x96
  v_bitop3_b32 v37, v2, v3, v37 bitop3:0x96
  v_bitop3_b32 v36, v36, v37, s77 bitop3:0x96
  v_cmp_ne_u32 vcc, 0, v36
  s_nop 3
  s_cbranch_vccnz L_KV_retry_24
  s_branch L_KV_back_23
L_KV_bad_25:
  s_mov_b32 s70, 0
L_KV_retry_27:
  s_add_u32 s70, s70, 1
  s_cmp_ge_u32 s70, 100000
  s_cbranch_scc1 L_KV_back_26
  s_add_u32 s6, s57, 28672
  buffer_load_dwordx4 v[208:211], v1, s[36:39], s6 offen sc1
  buffer_load_dwordx4 v[212:215], v1, s[36:39], s6 offen offset:1024 sc1
  buffer_load_dwordx4 v[216:219], v1, s[36:39], s6 offen offset:2048 sc1
  buffer_load_dwordx4 v[220:223], v1, s[36:39], s6 offen offset:3072 sc1
  s_add_u32 s6, s74, 7168
  buffer_load_dword v4, v0, s[36:39], s6 offen sc1
  buffer_load_dword v5, v0, s[36:39], s6 offen offset:256 sc1
  s_waitcnt vmcnt(0)
  v_bitop3_b32 v38, v208, v209, v210 bitop3:0x96
  v_bitop3_b32 v39, v217, v218, v219 bitop3:0x96
  v_bitop3_b32 v38, v211, v212, v38 bitop3:0x96
  v_bitop3_b32 v39, v220, v221, v39 bitop3:0x96
  v_bitop3_b32 v38, v213, v214, v38 bitop3:0x96
  v_bitop3_b32 v39, v222, v223, v39 bitop3:0x96
  v_bitop3_b32 v38, v215, v216, v38 bitop3:0x96
  v_bitop3_b32 v39, v4, v5, v39 bitop3:0x96
  v_bitop3_b32 v38, v38, v39, s78 bitop3:0x96
  v_cmp_ne_u32 vcc, 0, v38
  s_nop 3
  s_cbranch_vccnz L_KV_retry_27
  s_branch L_KV_back_26
L_KV_bad_28:
  s_mov_b32 s70, 0
L_KV_retry_30:
  s_add_u32 s70, s70, 1
  s_cmp_ge_u32 s70, 100000
  s_cbranch_scc1 L_KV_back_29
  s_add_u32 s6, s58, 0
  buffer_load_dwordx4 v[224:227], v1, s[36:39], s6 offen sc1
  buffer_load_dwordx4 v[228:231], v1, s[36:39], s6 offen offset:1024 sc1
  buffer_load_dwordx4 v[232:235], v1, s[36:39], s6 offen offset:2048 sc1
  buffer_load_dwordx4 v[236:239], v1, s[36:39], s6 offen offset:3072 sc1
  s_add_u32 s6, s58, 4096
  buffer_load_dwordx4 v[240:243], v1, s[36:39], s6 offen sc1
  buffer_load_dwordx4 v[244:247], v1, s[36:39], s6 offen offset:1024 sc1
  buffer_load_dwordx4 v[248:251], v1, s[36:39], s6 offen offset:2048 sc1
  buffer_load_dwordx4 v[252:255], v1, s[36:39], s6 offen offset:3072 sc1
  s_mul_i32 s7, s45, 10240
  s_sub_u32 s7, s74, s7
  s_add_u32 s6, s7, 57344
  buffer_load_dword v6, v0, s[36:39], s6 offen sc1
  buffer_load_dword v7, v0, s[36:39], s6 offen offset:256 sc1
  s_waitcnt vmcnt(0)
  v_bitop3_b32 v36, v224, v225, v226 bitop3:0x96
  v_bitop3_b32 v37, v241, v242, v243 bitop3:0x96
  v_bitop3_b32 v36, v227, v228, v36 bitop3:0x96
  v_bitop3_b32 v37, v244, v245, v37 bitop3:0x96
  v_bitop3_b32 v36, v229, v230, v36 bitop3:0x96
  v_bitop3_b32 v37, v246, v247, v37 bitop3:0x96
  v_bitop3_b32 v36, v231, v232, v36 bitop3:0x96
  v_bitop3_b32 v37, v248, v249, v37 bitop3:0x96
  v_bitop3_b32 v36, v233, v234, v36 bitop3:0x96
  v_bitop3_b32 v37, v250, v251, v37 bitop3:0x96
  v_bitop3_b32 v36, v235, v236, v36 bitop3:0x96
  v_bitop3_b32 v37, v252, v253, v37 bitop3:0x96
  v_bitop3_b32 v36, v237, v238, v36 bitop3:0x96
  v_bitop3_b32 v37, v254, v255, v37 bitop3:0x96
  v_bitop3_b32 v36, v239, v240, v36 bitop3:0x96
  v_bitop3_b32 v37, v6, v7, v37 bitop3:0x96
  v_bitop3_b32 v36, v36, v37, s76 bitop3:0x96
  v_cmp_ne_u32 vcc, 0, v36
  s_nop 3
  s_cbranch_vccnz L_KV_retry_30
  s_branch L_KV_back_29
L_KV_bad_31:
  s_mov_b32 s70, 0
L_KV_retry_33:
  s_add_u32 s70, s70, 1
  s_cmp_ge_u32 s70, 100000
  s_cbranch_scc1 L_KV_back_32
  s_add_u32 s6, s58, 8192
  buffer_load_dwordx4 v[128:131], v1, s[36:39], s6 offen sc1
  buffer_load_dwordx4 v[132:135], v1, s[36:39], s6 offen offset:1024 sc1
  buffer_load_dwordx4 v[136:139], v1, s[36:39], s6 offen offset:2048 sc1
  buffer_load_dwordx4 v[140:143], v1, s[36:39], s6 offen offset:3072 sc1
  s_add_u32 s6, s58, 12288
  buffer_load_dwordx4 v[144:147], v1, s[36:39], s6 offen sc1
  buffer_load_dwordx4 v[148:151], v1, s[36:39], s6 offen offset:1024 sc1
  buffer_load_dwordx4 v[152:155], v1, s[36:39], s6 offen offset:2048 sc1
  buffer_load_dwordx4 v[156:159], v1, s[36:39], s6 offen offset:3072 sc1
  s_mul_i32 s7, s45, 10240
  s_sub_u32 s7, s74, s7
  s_add_u32 s6, s7, 59392
  buffer_load_dword v8, v0, s[36:39], s6 offen sc1
  buffer_load_dword v9, v0, s[36:39], s6 offen offset:256 sc1
  s_waitcnt vmcnt(0)
  v_bitop3_b32 v38, v128, v129, v130 bitop3:0x96
  v_bitop3_b32 v39, v145, v146, v147 bitop3:0x96
  v_bitop3_b32 v38, v131, v132, v38 bitop3:0x96
  v_bitop3_b32 v39, v148, v149, v39 bitop3:0x96
  v_bitop3_b32 v38, v133, v134, v38 bitop3:0x96
  v_bitop3_b32 v39, v150, v151, v39 bitop3:0x96
  v_bitop3_b32 v38, v135, v136, v38 bitop3:0x96
  v_bitop3_b32 v39, v152, v153, v39 bitop3:0x96
  v_bitop3_b32 v38, v137, v138, v38 bitop3:0x96
  v_bitop3_b32 v39, v154, v155, v39 bitop3:0x96
  v_bitop3_b32 v38, v139, v140, v38 bitop3:0x96
  v_bitop3_b32 v39, v156, v157, v39 bitop3:0x96
  v_bitop3_b32 v38, v141, v142, v38 bitop3:0x96
  v_bitop3_b32 v39, v158, v159, v39 bitop3:0x96
  v_bitop3_b32 v38, v143, v144, v38 bitop3:0x96
  v_bitop3_b32 v39, v8, v9, v39 bitop3:0x96
  v_bitop3_b32 v38, v38, v39, s79 bitop3:0x96
  v_cmp_ne_u32 vcc, 0, v38
  s_nop 3
  s_cbranch_vccnz L_KV_retry_33
  s_branch L_KV_back_32
L_end:
  s_endpgm
L_codeend:
  .fill 320, 4, 0xbf800000

.section .rodata,"a"
.p2align 6
.amdhsa_kernel parallel_sum__linear_attn_block__glu_gated_bilinear__prompt_kernel
  .amdhsa_next_free_vgpr 512
  .amdhsa_next_free_sgpr 102
  .amdhsa_accum_offset 256
  .amdhsa_group_segment_fixed_size 0
  .amdhsa_kernarg_size 80
  .amdhsa_user_sgpr_count 2
  .amdhsa_user_sgpr_kernarg_segment_ptr 1
  .amdhsa_system_sgpr_workgroup_id_x 1
.end_amdhsa_kernel
```
